```python
import torch

def _softmax(x, axis=-1):
    return torch.softmax(x, dim=axis)
def _gelu(x):
    return torch.nn.functional.gelu(x, approximate="tanh")
def _silu(x):
    return torch.nn.functional.silu(x)
def _sigmoid(x):
    return torch.sigmoid(x)
def _layernorm(x, axis=-1, eps=1e-5):
    m = x.mean(dim=axis, keepdim=True)
    v = x.var(dim=axis, keepdim=True, unbiased=False)
    return (x - m) / torch.sqrt(v + eps)
def _scatter_add(tgt, idx, src, axis=0):
    return tgt.clone().index_add_(axis, idx, src)
def _segment_sum(src, seg, n):
    out = torch.zeros((n,) + src.shape[1:], dtype=src.dtype)
    return out.index_add_(0, seg, src)
def _pad(x, pw):
    flat = tuple(v for pair in reversed(pw) for v in pair)
    return torch.nn.functional.pad(x, flat)

kernel_name = 'concat_heads__mha_block_cached__gqa_block_cached__near_ridge'

def setup_inputs():

    _w = (lambda a: (lambda t: t.to(torch.bfloat16) if t.is_floating_point() else t)(torch.as_tensor(a)))
    def _A_setup():
        B, Sq, D = 8, 256, 512
        H, Sk, Dh = 32, 1024, 128
        return {
            "x": _w((lambda *s: torch.randn(*s, dtype=torch.bfloat16) * 0.8)(B, Sq, D)),
            "k_cache": _w((lambda *s: torch.randn(*s, dtype=torch.bfloat16) * 0.8)(B, H, Sk, Dh)),
            "v_cache": _w((lambda *s: torch.randn(*s, dtype=torch.bfloat16) * 0.05)(B, H, Sk, Dh)),
            "wq": _w((lambda *s: torch.randn(*s, dtype=torch.bfloat16) * 0.8)(D, H * Dh) * (D ** -0.5)),
            "wo": _w((lambda *s: torch.randn(*s, dtype=torch.bfloat16) * 0.05)(H * Dh, D) * ((H * Dh) ** -0.5)),
        }
    _A_in = _A_setup()

    def _B_setup():
        B, Sq, D = 8, 256, 512
        Hq, Hkv, Sk, Dh = 32, 32, 1024, 128
        assert Hq % Hkv == 0, (Hq, Hkv)
        return {
            "x": _w((lambda *s: torch.randn(*s, dtype=torch.bfloat16) * 0.8)(B, Sq, D)),
            "k_cache": _w((lambda *s: torch.randn(*s, dtype=torch.bfloat16) * 0.8)(B, Hkv, Sk, Dh)),
            "v_cache": _w((lambda *s: torch.randn(*s, dtype=torch.bfloat16) * 0.05)(B, Hkv, Sk, Dh)),
            "wq": _w((lambda *s: torch.randn(*s, dtype=torch.bfloat16) * 0.8)(D, Hq * Dh) * (D ** -0.5)),
            "wo": _w((lambda *s: torch.randn(*s, dtype=torch.bfloat16) * 0.05)(Hq * Dh, D) * ((Hq * Dh) ** -0.5)),
        }
    _B_in = _B_setup()

    return {
        "A_x": _A_in["x"],
        "A_k_cache": _A_in["k_cache"],
        "A_v_cache": _A_in["v_cache"],
        "A_wq": _A_in["wq"],
        "A_wo": _A_in["wo"],
        "B_x": _B_in["x"],
        "B_k_cache": _B_in["k_cache"],
        "B_v_cache": _B_in["v_cache"],
        "B_wq": _B_in["wq"],
        "B_wo": _B_in["wo"],
    }

def reference(A_x, A_k_cache, A_v_cache, A_wq, A_wo, B_x, B_k_cache, B_v_cache, B_wq, B_wo):
    def _A_ref(x, k_cache, v_cache, wq, wo):
        B, Sq, D = x.shape
        H, Dh = 32, 128
        q = (lambda x, *d: x.permute(*d))((x @ wq).reshape(B, Sq, H, Dh), 0, 2, 1, 3)
        scores = torch.einsum("bhqd,bhkd->bhqk", q, k_cache) * (Dh ** -0.5)
        p = _softmax(scores, axis=-1)
        o = torch.einsum("bhqk,bhkd->bhqd", p, v_cache)
        return (lambda x, *d: x.permute(*d))(o, 0, 2, 1, 3).reshape(B, Sq, H * Dh) @ wo

    def _B_ref(x, k_cache, v_cache, wq, wo):
        B, Sq, D = x.shape
        Hq, Dh = 32, 128
        Hkv = k_cache.shape[1]
        rep = Hq // Hkv
        q = (lambda x, *d: x.permute(*d))((x @ wq).reshape(B, Sq, Hq, Dh), 0, 2, 1, 3)
        k = (lambda x, n, axis: torch.repeat_interleave(x, n, dim=axis))(k_cache, rep, axis=1)
        v = (lambda x, n, axis: torch.repeat_interleave(x, n, dim=axis))(v_cache, rep, axis=1)
        scores = torch.einsum("bhqd,bhkd->bhqk", q, k) * (Dh ** -0.5)
        p = _softmax(scores, axis=-1)
        o = torch.einsum("bhqk,bhkd->bhqd", p, v)
        return (lambda x, *d: x.permute(*d))(o, 0, 2, 1, 3).reshape(B, Sq, Hq * Dh) @ wo

    a = _A_ref(A_x, A_k_cache, A_v_cache, A_wq, A_wo)
    b = _B_ref(B_x, B_k_cache, B_v_cache, B_wq, B_wo)
    return torch.concatenate([a, b], axis=-1)
```

```asm
; @launch grid=(256,1,1) block=(256,1,1) lds=163840
.amdgcn_target "amdgcn-amd-amdhsa--gfx950"
.text
.globl concat_heads__mha_block_cached__gqa_block_cached__near_ridge_kernel
.type concat_heads__mha_block_cached__gqa_block_cached__near_ridge_kernel,@function
.p2align 8
concat_heads__mha_block_cached__gqa_block_cached__near_ridge_kernel:
s_cmp_ge_u32 s2, 256
s_cbranch_scc1 K1_END
s_getpc_b64 s[36:37]
K1_PC:
s_mov_b64 s[78:79], s[36:37]
s_mov_b32 s38, (CODE_END - K1_PC)
s_mov_b32 s39, 0x20000
s_lshr_b32 s3, s2, 3
s_lshl_b32 s3, s3, 7
v_lshlrev_b32 v1, 12, v0
buffer_load_dword a48, v1, s[36:39], s3 offen
s_bfe_u32 s3, s2, 0x10002
s_mul_i32 s61, s3, 40
s_load_dwordx8 s[24:31], s[0:1], s61
s_add_u32 s62, s61, 32
s_load_dwordx2 s[82:83], s[0:1], s62
s_load_dwordx4 s[84:87], s[0:1], 80
s_load_dwordx2 s[32:33], s[0:1], 96
v_lshrrev_b32 v2, 6, v0
v_and_b32 v3, 63, v0
v_readfirstlane_b32 s40, v2
v_lshlrev_b32 v1, 4, v3
s_lshr_b32 s62, s2, 6
s_bfe_u32 s61, s2, 0x30003
s_and_b32 s92, s61, 1
s_lshr_b32 s88, s61, 1
s_and_b32 s93, s2, 1
s_mov_b32 s52, 0
s_bfe_u32 s63, s2, 0x10001
s_lshl_b32 s63, s63, 2
s_add_u32 s62, s62, s63
s_and_b32 s63, s2, 1
s_lshl_b32 s63, s63, 3
s_add_u32 s61, s61, s63
s_lshl_b32 s35, s40, 12
s_lshl_b32 s41, s40, 13
s_mov_b32 s53, 0
s_mul_i32 s43, s40, 4224
s_lshl_b32 s44, s52, 1
s_lshl_b32 s45, s52, 7
s_lshl_b32 s46, s44, 18
v_lshrrev_b32 v4, 3, v3
v_lshrrev_b32 v5, 4, v3
v_and_b32 v6, 7, v3
v_xor_b32 v6, v5, v6
v_lshlrev_b32 v6, 4, v6
v_lshl_add_u32 v6, v4, 10, v6
v_lshl_add_u32 v13, v2, 16, v6
v_lshrrev_b32 v8, 1, v5
v_lshlrev_b32 v8, 4, v8
v_and_b32 v9, 1, v5
v_lshl_add_u32 v8, v9, 2, v8
v_and_b32 v9, 1, v2
v_lshl_add_u32 v8, v9, 3, v8
v_lshlrev_b32 v8, 13, v8
v_and_b32 v9, 15, v3
v_lshl_add_u32 v8, v9, 4, v8
v_lshrrev_b32 v10, 1, v2
v_lshl_add_u32 v8, v10, 8, v8
v_lshrrev_b32 v10, 1, v9
v_xor_b32 v10, v10, v5
v_lshlrev_b32 v10, 4, v10
v_lshl_add_u32 v10, v9, 7, v10
v_lshl_add_u32 v4, v2, 13, v10
v_and_b32 v11, 1, v5
v_lshlrev_b32 v11, 2, v11
v_lshrrev_b32 v12, 2, v9
v_add_u32 v11, v11, v12
v_mul_u32_u24 v11, 1056, v11
v_lshrrev_b32 v12, 1, v5
v_lshl_add_u32 v11, v12, 9, v11
v_and_b32 v12, 3, v3
v_lshl_add_u32 v10, v12, 4, v11
v_xor_b32 v5, 64, v4
v_mov_b32 v2, v13
v_xor_b32 v3, 64, v13
v_add_u32 v9, 21408, v8
v_add_u32 v7, 7136, v8
v_mov_b32 v6, v8
v_add_u32 v8, 14272, v6
s_waitcnt lgkmcnt(0)
s_mov_b32 s89, s62
s_lshl_b32 s63, s62, 18
s_add_u32 s4, s24, s63
s_addc_u32 s5, s25, 0
s_lshl_b32 s63, s61, 9
s_add_u32 s8, s30, s63
s_addc_u32 s9, s31, 0
s_sub_u32 s10, 0x400000, s63
s_lshl_b32 s62, s62, 5
s_lshl_b32 s61, s61, 1
s_add_u32 s62, s62, s61
s_lshl_b32 s63, s62, 18
s_add_u32 s12, s26, s63
s_addc_u32 s13, s27, 0
s_add_u32 s16, s28, s63
s_addc_u32 s17, s29, 0
s_lshl_b32 s3, s3, 8
s_add_u32 s62, s62, s3
s_lshl_b32 s63, s62, 16
s_add_u32 s20, s32, s63
s_addc_u32 s21, s33, 0
s_mov_b32 s6, 0x40000
s_mov_b32 s7, 0x20000
s_mov_b32 s11, 0x20000
s_mov_b32 s14, 0x80000
s_mov_b32 s15, 0x20000
s_mov_b32 s18, 0x80000
s_mov_b32 s19, 0x20000
s_mov_b32 s22, 0x20000
s_mov_b32 s23, 0x20000
s_add_u32 s60, s41, 84480
s_lshl_b32 s61, s40, 10
s_add_u32 m0, s61, 150016
s_add_u32 s61, s61, (PF_TABLE - K1_PC)
buffer_load_dwordx4 v1, s[36:39], s61 offen lds
s_add_u32 m0, s43, 50688
s_nop 0
buffer_load_dwordx4 v6, s[8:11], s46 offen offset:0  lds
buffer_load_dwordx4 v7, s[8:11], s46 offen offset:1056  lds
buffer_load_dwordx4 v8, s[8:11], s46 offen offset:2112  lds
buffer_load_dwordx4 v9, s[8:11], s46 offen offset:3168  lds
s_add_u32 m0, s60, 0
s_add_u32 s61, s45, 0
buffer_load_dwordx4 v2, s[4:7], s61 offen  lds
s_add_u32 m0, s60, 1024
s_add_u32 s61, s45, 8192
buffer_load_dwordx4 v3, s[4:7], s61 offen  lds
s_add_u32 m0, s60, 2048
s_add_u32 s61, s45, 16384
buffer_load_dwordx4 v2, s[4:7], s61 offen  lds
s_add_u32 m0, s60, 3072
s_add_u32 s61, s45, 24576
buffer_load_dwordx4 v3, s[4:7], s61 offen  lds
s_add_u32 m0, s60, 4096
s_add_u32 s61, s45, 32768
buffer_load_dwordx4 v2, s[4:7], s61 offen  lds
s_add_u32 m0, s60, 5120
s_add_u32 s61, s45, 40960
buffer_load_dwordx4 v3, s[4:7], s61 offen  lds
s_add_u32 m0, s60, 6144
s_add_u32 s61, s45, 49152
buffer_load_dwordx4 v2, s[4:7], s61 offen  lds
s_add_u32 m0, s60, 7168
s_add_u32 s61, s45, 57344
buffer_load_dwordx4 v3, s[4:7], s61 offen  lds
s_add_u32 s44, s44, 1
s_and_b32 s44, s44, 15
s_lshl_b32 s46, s44, 18
s_add_u32 m0, s43, 16896
s_nop 0
buffer_load_dwordx4 v6, s[8:11], s46 offen offset:0  lds
buffer_load_dwordx4 v7, s[8:11], s46 offen offset:1056  lds
buffer_load_dwordx4 v8, s[8:11], s46 offen offset:2112  lds
buffer_load_dwordx4 v9, s[8:11], s46 offen offset:3168  lds
s_mov_b32 s47, 50688
s_mov_b32 s50, 0
s_mov_b32 s49, 84480
s_mov_b32 s24, 0
s_and_b32 s25, s53, 15
s_lshl_b32 s25, s25, 14
s_add_u32 s25, s25, s35
s_lshr_b32 s61, s3, 5
s_add_u32 s61, s61, s89
s_lshl_b32 s62, s61, 4
s_add_u32 s80, s86, s62
s_addc_u32 s81, s87, 0
s_lshl_b32 s61, s61, 1
s_add_u32 s61, s61, s93
s_lshl_b32 s26, s61, 20
s_lshl_b32 s27, s88, 8
s_lshl_b32 s61, s89, 19
s_add_u32 s61, s61, s27
s_lshl_b32 s62, s3, 2
s_add_u32 s61, s61, s62
s_add_u32 s64, s84, s61
s_addc_u32 s65, s85, 0
s_sub_u32 s66, 0x400000, s61
s_mov_b32 s67, 0x20000
s_lshr_b32 s62, s2, 1
s_lshl_b32 s61, s62, 16
s_add_u32 s61, s61, 33554432
s_add_u32 s68, s32, s61
s_addc_u32 s69, s33, 0
s_mov_b32 s70, 0x10000
s_mov_b32 s71, 0x20000
s_lshl_b32 s74, s40, 13
s_mov_b32 s75, 0x20000
s_lshl_b32 s61, s62, 8
s_add_u32 s61, s61, 41943040
s_add_u32 s76, s32, s61
s_addc_u32 s77, s33, 0
s_lshl_b32 s61, s93, 21
s_add_u32 s36, s82, s61
s_addc_u32 s37, s83, 0
s_mov_b32 s38, 0x200000
s_mov_b32 s39, 0x20000
s_mul_i32 s90, s40, 8448
s_mov_b32 s28, 0x100000
s_cmp_eq_u32 s40, 0
s_cselect_b32 s95, 10, 0xffff
v_and_b32 v13, 63, v0
v_lshlrev_b32 v13, 2, v13
v_add_u32 v11, 150016, v13
v_mov_b32 v14, 0x40000000
v_and_b32 v12, 1, v0
v_lshlrev_b32 v12, 7, v12
v_mov_b32 v13, 0
global_store_dword v12, v13, s[76:77] sc1
s_mov_b32 s54, 0x3e0293ee
s_mov_b32 s55, 0x3e0293ee
s_mov_b32 s56, 0
v_mov_b32 v12, 163836
v_mov_b32 v13, 0
ds_write_b32 v12, v13
v_add_u32 v12, 84480, v4
v_add_u32 v13, 50688, v10
s_waitcnt vmcnt(5) lgkmcnt(0)
s_barrier
ds_read_b128 a[0:3], v12 offset:0
ds_read_b128 a[4:7], v12 offset:2048
ds_read_b128 a[8:11], v12 offset:4096
ds_read_b128 a[12:15], v12 offset:6144
ds_read_b64_tr_b16 a[64:65], v13 offset:0
ds_read_b64_tr_b16 a[66:67], v13 offset:256
ds_read_b64_tr_b16 a[68:69], v13 offset:8
ds_read_b64_tr_b16 a[70:71], v13 offset:264
ds_read_b64_tr_b16 a[72:73], v13 offset:64
ds_read_b64_tr_b16 a[74:75], v13 offset:320
ds_read_b64_tr_b16 a[76:77], v13 offset:72
ds_read_b64_tr_b16 a[78:79], v13 offset:328
ds_read_b64_tr_b16 a[80:81], v13 offset:128
ds_read_b64_tr_b16 a[82:83], v13 offset:384
ds_read_b64_tr_b16 a[84:85], v13 offset:136
ds_read_b64_tr_b16 a[86:87], v13 offset:392
ds_read_b64_tr_b16 a[88:89], v13 offset:192
ds_read_b64_tr_b16 a[90:91], v13 offset:448
ds_read_b64_tr_b16 a[92:93], v13 offset:200
ds_read_b64_tr_b16 a[94:95], v13 offset:456
ds_read_b64_tr_b16 a[96:97], v13 offset:8448
ds_read_b64_tr_b16 a[98:99], v13 offset:8704
ds_read_b64_tr_b16 a[100:101], v13 offset:8456
ds_read_b64_tr_b16 a[102:103], v13 offset:8712
ds_read_b64_tr_b16 a[104:105], v13 offset:8512
ds_read_b64_tr_b16 a[106:107], v13 offset:8768
s_waitcnt lgkmcnt(15)
v_mfma_f32_16x16x32_bf16 a[32:35], a[64:67], a[0:3], 0
s_add_u32 s44, s44, 1
s_and_b32 s44, s44, 15
ds_read_b64_tr_b16 a[108:109], v13 offset:8520
v_mfma_f32_16x16x32_bf16 a[36:39], a[64:67], a[4:7], 0
s_lshl_b32 s46, s44, 18
s_add_u32 m0, s43, 33792
v_mfma_f32_16x16x32_bf16 a[40:43], a[64:67], a[8:11], 0
ds_read_b64_tr_b16 a[110:111], v13 offset:8776
buffer_load_dwordx4 v6, s[8:11], s46 offen offset:0  lds
v_mfma_f32_16x16x32_bf16 a[44:47], a[64:67], a[12:15], 0
v_mfma_f32_16x16x32_bf16 v[28:31], a[68:71], a[12:15], 0
buffer_load_dwordx4 v7, s[8:11], s46 offen offset:1056  lds
v_mfma_f32_16x16x32_bf16 v[24:27], a[68:71], a[8:11], 0
ds_read_b64_tr_b16 a[112:113], v13 offset:8576
v_mfma_f32_16x16x32_bf16 v[20:23], a[68:71], a[4:7], 0
buffer_load_dwordx4 v8, s[8:11], s46 offen offset:2112  lds
v_mfma_f32_16x16x32_bf16 v[16:19], a[68:71], a[0:3], 0
v_mfma_f32_16x16x32_bf16 v[32:35], a[72:75], a[0:3], 0
s_waitcnt lgkmcnt(15)
ds_read_b64_tr_b16 a[114:115], v13 offset:8832
buffer_load_dwordx4 v9, s[8:11], s46 offen offset:3168  lds
v_mfma_f32_16x16x32_bf16 v[36:39], a[72:75], a[4:7], 0
s_add_u32 s52, s52, 1
s_and_b32 s52, s52, 7
v_mfma_f32_16x16x32_bf16 v[40:43], a[72:75], a[8:11], 0
s_lshl_b32 s45, s52, 7
s_add_u32 s60, s41, 117248
v_mfma_f32_16x16x32_bf16 v[44:47], a[72:75], a[12:15], 0
s_add_u32 m0, s60, 0
s_add_u32 s61, s45, 0
ds_read_b64_tr_b16 a[116:117], v13 offset:8584
v_mfma_f32_16x16x32_bf16 v[60:63], a[76:79], a[12:15], 0
ds_read_b64_tr_b16 a[118:119], v13 offset:8840
buffer_load_dwordx4 v2, s[4:7], s61 offen  lds
v_mfma_f32_16x16x32_bf16 v[56:59], a[76:79], a[8:11], 0
s_add_u32 m0, s60, 1024
s_add_u32 s61, s45, 8192
v_mfma_f32_16x16x32_bf16 v[52:55], a[76:79], a[4:7], 0
ds_read_b64_tr_b16 a[120:121], v13 offset:8640
buffer_load_dwordx4 v3, s[4:7], s61 offen  lds
v_mfma_f32_16x16x32_bf16 v[48:51], a[76:79], a[0:3], 0
s_add_u32 m0, s60, 2048
s_add_u32 s61, s45, 16384
v_mfma_f32_16x16x32_bf16 v[64:67], a[80:83], a[0:3], 0
buffer_load_dwordx4 v2, s[4:7], s61 offen  lds
v_mfma_f32_16x16x32_bf16 v[68:71], a[80:83], a[4:7], 0
s_add_u32 m0, s60, 3072
s_add_u32 s61, s45, 24576
ds_read_b64_tr_b16 a[122:123], v13 offset:8896
v_mfma_f32_16x16x32_bf16 v[72:75], a[80:83], a[8:11], 0
s_waitcnt lgkmcnt(15)
buffer_load_dwordx4 v3, s[4:7], s61 offen  lds
v_mfma_f32_16x16x32_bf16 v[76:79], a[80:83], a[12:15], 0
s_add_u32 m0, s60, 4096
s_add_u32 s61, s45, 32768
v_mfma_f32_16x16x32_bf16 v[92:95], a[84:87], a[12:15], 0
ds_read_b64_tr_b16 a[124:125], v13 offset:8648
buffer_load_dwordx4 v2, s[4:7], s61 offen  lds
v_mfma_f32_16x16x32_bf16 v[88:91], a[84:87], a[8:11], 0
s_add_u32 m0, s60, 5120
s_add_u32 s61, s45, 40960
ds_read_b32 v14, v11
v_mfma_f32_16x16x32_bf16 v[84:87], a[84:87], a[4:7], 0
buffer_load_dwordx4 v3, s[4:7], s61 offen  lds
v_mfma_f32_16x16x32_bf16 v[80:83], a[84:87], a[0:3], 0
s_add_u32 m0, s60, 6144
s_add_u32 s61, s45, 49152
ds_read_b64_tr_b16 a[126:127], v13 offset:8904
v_mfma_f32_16x16x32_bf16 v[96:99], a[88:91], a[0:3], 0
buffer_load_dwordx4 v2, s[4:7], s61 offen  lds
v_add_u32 v11, 256, v11
v_mfma_f32_16x16x32_bf16 v[100:103], a[88:91], a[4:7], 0
s_add_u32 m0, s60, 7168
s_add_u32 s61, s45, 57344
v_mfma_f32_16x16x32_bf16 v[104:107], a[88:91], a[8:11], 0
s_waitcnt lgkmcnt(15)
buffer_load_dwordx4 v3, s[4:7], s61 offen  lds
v_mfma_f32_16x16x32_bf16 v[108:111], a[88:91], a[12:15], 0
v_mfma_f32_16x16x32_bf16 v[124:127], a[92:95], a[12:15], 0
s_add_u32 s48, s47, 16896
v_mfma_f32_16x16x32_bf16 v[120:123], a[92:95], a[8:11], 0
s_cmp_eq_u32 s48, 67584
v_mfma_f32_16x16x32_bf16 v[116:119], a[92:95], a[4:7], 0
s_cselect_b32 s48, 16896, s48
v_mfma_f32_16x16x32_bf16 v[112:115], a[92:95], a[0:3], 0
s_waitcnt vmcnt(13) lgkmcnt(0)
v_mfma_f32_16x16x32_bf16 v[128:131], a[96:99], a[0:3], 0
s_barrier
v_add_u32 v12, s49, v5
v_add_u32 v13, s48, v10
v_mfma_f32_16x16x32_bf16 v[160:163], a[96:99], a[4:7], 0
ds_read_b128 a[16:19], v12 offset:0
v_mfma_f32_16x16x32_bf16 v[192:195], a[96:99], a[8:11], 0
s_add_u32 s44, s44, 1
s_and_b32 s44, s44, 15
ds_read_b128 a[20:23], v12 offset:2048
v_mfma_f32_16x16x32_bf16 v[224:227], a[96:99], a[12:15], 0
s_lshl_b32 s46, s44, 18
s_add_u32 m0, s43, s47
ds_read_b128 a[24:27], v12 offset:4096
v_mfma_f32_16x16x32_bf16 v[228:231], a[100:103], a[12:15], 0
buffer_load_dwordx4 v6, s[8:11], s46 offen offset:0  lds
v_mfma_f32_16x16x32_bf16 v[196:199], a[100:103], a[8:11], 0
ds_read_b128 a[28:31], v12 offset:6144
v_mfma_f32_16x16x32_bf16 v[164:167], a[100:103], a[4:7], 0
ds_read_b64_tr_b16 a[64:65], v13 offset:0
v_mfma_f32_16x16x32_bf16 v[132:135], a[100:103], a[0:3], 0
ds_read_b64_tr_b16 a[66:67], v13 offset:256
v_mfma_f32_16x16x32_bf16 v[136:139], a[104:107], a[0:3], 0
ds_read_b64_tr_b16 a[68:69], v13 offset:8
v_mfma_f32_16x16x32_bf16 v[168:171], a[104:107], a[4:7], 0
ds_read_b64_tr_b16 a[70:71], v13 offset:264
v_mfma_f32_16x16x32_bf16 v[200:203], a[104:107], a[8:11], 0
buffer_load_dwordx4 v7, s[8:11], s46 offen offset:1056  lds
v_mfma_f32_16x16x32_bf16 v[232:235], a[104:107], a[12:15], 0
ds_read_b64_tr_b16 a[72:73], v13 offset:64
v_mfma_f32_16x16x32_bf16 v[236:239], a[108:111], a[12:15], 0
ds_read_b64_tr_b16 a[74:75], v13 offset:320
v_mfma_f32_16x16x32_bf16 v[204:207], a[108:111], a[8:11], 0
ds_read_b64_tr_b16 a[76:77], v13 offset:72
v_mfma_f32_16x16x32_bf16 v[172:175], a[108:111], a[4:7], 0
ds_read_b64_tr_b16 a[78:79], v13 offset:328
v_mfma_f32_16x16x32_bf16 v[140:143], a[108:111], a[0:3], 0
ds_read_b64_tr_b16 a[80:81], v13 offset:128
v_mfma_f32_16x16x32_bf16 v[144:147], a[112:115], a[0:3], 0
buffer_load_dwordx4 v8, s[8:11], s46 offen offset:2112  lds
v_mfma_f32_16x16x32_bf16 v[176:179], a[112:115], a[4:7], 0
ds_read_b64_tr_b16 a[82:83], v13 offset:384
v_mfma_f32_16x16x32_bf16 v[208:211], a[112:115], a[8:11], 0
ds_read_b64_tr_b16 a[84:85], v13 offset:136
v_mfma_f32_16x16x32_bf16 v[240:243], a[112:115], a[12:15], 0
ds_read_b64_tr_b16 a[86:87], v13 offset:392
v_mfma_f32_16x16x32_bf16 v[244:247], a[116:119], a[12:15], 0
ds_read_b64_tr_b16 a[88:89], v13 offset:192
v_mfma_f32_16x16x32_bf16 v[212:215], a[116:119], a[8:11], 0
ds_read_b64_tr_b16 a[90:91], v13 offset:448
v_mfma_f32_16x16x32_bf16 v[180:183], a[116:119], a[4:7], 0
buffer_load_dwordx4 v9, s[8:11], s46 offen offset:3168  lds
v_mfma_f32_16x16x32_bf16 v[148:151], a[116:119], a[0:3], 0
ds_read_b64_tr_b16 a[92:93], v13 offset:200
v_mfma_f32_16x16x32_bf16 v[152:155], a[120:123], a[0:3], 0
ds_read_b64_tr_b16 a[94:95], v13 offset:456
v_mfma_f32_16x16x32_bf16 v[184:187], a[120:123], a[4:7], 0
ds_read_b64_tr_b16 a[96:97], v13 offset:8448
v_mfma_f32_16x16x32_bf16 v[216:219], a[120:123], a[8:11], 0
s_mov_b32 s47, s48
ds_read_b64_tr_b16 a[98:99], v13 offset:8704
v_mfma_f32_16x16x32_bf16 v[248:251], a[120:123], a[12:15], 0
ds_read_b64_tr_b16 a[100:101], v13 offset:8456
v_mfma_f32_16x16x32_bf16 v[252:255], a[124:127], a[12:15], 0
buffer_load_dword a48, v14, s[12:15], s35 offen
v_mfma_f32_16x16x32_bf16 v[220:223], a[124:127], a[8:11], 0
ds_read_b64_tr_b16 a[102:103], v13 offset:8712
v_mfma_f32_16x16x32_bf16 v[188:191], a[124:127], a[4:7], 0
ds_read_b64_tr_b16 a[104:105], v13 offset:8512
v_mfma_f32_16x16x32_bf16 v[156:159], a[124:127], a[0:3], 0
ds_read_b64_tr_b16 a[106:107], v13 offset:8768
s_waitcnt lgkmcnt(15)
v_mfma_f32_16x16x32_bf16 a[32:35], a[64:67], a[16:19], a[32:35]
ds_read_b64_tr_b16 a[108:109], v13 offset:8520
v_mfma_f32_16x16x32_bf16 a[36:39], a[64:67], a[20:23], a[36:39]
s_add_u32 s52, s52, 1
s_and_b32 s52, s52, 7
v_mfma_f32_16x16x32_bf16 a[40:43], a[64:67], a[24:27], a[40:43]
s_lshl_b32 s45, s52, 7
s_add_u32 s60, s41, s49
ds_read_b64_tr_b16 a[110:111], v13 offset:8776
v_mfma_f32_16x16x32_bf16 a[44:47], a[64:67], a[28:31], a[44:47]
s_add_u32 m0, s60, 0
s_add_u32 s61, s45, 0
v_mfma_f32_16x16x32_bf16 v[28:31], a[68:71], a[28:31], v[28:31]
buffer_load_dwordx4 v2, s[4:7], s61 offen  lds
v_mfma_f32_16x16x32_bf16 v[24:27], a[68:71], a[24:27], v[24:27]
ds_read_b64_tr_b16 a[112:113], v13 offset:8576
v_mfma_f32_16x16x32_bf16 v[20:23], a[68:71], a[20:23], v[20:23]
s_add_u32 m0, s60, 1024
s_add_u32 s61, s45, 8192
v_mfma_f32_16x16x32_bf16 v[16:19], a[68:71], a[16:19], v[16:19]
buffer_load_dwordx4 v3, s[4:7], s61 offen  lds
v_mfma_f32_16x16x32_bf16 v[32:35], a[72:75], a[16:19], v[32:35]
ds_read_b64_tr_b16 a[114:115], v13 offset:8832
v_mfma_f32_16x16x32_bf16 v[36:39], a[72:75], a[20:23], v[36:39]
s_add_u32 m0, s60, 2048
s_add_u32 s61, s45, 16384
v_mfma_f32_16x16x32_bf16 v[40:43], a[72:75], a[24:27], v[40:43]
buffer_load_dwordx4 v2, s[4:7], s61 offen  lds
v_mfma_f32_16x16x32_bf16 v[44:47], a[72:75], a[28:31], v[44:47]
s_waitcnt lgkmcnt(15)
ds_read_b64_tr_b16 a[116:117], v13 offset:8584
v_mfma_f32_16x16x32_bf16 v[60:63], a[76:79], a[28:31], v[60:63]
s_add_u32 m0, s60, 3072
s_add_u32 s61, s45, 24576
ds_read_b64_tr_b16 a[118:119], v13 offset:8840
v_mfma_f32_16x16x32_bf16 v[56:59], a[76:79], a[24:27], v[56:59]
buffer_load_dwordx4 v3, s[4:7], s61 offen  lds
v_mfma_f32_16x16x32_bf16 v[52:55], a[76:79], a[20:23], v[52:55]
ds_read_b64_tr_b16 a[120:121], v13 offset:8640
v_mfma_f32_16x16x32_bf16 v[48:51], a[76:79], a[16:19], v[48:51]
s_add_u32 m0, s60, 4096
s_add_u32 s61, s45, 32768
v_mfma_f32_16x16x32_bf16 v[64:67], a[80:83], a[16:19], v[64:67]
buffer_load_dwordx4 v2, s[4:7], s61 offen  lds
v_mfma_f32_16x16x32_bf16 v[68:71], a[80:83], a[20:23], v[68:71]
ds_read_b64_tr_b16 a[122:123], v13 offset:8896
v_mfma_f32_16x16x32_bf16 v[72:75], a[80:83], a[24:27], v[72:75]
s_add_u32 m0, s60, 5120
s_add_u32 s61, s45, 40960
v_mfma_f32_16x16x32_bf16 v[76:79], a[80:83], a[28:31], v[76:79]
s_waitcnt lgkmcnt(15)
buffer_load_dwordx4 v3, s[4:7], s61 offen  lds
v_mfma_f32_16x16x32_bf16 v[92:95], a[84:87], a[28:31], v[92:95]
ds_read_b64_tr_b16 a[124:125], v13 offset:8648
v_mfma_f32_16x16x32_bf16 v[88:91], a[84:87], a[24:27], v[88:91]
s_add_u32 m0, s60, 6144
s_add_u32 s61, s45, 49152
ds_read_b32 v14, v11
v_mfma_f32_16x16x32_bf16 v[84:87], a[84:87], a[20:23], v[84:87]
buffer_load_dwordx4 v2, s[4:7], s61 offen  lds
v_mfma_f32_16x16x32_bf16 v[80:83], a[84:87], a[16:19], v[80:83]
ds_read_b64_tr_b16 a[126:127], v13 offset:8904
v_mfma_f32_16x16x32_bf16 v[96:99], a[88:91], a[16:19], v[96:99]
s_add_u32 m0, s60, 7168
s_add_u32 s61, s45, 57344
v_add_u32 v11, 256, v11
v_mfma_f32_16x16x32_bf16 v[100:103], a[88:91], a[20:23], v[100:103]
buffer_load_dwordx4 v3, s[4:7], s61 offen  lds
v_mfma_f32_16x16x32_bf16 v[104:107], a[88:91], a[24:27], v[104:107]
s_waitcnt lgkmcnt(15)
v_mfma_f32_16x16x32_bf16 v[108:111], a[88:91], a[28:31], v[108:111]
s_xor_b32 s50, s50, 32768
v_mfma_f32_16x16x32_bf16 v[124:127], a[92:95], a[28:31], v[124:127]
s_add_u32 s48, s47, 16896
v_mfma_f32_16x16x32_bf16 v[120:123], a[92:95], a[24:27], v[120:123]
s_cmp_eq_u32 s48, 67584
v_mfma_f32_16x16x32_bf16 v[116:119], a[92:95], a[20:23], v[116:119]
s_cselect_b32 s48, 16896, s48
s_add_u32 s49, s50, 84480
v_mfma_f32_16x16x32_bf16 v[112:115], a[92:95], a[16:19], v[112:115]
s_waitcnt vmcnt(13) lgkmcnt(0)
v_mfma_f32_16x16x32_bf16 v[128:131], a[96:99], a[16:19], v[128:131]
s_barrier
v_add_u32 v12, s49, v4
v_add_u32 v13, s48, v10
v_mfma_f32_16x16x32_bf16 v[160:163], a[96:99], a[20:23], v[160:163]
ds_read_b128 a[0:3], v12 offset:0
v_mfma_f32_16x16x32_bf16 v[192:195], a[96:99], a[24:27], v[192:195]
s_add_u32 s44, s44, 1
s_and_b32 s44, s44, 15
ds_read_b128 a[4:7], v12 offset:2048
v_mfma_f32_16x16x32_bf16 v[224:227], a[96:99], a[28:31], v[224:227]
s_lshl_b32 s46, s44, 18
s_add_u32 m0, s43, s47
ds_read_b128 a[8:11], v12 offset:4096
v_mfma_f32_16x16x32_bf16 v[228:231], a[100:103], a[28:31], v[228:231]
buffer_load_dwordx4 v6, s[8:11], s46 offen offset:0  lds
v_mfma_f32_16x16x32_bf16 v[196:199], a[100:103], a[24:27], v[196:199]
ds_read_b128 a[12:15], v12 offset:6144
v_mfma_f32_16x16x32_bf16 v[164:167], a[100:103], a[20:23], v[164:167]
ds_read_b64_tr_b16 a[64:65], v13 offset:0
v_mfma_f32_16x16x32_bf16 v[132:135], a[100:103], a[16:19], v[132:135]
ds_read_b64_tr_b16 a[66:67], v13 offset:256
v_mfma_f32_16x16x32_bf16 v[136:139], a[104:107], a[16:19], v[136:139]
ds_read_b64_tr_b16 a[68:69], v13 offset:8
v_mfma_f32_16x16x32_bf16 v[168:171], a[104:107], a[20:23], v[168:171]
ds_read_b64_tr_b16 a[70:71], v13 offset:264
v_mfma_f32_16x16x32_bf16 v[200:203], a[104:107], a[24:27], v[200:203]
buffer_load_dwordx4 v7, s[8:11], s46 offen offset:1056  lds
v_mfma_f32_16x16x32_bf16 v[232:235], a[104:107], a[28:31], v[232:235]
ds_read_b64_tr_b16 a[72:73], v13 offset:64
v_mfma_f32_16x16x32_bf16 v[236:239], a[108:111], a[28:31], v[236:239]
ds_read_b64_tr_b16 a[74:75], v13 offset:320
v_mfma_f32_16x16x32_bf16 v[204:207], a[108:111], a[24:27], v[204:207]
ds_read_b64_tr_b16 a[76:77], v13 offset:72
v_mfma_f32_16x16x32_bf16 v[172:175], a[108:111], a[20:23], v[172:175]
ds_read_b64_tr_b16 a[78:79], v13 offset:328
v_mfma_f32_16x16x32_bf16 v[140:143], a[108:111], a[16:19], v[140:143]
ds_read_b64_tr_b16 a[80:81], v13 offset:128
v_mfma_f32_16x16x32_bf16 v[144:147], a[112:115], a[16:19], v[144:147]
buffer_load_dwordx4 v8, s[8:11], s46 offen offset:2112  lds
v_mfma_f32_16x16x32_bf16 v[176:179], a[112:115], a[20:23], v[176:179]
ds_read_b64_tr_b16 a[82:83], v13 offset:384
v_mfma_f32_16x16x32_bf16 v[208:211], a[112:115], a[24:27], v[208:211]
ds_read_b64_tr_b16 a[84:85], v13 offset:136
v_mfma_f32_16x16x32_bf16 v[240:243], a[112:115], a[28:31], v[240:243]
ds_read_b64_tr_b16 a[86:87], v13 offset:392
v_mfma_f32_16x16x32_bf16 v[244:247], a[116:119], a[28:31], v[244:247]
ds_read_b64_tr_b16 a[88:89], v13 offset:192
v_mfma_f32_16x16x32_bf16 v[212:215], a[116:119], a[24:27], v[212:215]
ds_read_b64_tr_b16 a[90:91], v13 offset:448
v_mfma_f32_16x16x32_bf16 v[180:183], a[116:119], a[20:23], v[180:183]
buffer_load_dwordx4 v9, s[8:11], s46 offen offset:3168  lds
v_mfma_f32_16x16x32_bf16 v[148:151], a[116:119], a[16:19], v[148:151]
ds_read_b64_tr_b16 a[92:93], v13 offset:200
v_mfma_f32_16x16x32_bf16 v[152:155], a[120:123], a[16:19], v[152:155]
ds_read_b64_tr_b16 a[94:95], v13 offset:456
v_mfma_f32_16x16x32_bf16 v[184:187], a[120:123], a[20:23], v[184:187]
ds_read_b64_tr_b16 a[96:97], v13 offset:8448
v_mfma_f32_16x16x32_bf16 v[216:219], a[120:123], a[24:27], v[216:219]
s_mov_b32 s47, s48
ds_read_b64_tr_b16 a[98:99], v13 offset:8704
v_mfma_f32_16x16x32_bf16 v[248:251], a[120:123], a[28:31], v[248:251]
ds_read_b64_tr_b16 a[100:101], v13 offset:8456
v_mfma_f32_16x16x32_bf16 v[252:255], a[124:127], a[28:31], v[252:255]
buffer_load_dword a48, v14, s[12:15], s35 offen
v_mfma_f32_16x16x32_bf16 v[220:223], a[124:127], a[24:27], v[220:223]
ds_read_b64_tr_b16 a[102:103], v13 offset:8712
v_mfma_f32_16x16x32_bf16 v[188:191], a[124:127], a[20:23], v[188:191]
ds_read_b64_tr_b16 a[104:105], v13 offset:8512
v_mfma_f32_16x16x32_bf16 v[156:159], a[124:127], a[16:19], v[156:159]
ds_read_b64_tr_b16 a[106:107], v13 offset:8768
s_mov_b32 s51, 5
LOOP_Q:
s_waitcnt lgkmcnt(15)
v_mfma_f32_16x16x32_bf16 a[32:35], a[64:67], a[0:3], a[32:35]
ds_read_b64_tr_b16 a[108:109], v13 offset:8520
v_mfma_f32_16x16x32_bf16 a[36:39], a[64:67], a[4:7], a[36:39]
v_mfma_f32_16x16x32_bf16 a[40:43], a[64:67], a[8:11], a[40:43]
s_min_u32 s63, s24, 3
s_add_u32 s24, s24, 1
ds_read_b64_tr_b16 a[110:111], v13 offset:8776
v_mfma_f32_16x16x32_bf16 a[44:47], a[64:67], a[12:15], a[44:47]
s_mul_i32 s62, s63, 1056
s_lshl_b32 s63, s63, 10
v_mfma_f32_16x16x32_bf16 v[28:31], a[68:71], a[12:15], v[28:31]
s_add_u32 s63, s63, s25
s_add_u32 s62, s62, s43
v_mfma_f32_16x16x32_bf16 v[24:27], a[68:71], a[8:11], v[24:27]
s_mov_b32 m0, s62
ds_read_b64_tr_b16 a[112:113], v13 offset:8576
v_mfma_f32_16x16x32_bf16 v[20:23], a[68:71], a[4:7], v[20:23]
buffer_load_dwordx4 v1, s[12:15], s63 offen offset:0 nt lds
v_mfma_f32_16x16x32_bf16 v[16:19], a[68:71], a[0:3], v[16:19]
v_mfma_f32_16x16x32_bf16 v[32:35], a[72:75], a[0:3], v[32:35]
ds_read_b64_tr_b16 a[114:115], v13 offset:8832
v_mfma_f32_16x16x32_bf16 v[36:39], a[72:75], a[4:7], v[36:39]
v_mfma_f32_16x16x32_bf16 v[40:43], a[72:75], a[8:11], v[40:43]
v_mfma_f32_16x16x32_bf16 v[44:47], a[72:75], a[12:15], v[44:47]
s_waitcnt lgkmcnt(15)
ds_read_b64_tr_b16 a[116:117], v13 offset:8584
v_mfma_f32_16x16x32_bf16 v[60:63], a[76:79], a[12:15], v[60:63]
ds_read_b64_tr_b16 a[118:119], v13 offset:8840
v_mfma_f32_16x16x32_bf16 v[56:59], a[76:79], a[8:11], v[56:59]
v_mfma_f32_16x16x32_bf16 v[52:55], a[76:79], a[4:7], v[52:55]
ds_read_b64_tr_b16 a[120:121], v13 offset:8640
v_mfma_f32_16x16x32_bf16 v[48:51], a[76:79], a[0:3], v[48:51]
v_mfma_f32_16x16x32_bf16 v[64:67], a[80:83], a[0:3], v[64:67]
v_mfma_f32_16x16x32_bf16 v[68:71], a[80:83], a[4:7], v[68:71]
s_add_u32 m0, s62, 67584
ds_read_b64_tr_b16 a[122:123], v13 offset:8896
v_mfma_f32_16x16x32_bf16 v[72:75], a[80:83], a[8:11], v[72:75]
s_waitcnt lgkmcnt(15)
buffer_load_dwordx4 v1, s[16:19], s63 offen offset:0 nt lds
v_mfma_f32_16x16x32_bf16 v[76:79], a[80:83], a[12:15], v[76:79]
v_mfma_f32_16x16x32_bf16 v[92:95], a[84:87], a[12:15], v[92:95]
ds_read_b64_tr_b16 a[124:125], v13 offset:8648
v_mfma_f32_16x16x32_bf16 v[88:91], a[84:87], a[8:11], v[88:91]
ds_read_b32 v14, v11
v_mfma_f32_16x16x32_bf16 v[84:87], a[84:87], a[4:7], v[84:87]
v_mfma_f32_16x16x32_bf16 v[80:83], a[84:87], a[0:3], v[80:83]
ds_read_b64_tr_b16 a[126:127], v13 offset:8904
v_mfma_f32_16x16x32_bf16 v[96:99], a[88:91], a[0:3], v[96:99]
v_add_u32 v11, 256, v11
v_mfma_f32_16x16x32_bf16 v[100:103], a[88:91], a[4:7], v[100:103]
v_mfma_f32_16x16x32_bf16 v[104:107], a[88:91], a[8:11], v[104:107]
s_waitcnt lgkmcnt(15)
v_mfma_f32_16x16x32_bf16 v[108:111], a[88:91], a[12:15], v[108:111]
v_mfma_f32_16x16x32_bf16 v[124:127], a[92:95], a[12:15], v[124:127]
s_add_u32 s48, s47, 16896
v_mfma_f32_16x16x32_bf16 v[120:123], a[92:95], a[8:11], v[120:123]
s_cmp_eq_u32 s48, 67584
v_mfma_f32_16x16x32_bf16 v[116:119], a[92:95], a[4:7], v[116:119]
s_cselect_b32 s48, 16896, s48
v_mfma_f32_16x16x32_bf16 v[112:115], a[92:95], a[0:3], v[112:115]
s_waitcnt vmcnt(16) lgkmcnt(0)
v_mfma_f32_16x16x32_bf16 v[128:131], a[96:99], a[0:3], v[128:131]
s_barrier
v_add_u32 v12, s49, v5
v_add_u32 v13, s48, v10
v_mfma_f32_16x16x32_bf16 v[160:163], a[96:99], a[4:7], v[160:163]
ds_read_b128 a[16:19], v12 offset:0
v_mfma_f32_16x16x32_bf16 v[192:195], a[96:99], a[8:11], v[192:195]
s_add_u32 s44, s44, 1
s_and_b32 s44, s44, 15
ds_read_b128 a[20:23], v12 offset:2048
v_mfma_f32_16x16x32_bf16 v[224:227], a[96:99], a[12:15], v[224:227]
s_lshl_b32 s46, s44, 18
s_add_u32 m0, s43, s47
ds_read_b128 a[24:27], v12 offset:4096
v_mfma_f32_16x16x32_bf16 v[228:231], a[100:103], a[12:15], v[228:231]
buffer_load_dwordx4 v6, s[8:11], s46 offen offset:0  lds
v_mfma_f32_16x16x32_bf16 v[196:199], a[100:103], a[8:11], v[196:199]
ds_read_b128 a[28:31], v12 offset:6144
v_mfma_f32_16x16x32_bf16 v[164:167], a[100:103], a[4:7], v[164:167]
ds_read_b64_tr_b16 a[64:65], v13 offset:0
v_mfma_f32_16x16x32_bf16 v[132:135], a[100:103], a[0:3], v[132:135]
ds_read_b64_tr_b16 a[66:67], v13 offset:256
v_mfma_f32_16x16x32_bf16 v[136:139], a[104:107], a[0:3], v[136:139]
ds_read_b64_tr_b16 a[68:69], v13 offset:8
v_mfma_f32_16x16x32_bf16 v[168:171], a[104:107], a[4:7], v[168:171]
ds_read_b64_tr_b16 a[70:71], v13 offset:264
v_mfma_f32_16x16x32_bf16 v[200:203], a[104:107], a[8:11], v[200:203]
buffer_load_dwordx4 v7, s[8:11], s46 offen offset:1056  lds
v_mfma_f32_16x16x32_bf16 v[232:235], a[104:107], a[12:15], v[232:235]
ds_read_b64_tr_b16 a[72:73], v13 offset:64
v_mfma_f32_16x16x32_bf16 v[236:239], a[108:111], a[12:15], v[236:239]
ds_read_b64_tr_b16 a[74:75], v13 offset:320
v_mfma_f32_16x16x32_bf16 v[204:207], a[108:111], a[8:11], v[204:207]
ds_read_b64_tr_b16 a[76:77], v13 offset:72
v_mfma_f32_16x16x32_bf16 v[172:175], a[108:111], a[4:7], v[172:175]
ds_read_b64_tr_b16 a[78:79], v13 offset:328
v_mfma_f32_16x16x32_bf16 v[140:143], a[108:111], a[0:3], v[140:143]
ds_read_b64_tr_b16 a[80:81], v13 offset:128
v_mfma_f32_16x16x32_bf16 v[144:147], a[112:115], a[0:3], v[144:147]
buffer_load_dwordx4 v8, s[8:11], s46 offen offset:2112  lds
v_mfma_f32_16x16x32_bf16 v[176:179], a[112:115], a[4:7], v[176:179]
ds_read_b64_tr_b16 a[82:83], v13 offset:384
v_mfma_f32_16x16x32_bf16 v[208:211], a[112:115], a[8:11], v[208:211]
ds_read_b64_tr_b16 a[84:85], v13 offset:136
v_mfma_f32_16x16x32_bf16 v[240:243], a[112:115], a[12:15], v[240:243]
ds_read_b64_tr_b16 a[86:87], v13 offset:392
v_mfma_f32_16x16x32_bf16 v[244:247], a[116:119], a[12:15], v[244:247]
ds_read_b64_tr_b16 a[88:89], v13 offset:192
v_mfma_f32_16x16x32_bf16 v[212:215], a[116:119], a[8:11], v[212:215]
ds_read_b64_tr_b16 a[90:91], v13 offset:448
v_mfma_f32_16x16x32_bf16 v[180:183], a[116:119], a[4:7], v[180:183]
buffer_load_dwordx4 v9, s[8:11], s46 offen offset:3168  lds
v_mfma_f32_16x16x32_bf16 v[148:151], a[116:119], a[0:3], v[148:151]
ds_read_b64_tr_b16 a[92:93], v13 offset:200
v_mfma_f32_16x16x32_bf16 v[152:155], a[120:123], a[0:3], v[152:155]
ds_read_b64_tr_b16 a[94:95], v13 offset:456
v_mfma_f32_16x16x32_bf16 v[184:187], a[120:123], a[4:7], v[184:187]
ds_read_b64_tr_b16 a[96:97], v13 offset:8448
v_mfma_f32_16x16x32_bf16 v[216:219], a[120:123], a[8:11], v[216:219]
s_mov_b32 s47, s48
ds_read_b64_tr_b16 a[98:99], v13 offset:8704
v_mfma_f32_16x16x32_bf16 v[248:251], a[120:123], a[12:15], v[248:251]
ds_read_b64_tr_b16 a[100:101], v13 offset:8456
v_mfma_f32_16x16x32_bf16 v[252:255], a[124:127], a[12:15], v[252:255]
buffer_load_dword a48, v14, s[12:15], s35 offen
v_mfma_f32_16x16x32_bf16 v[220:223], a[124:127], a[8:11], v[220:223]
ds_read_b64_tr_b16 a[102:103], v13 offset:8712
v_mfma_f32_16x16x32_bf16 v[188:191], a[124:127], a[4:7], v[188:191]
ds_read_b64_tr_b16 a[104:105], v13 offset:8512
v_mfma_f32_16x16x32_bf16 v[156:159], a[124:127], a[0:3], v[156:159]
ds_read_b64_tr_b16 a[106:107], v13 offset:8768
s_waitcnt lgkmcnt(15)
v_mfma_f32_16x16x32_bf16 a[32:35], a[64:67], a[16:19], a[32:35]
ds_read_b64_tr_b16 a[108:109], v13 offset:8520
v_mfma_f32_16x16x32_bf16 a[36:39], a[64:67], a[20:23], a[36:39]
s_add_u32 s52, s52, 1
s_and_b32 s52, s52, 7
v_mfma_f32_16x16x32_bf16 a[40:43], a[64:67], a[24:27], a[40:43]
s_lshl_b32 s45, s52, 7
s_add_u32 s60, s41, s49
ds_read_b64_tr_b16 a[110:111], v13 offset:8776
v_mfma_f32_16x16x32_bf16 a[44:47], a[64:67], a[28:31], a[44:47]
s_add_u32 m0, s60, 0
s_add_u32 s61, s45, 0
v_mfma_f32_16x16x32_bf16 v[28:31], a[68:71], a[28:31], v[28:31]
buffer_load_dwordx4 v2, s[4:7], s61 offen  lds
v_mfma_f32_16x16x32_bf16 v[24:27], a[68:71], a[24:27], v[24:27]
ds_read_b64_tr_b16 a[112:113], v13 offset:8576
v_mfma_f32_16x16x32_bf16 v[20:23], a[68:71], a[20:23], v[20:23]
s_add_u32 m0, s60, 1024
s_add_u32 s61, s45, 8192
v_mfma_f32_16x16x32_bf16 v[16:19], a[68:71], a[16:19], v[16:19]
buffer_load_dwordx4 v3, s[4:7], s61 offen  lds
v_mfma_f32_16x16x32_bf16 v[32:35], a[72:75], a[16:19], v[32:35]
ds_read_b64_tr_b16 a[114:115], v13 offset:8832
v_mfma_f32_16x16x32_bf16 v[36:39], a[72:75], a[20:23], v[36:39]
s_add_u32 m0, s60, 2048
s_add_u32 s61, s45, 16384
v_mfma_f32_16x16x32_bf16 v[40:43], a[72:75], a[24:27], v[40:43]
buffer_load_dwordx4 v2, s[4:7], s61 offen  lds
v_mfma_f32_16x16x32_bf16 v[44:47], a[72:75], a[28:31], v[44:47]
s_waitcnt lgkmcnt(15)
ds_read_b64_tr_b16 a[116:117], v13 offset:8584
v_mfma_f32_16x16x32_bf16 v[60:63], a[76:79], a[28:31], v[60:63]
s_add_u32 m0, s60, 3072
s_add_u32 s61, s45, 24576
ds_read_b64_tr_b16 a[118:119], v13 offset:8840
v_mfma_f32_16x16x32_bf16 v[56:59], a[76:79], a[24:27], v[56:59]
buffer_load_dwordx4 v3, s[4:7], s61 offen  lds
v_mfma_f32_16x16x32_bf16 v[52:55], a[76:79], a[20:23], v[52:55]
ds_read_b64_tr_b16 a[120:121], v13 offset:8640
v_mfma_f32_16x16x32_bf16 v[48:51], a[76:79], a[16:19], v[48:51]
s_add_u32 m0, s60, 4096
s_add_u32 s61, s45, 32768
v_mfma_f32_16x16x32_bf16 v[64:67], a[80:83], a[16:19], v[64:67]
buffer_load_dwordx4 v2, s[4:7], s61 offen  lds
v_mfma_f32_16x16x32_bf16 v[68:71], a[80:83], a[20:23], v[68:71]
ds_read_b64_tr_b16 a[122:123], v13 offset:8896
v_mfma_f32_16x16x32_bf16 v[72:75], a[80:83], a[24:27], v[72:75]
s_add_u32 m0, s60, 5120
s_add_u32 s61, s45, 40960
v_mfma_f32_16x16x32_bf16 v[76:79], a[80:83], a[28:31], v[76:79]
s_waitcnt lgkmcnt(15)
buffer_load_dwordx4 v3, s[4:7], s61 offen  lds
v_mfma_f32_16x16x32_bf16 v[92:95], a[84:87], a[28:31], v[92:95]
ds_read_b64_tr_b16 a[124:125], v13 offset:8648
v_mfma_f32_16x16x32_bf16 v[88:91], a[84:87], a[24:27], v[88:91]
s_add_u32 m0, s60, 6144
s_add_u32 s61, s45, 49152
ds_read_b32 v14, v11
v_mfma_f32_16x16x32_bf16 v[84:87], a[84:87], a[20:23], v[84:87]
buffer_load_dwordx4 v2, s[4:7], s61 offen  lds
v_mfma_f32_16x16x32_bf16 v[80:83], a[84:87], a[16:19], v[80:83]
ds_read_b64_tr_b16 a[126:127], v13 offset:8904
v_mfma_f32_16x16x32_bf16 v[96:99], a[88:91], a[16:19], v[96:99]
s_add_u32 m0, s60, 7168
s_add_u32 s61, s45, 57344
v_add_u32 v11, 256, v11
v_mfma_f32_16x16x32_bf16 v[100:103], a[88:91], a[20:23], v[100:103]
buffer_load_dwordx4 v3, s[4:7], s61 offen  lds
v_mfma_f32_16x16x32_bf16 v[104:107], a[88:91], a[24:27], v[104:107]
s_waitcnt lgkmcnt(15)
v_mfma_f32_16x16x32_bf16 v[108:111], a[88:91], a[28:31], v[108:111]
s_xor_b32 s50, s50, 32768
v_mfma_f32_16x16x32_bf16 v[124:127], a[92:95], a[28:31], v[124:127]
s_add_u32 s48, s47, 16896
v_mfma_f32_16x16x32_bf16 v[120:123], a[92:95], a[24:27], v[120:123]
s_cmp_eq_u32 s48, 67584
v_mfma_f32_16x16x32_bf16 v[116:119], a[92:95], a[20:23], v[116:119]
s_cselect_b32 s48, 16896, s48
s_add_u32 s49, s50, 84480
v_mfma_f32_16x16x32_bf16 v[112:115], a[92:95], a[16:19], v[112:115]
s_waitcnt vmcnt(16) lgkmcnt(0)
v_mfma_f32_16x16x32_bf16 v[128:131], a[96:99], a[16:19], v[128:131]
s_barrier
v_add_u32 v12, s49, v4
v_add_u32 v13, s48, v10
v_mfma_f32_16x16x32_bf16 v[160:163], a[96:99], a[20:23], v[160:163]
ds_read_b128 a[0:3], v12 offset:0
v_mfma_f32_16x16x32_bf16 v[192:195], a[96:99], a[24:27], v[192:195]
s_add_u32 s44, s44, 1
s_and_b32 s44, s44, 15
ds_read_b128 a[4:7], v12 offset:2048
v_mfma_f32_16x16x32_bf16 v[224:227], a[96:99], a[28:31], v[224:227]
s_lshl_b32 s46, s44, 18
s_add_u32 m0, s43, s47
ds_read_b128 a[8:11], v12 offset:4096
v_mfma_f32_16x16x32_bf16 v[228:231], a[100:103], a[28:31], v[228:231]
buffer_load_dwordx4 v6, s[8:11], s46 offen offset:0  lds
v_mfma_f32_16x16x32_bf16 v[196:199], a[100:103], a[24:27], v[196:199]
ds_read_b128 a[12:15], v12 offset:6144
v_mfma_f32_16x16x32_bf16 v[164:167], a[100:103], a[20:23], v[164:167]
ds_read_b64_tr_b16 a[64:65], v13 offset:0
v_mfma_f32_16x16x32_bf16 v[132:135], a[100:103], a[16:19], v[132:135]
ds_read_b64_tr_b16 a[66:67], v13 offset:256
v_mfma_f32_16x16x32_bf16 v[136:139], a[104:107], a[16:19], v[136:139]
ds_read_b64_tr_b16 a[68:69], v13 offset:8
v_mfma_f32_16x16x32_bf16 v[168:171], a[104:107], a[20:23], v[168:171]
ds_read_b64_tr_b16 a[70:71], v13 offset:264
v_mfma_f32_16x16x32_bf16 v[200:203], a[104:107], a[24:27], v[200:203]
buffer_load_dwordx4 v7, s[8:11], s46 offen offset:1056  lds
v_mfma_f32_16x16x32_bf16 v[232:235], a[104:107], a[28:31], v[232:235]
ds_read_b64_tr_b16 a[72:73], v13 offset:64
v_mfma_f32_16x16x32_bf16 v[236:239], a[108:111], a[28:31], v[236:239]
ds_read_b64_tr_b16 a[74:75], v13 offset:320
v_mfma_f32_16x16x32_bf16 v[204:207], a[108:111], a[24:27], v[204:207]
ds_read_b64_tr_b16 a[76:77], v13 offset:72
v_mfma_f32_16x16x32_bf16 v[172:175], a[108:111], a[20:23], v[172:175]
ds_read_b64_tr_b16 a[78:79], v13 offset:328
v_mfma_f32_16x16x32_bf16 v[140:143], a[108:111], a[16:19], v[140:143]
ds_read_b64_tr_b16 a[80:81], v13 offset:128
v_mfma_f32_16x16x32_bf16 v[144:147], a[112:115], a[16:19], v[144:147]
buffer_load_dwordx4 v8, s[8:11], s46 offen offset:2112  lds
v_mfma_f32_16x16x32_bf16 v[176:179], a[112:115], a[20:23], v[176:179]
ds_read_b64_tr_b16 a[82:83], v13 offset:384
v_mfma_f32_16x16x32_bf16 v[208:211], a[112:115], a[24:27], v[208:211]
ds_read_b64_tr_b16 a[84:85], v13 offset:136
v_mfma_f32_16x16x32_bf16 v[240:243], a[112:115], a[28:31], v[240:243]
ds_read_b64_tr_b16 a[86:87], v13 offset:392
v_mfma_f32_16x16x32_bf16 v[244:247], a[116:119], a[28:31], v[244:247]
ds_read_b64_tr_b16 a[88:89], v13 offset:192
v_mfma_f32_16x16x32_bf16 v[212:215], a[116:119], a[24:27], v[212:215]
ds_read_b64_tr_b16 a[90:91], v13 offset:448
v_mfma_f32_16x16x32_bf16 v[180:183], a[116:119], a[20:23], v[180:183]
buffer_load_dwordx4 v9, s[8:11], s46 offen offset:3168  lds
v_mfma_f32_16x16x32_bf16 v[148:151], a[116:119], a[16:19], v[148:151]
ds_read_b64_tr_b16 a[92:93], v13 offset:200
v_mfma_f32_16x16x32_bf16 v[152:155], a[120:123], a[16:19], v[152:155]
ds_read_b64_tr_b16 a[94:95], v13 offset:456
v_mfma_f32_16x16x32_bf16 v[184:187], a[120:123], a[20:23], v[184:187]
ds_read_b64_tr_b16 a[96:97], v13 offset:8448
v_mfma_f32_16x16x32_bf16 v[216:219], a[120:123], a[24:27], v[216:219]
s_mov_b32 s47, s48
ds_read_b64_tr_b16 a[98:99], v13 offset:8704
v_mfma_f32_16x16x32_bf16 v[248:251], a[120:123], a[28:31], v[248:251]
ds_read_b64_tr_b16 a[100:101], v13 offset:8456
v_mfma_f32_16x16x32_bf16 v[252:255], a[124:127], a[28:31], v[252:255]
buffer_load_dword a48, v14, s[12:15], s35 offen
v_mfma_f32_16x16x32_bf16 v[220:223], a[124:127], a[24:27], v[220:223]
ds_read_b64_tr_b16 a[102:103], v13 offset:8712
v_mfma_f32_16x16x32_bf16 v[188:191], a[124:127], a[20:23], v[188:191]
s_sub_u32 s51, s51, 1
ds_read_b64_tr_b16 a[104:105], v13 offset:8512
v_mfma_f32_16x16x32_bf16 v[156:159], a[124:127], a[16:19], v[156:159]
s_cmp_lg_u32 s51, 0
ds_read_b64_tr_b16 a[106:107], v13 offset:8768
s_cbranch_scc1 LOOP_Q
s_waitcnt lgkmcnt(15)
v_mfma_f32_16x16x32_bf16 a[32:35], a[64:67], a[0:3], a[32:35]
ds_read_b64_tr_b16 a[108:109], v13 offset:8520
v_mfma_f32_16x16x32_bf16 a[36:39], a[64:67], a[4:7], a[36:39]
v_mfma_f32_16x16x32_bf16 a[40:43], a[64:67], a[8:11], a[40:43]
ds_read_b64_tr_b16 a[110:111], v13 offset:8776
v_mfma_f32_16x16x32_bf16 a[44:47], a[64:67], a[12:15], a[44:47]
v_mfma_f32_16x16x32_bf16 v[28:31], a[68:71], a[12:15], v[28:31]
v_mfma_f32_16x16x32_bf16 v[24:27], a[68:71], a[8:11], v[24:27]
ds_read_b64_tr_b16 a[112:113], v13 offset:8576
v_mfma_f32_16x16x32_bf16 v[20:23], a[68:71], a[4:7], v[20:23]
v_mfma_f32_16x16x32_bf16 v[16:19], a[68:71], a[0:3], v[16:19]
v_mfma_f32_16x16x32_bf16 v[32:35], a[72:75], a[0:3], v[32:35]
ds_read_b64_tr_b16 a[114:115], v13 offset:8832
v_mfma_f32_16x16x32_bf16 v[36:39], a[72:75], a[4:7], v[36:39]
v_mfma_f32_16x16x32_bf16 v[40:43], a[72:75], a[8:11], v[40:43]
v_mfma_f32_16x16x32_bf16 v[44:47], a[72:75], a[12:15], v[44:47]
s_waitcnt lgkmcnt(15)
ds_read_b64_tr_b16 a[116:117], v13 offset:8584
v_mfma_f32_16x16x32_bf16 v[60:63], a[76:79], a[12:15], v[60:63]
ds_read_b64_tr_b16 a[118:119], v13 offset:8840
v_mfma_f32_16x16x32_bf16 v[56:59], a[76:79], a[8:11], v[56:59]
v_mfma_f32_16x16x32_bf16 v[52:55], a[76:79], a[4:7], v[52:55]
ds_read_b64_tr_b16 a[120:121], v13 offset:8640
v_mfma_f32_16x16x32_bf16 v[48:51], a[76:79], a[0:3], v[48:51]
v_mfma_f32_16x16x32_bf16 v[64:67], a[80:83], a[0:3], v[64:67]
v_mfma_f32_16x16x32_bf16 v[68:71], a[80:83], a[4:7], v[68:71]
ds_read_b64_tr_b16 a[122:123], v13 offset:8896
v_mfma_f32_16x16x32_bf16 v[72:75], a[80:83], a[8:11], v[72:75]
s_waitcnt lgkmcnt(15)
v_mfma_f32_16x16x32_bf16 v[76:79], a[80:83], a[12:15], v[76:79]
v_mfma_f32_16x16x32_bf16 v[92:95], a[84:87], a[12:15], v[92:95]
ds_read_b64_tr_b16 a[124:125], v13 offset:8648
v_mfma_f32_16x16x32_bf16 v[88:91], a[84:87], a[8:11], v[88:91]
v_mfma_f32_16x16x32_bf16 v[84:87], a[84:87], a[4:7], v[84:87]
v_mfma_f32_16x16x32_bf16 v[80:83], a[84:87], a[0:3], v[80:83]
ds_read_b64_tr_b16 a[126:127], v13 offset:8904
v_mfma_f32_16x16x32_bf16 v[96:99], a[88:91], a[0:3], v[96:99]
v_mfma_f32_16x16x32_bf16 v[100:103], a[88:91], a[4:7], v[100:103]
v_mfma_f32_16x16x32_bf16 v[104:107], a[88:91], a[8:11], v[104:107]
s_waitcnt lgkmcnt(15)
v_mfma_f32_16x16x32_bf16 v[108:111], a[88:91], a[12:15], v[108:111]
v_mfma_f32_16x16x32_bf16 v[124:127], a[92:95], a[12:15], v[124:127]
s_add_u32 s48, s47, 16896
v_mfma_f32_16x16x32_bf16 v[120:123], a[92:95], a[8:11], v[120:123]
s_cmp_eq_u32 s48, 67584
v_mfma_f32_16x16x32_bf16 v[116:119], a[92:95], a[4:7], v[116:119]
s_cselect_b32 s48, 16896, s48
v_mfma_f32_16x16x32_bf16 v[112:115], a[92:95], a[0:3], v[112:115]
s_waitcnt vmcnt(14) lgkmcnt(0)
v_mfma_f32_16x16x32_bf16 v[128:131], a[96:99], a[0:3], v[128:131]
s_barrier
v_add_u32 v12, s49, v5
v_add_u32 v13, s48, v10
v_mfma_f32_16x16x32_bf16 v[160:163], a[96:99], a[4:7], v[160:163]
ds_read_b128 a[16:19], v12 offset:0
v_mfma_f32_16x16x32_bf16 v[192:195], a[96:99], a[8:11], v[192:195]
s_add_u32 s44, s44, 1
s_and_b32 s44, s44, 15
ds_read_b128 a[20:23], v12 offset:2048
v_mfma_f32_16x16x32_bf16 v[224:227], a[96:99], a[12:15], v[224:227]
s_lshl_b32 s46, s44, 18
s_add_u32 m0, s43, s47
ds_read_b128 a[24:27], v12 offset:4096
v_mfma_f32_16x16x32_bf16 v[228:231], a[100:103], a[12:15], v[228:231]
buffer_load_dwordx4 v6, s[8:11], s46 offen offset:0  lds
v_mfma_f32_16x16x32_bf16 v[196:199], a[100:103], a[8:11], v[196:199]
ds_read_b128 a[28:31], v12 offset:6144
v_mfma_f32_16x16x32_bf16 v[164:167], a[100:103], a[4:7], v[164:167]
ds_read_b64_tr_b16 a[64:65], v13 offset:0
v_mfma_f32_16x16x32_bf16 v[132:135], a[100:103], a[0:3], v[132:135]
ds_read_b64_tr_b16 a[66:67], v13 offset:256
v_mfma_f32_16x16x32_bf16 v[136:139], a[104:107], a[0:3], v[136:139]
ds_read_b64_tr_b16 a[68:69], v13 offset:8
v_mfma_f32_16x16x32_bf16 v[168:171], a[104:107], a[4:7], v[168:171]
ds_read_b64_tr_b16 a[70:71], v13 offset:264
v_mfma_f32_16x16x32_bf16 v[200:203], a[104:107], a[8:11], v[200:203]
buffer_load_dwordx4 v7, s[8:11], s46 offen offset:1056  lds
v_mfma_f32_16x16x32_bf16 v[232:235], a[104:107], a[12:15], v[232:235]
ds_read_b64_tr_b16 a[72:73], v13 offset:64
v_mfma_f32_16x16x32_bf16 v[236:239], a[108:111], a[12:15], v[236:239]
ds_read_b64_tr_b16 a[74:75], v13 offset:320
v_mfma_f32_16x16x32_bf16 v[204:207], a[108:111], a[8:11], v[204:207]
ds_read_b64_tr_b16 a[76:77], v13 offset:72
v_mfma_f32_16x16x32_bf16 v[172:175], a[108:111], a[4:7], v[172:175]
ds_read_b64_tr_b16 a[78:79], v13 offset:328
v_mfma_f32_16x16x32_bf16 v[140:143], a[108:111], a[0:3], v[140:143]
ds_read_b64_tr_b16 a[80:81], v13 offset:128
v_mfma_f32_16x16x32_bf16 v[144:147], a[112:115], a[0:3], v[144:147]
buffer_load_dwordx4 v8, s[8:11], s46 offen offset:2112  lds
v_mfma_f32_16x16x32_bf16 v[176:179], a[112:115], a[4:7], v[176:179]
ds_read_b64_tr_b16 a[82:83], v13 offset:384
v_mfma_f32_16x16x32_bf16 v[208:211], a[112:115], a[8:11], v[208:211]
ds_read_b64_tr_b16 a[84:85], v13 offset:136
v_mfma_f32_16x16x32_bf16 v[240:243], a[112:115], a[12:15], v[240:243]
ds_read_b64_tr_b16 a[86:87], v13 offset:392
v_mfma_f32_16x16x32_bf16 v[244:247], a[116:119], a[12:15], v[244:247]
ds_read_b64_tr_b16 a[88:89], v13 offset:192
v_mfma_f32_16x16x32_bf16 v[212:215], a[116:119], a[8:11], v[212:215]
ds_read_b64_tr_b16 a[90:91], v13 offset:448
v_mfma_f32_16x16x32_bf16 v[180:183], a[116:119], a[4:7], v[180:183]
buffer_load_dwordx4 v9, s[8:11], s46 offen offset:3168  lds
v_mfma_f32_16x16x32_bf16 v[148:151], a[116:119], a[0:3], v[148:151]
ds_read_b64_tr_b16 a[92:93], v13 offset:200
v_mfma_f32_16x16x32_bf16 v[152:155], a[120:123], a[0:3], v[152:155]
ds_read_b64_tr_b16 a[94:95], v13 offset:456
v_mfma_f32_16x16x32_bf16 v[184:187], a[120:123], a[4:7], v[184:187]
ds_read_b64_tr_b16 a[96:97], v13 offset:8448
v_mfma_f32_16x16x32_bf16 v[216:219], a[120:123], a[8:11], v[216:219]
s_mov_b32 s47, s48
ds_read_b64_tr_b16 a[98:99], v13 offset:8704
v_mfma_f32_16x16x32_bf16 v[248:251], a[120:123], a[12:15], v[248:251]
ds_read_b64_tr_b16 a[100:101], v13 offset:8456
v_mfma_f32_16x16x32_bf16 v[252:255], a[124:127], a[12:15], v[252:255]
v_mfma_f32_16x16x32_bf16 v[220:223], a[124:127], a[8:11], v[220:223]
ds_read_b64_tr_b16 a[102:103], v13 offset:8712
v_mfma_f32_16x16x32_bf16 v[188:191], a[124:127], a[4:7], v[188:191]
ds_read_b64_tr_b16 a[104:105], v13 offset:8512
v_mfma_f32_16x16x32_bf16 v[156:159], a[124:127], a[0:3], v[156:159]
ds_read_b64_tr_b16 a[106:107], v13 offset:8768
s_waitcnt lgkmcnt(15)
v_mfma_f32_16x16x32_bf16 a[32:35], a[64:67], a[16:19], a[32:35]
ds_read_b64_tr_b16 a[108:109], v13 offset:8520
v_mfma_f32_16x16x32_bf16 a[36:39], a[64:67], a[20:23], a[36:39]
v_mfma_f32_16x16x32_bf16 a[40:43], a[64:67], a[24:27], a[40:43]
ds_read_b64_tr_b16 a[110:111], v13 offset:8776
v_mfma_f32_16x16x32_bf16 a[44:47], a[64:67], a[28:31], a[44:47]
v_mfma_f32_16x16x32_bf16 v[28:31], a[68:71], a[28:31], v[28:31]
v_mfma_f32_16x16x32_bf16 v[24:27], a[68:71], a[24:27], v[24:27]
ds_read_b64_tr_b16 a[112:113], v13 offset:8576
v_mfma_f32_16x16x32_bf16 v[20:23], a[68:71], a[20:23], v[20:23]
v_mfma_f32_16x16x32_bf16 v[16:19], a[68:71], a[16:19], v[16:19]
v_mfma_f32_16x16x32_bf16 v[32:35], a[72:75], a[16:19], v[32:35]
ds_read_b64_tr_b16 a[114:115], v13 offset:8832
v_mfma_f32_16x16x32_bf16 v[36:39], a[72:75], a[20:23], v[36:39]
v_mfma_f32_16x16x32_bf16 v[40:43], a[72:75], a[24:27], v[40:43]
v_mfma_f32_16x16x32_bf16 v[44:47], a[72:75], a[28:31], v[44:47]
s_waitcnt lgkmcnt(15)
ds_read_b64_tr_b16 a[116:117], v13 offset:8584
v_mfma_f32_16x16x32_bf16 v[60:63], a[76:79], a[28:31], v[60:63]
ds_read_b64_tr_b16 a[118:119], v13 offset:8840
v_mfma_f32_16x16x32_bf16 v[56:59], a[76:79], a[24:27], v[56:59]
v_mfma_f32_16x16x32_bf16 v[52:55], a[76:79], a[20:23], v[52:55]
ds_read_b64_tr_b16 a[120:121], v13 offset:8640
v_mfma_f32_16x16x32_bf16 v[48:51], a[76:79], a[16:19], v[48:51]
v_mfma_f32_16x16x32_bf16 v[64:67], a[80:83], a[16:19], v[64:67]
v_mfma_f32_16x16x32_bf16 v[68:71], a[80:83], a[20:23], v[68:71]
ds_read_b64_tr_b16 a[122:123], v13 offset:8896
v_mfma_f32_16x16x32_bf16 v[72:75], a[80:83], a[24:27], v[72:75]
s_waitcnt lgkmcnt(15)
v_mfma_f32_16x16x32_bf16 v[76:79], a[80:83], a[28:31], v[76:79]
v_mfma_f32_16x16x32_bf16 v[92:95], a[84:87], a[28:31], v[92:95]
ds_read_b64_tr_b16 a[124:125], v13 offset:8648
v_mfma_f32_16x16x32_bf16 v[88:91], a[84:87], a[24:27], v[88:91]
v_mfma_f32_16x16x32_bf16 v[84:87], a[84:87], a[20:23], v[84:87]
v_mfma_f32_16x16x32_bf16 v[80:83], a[84:87], a[16:19], v[80:83]
ds_read_b64_tr_b16 a[126:127], v13 offset:8904
v_mfma_f32_16x16x32_bf16 v[96:99], a[88:91], a[16:19], v[96:99]
v_mfma_f32_16x16x32_bf16 v[100:103], a[88:91], a[20:23], v[100:103]
v_mfma_f32_16x16x32_bf16 v[104:107], a[88:91], a[24:27], v[104:107]
s_waitcnt lgkmcnt(15)
v_mfma_f32_16x16x32_bf16 v[108:111], a[88:91], a[28:31], v[108:111]
s_xor_b32 s50, s50, 32768
v_mfma_f32_16x16x32_bf16 v[124:127], a[92:95], a[28:31], v[124:127]
s_add_u32 s48, s47, 16896
v_mfma_f32_16x16x32_bf16 v[120:123], a[92:95], a[24:27], v[120:123]
s_cmp_eq_u32 s48, 67584
v_mfma_f32_16x16x32_bf16 v[116:119], a[92:95], a[20:23], v[116:119]
s_cselect_b32 s48, 16896, s48
s_add_u32 s49, s50, 84480
v_mfma_f32_16x16x32_bf16 v[112:115], a[92:95], a[16:19], v[112:115]
s_waitcnt vmcnt(5) lgkmcnt(0)
v_mfma_f32_16x16x32_bf16 v[128:131], a[96:99], a[16:19], v[128:131]
s_barrier
v_add_u32 v12, s49, v4
v_add_u32 v13, s48, v10
v_mfma_f32_16x16x32_bf16 v[160:163], a[96:99], a[20:23], v[160:163]
s_add_u32 s61, s53, 1
s_and_b32 s61, s61, 15
ds_read_b128 a[0:3], v12 offset:0
v_mfma_f32_16x16x32_bf16 v[192:195], a[96:99], a[24:27], v[192:195]
s_lshl_b32 s61, s61, 14
s_add_u32 s61, s61, s35
ds_read_b128 a[4:7], v12 offset:2048
v_mfma_f32_16x16x32_bf16 v[224:227], a[96:99], a[28:31], v[224:227]
s_add_u32 m0, s43, 16896
ds_read_b128 a[8:11], v12 offset:4096
v_mfma_f32_16x16x32_bf16 v[228:231], a[100:103], a[28:31], v[228:231]
buffer_load_dwordx4 v1, s[12:15], s61 offen offset:0 nt lds
v_mfma_f32_16x16x32_bf16 v[196:199], a[100:103], a[24:27], v[196:199]
ds_read_b128 a[12:15], v12 offset:6144
v_mfma_f32_16x16x32_bf16 v[164:167], a[100:103], a[20:23], v[164:167]
ds_read_b64_tr_b16 a[64:65], v13 offset:0
v_mfma_f32_16x16x32_bf16 v[132:135], a[100:103], a[16:19], v[132:135]
ds_read_b64_tr_b16 a[66:67], v13 offset:256
v_mfma_f32_16x16x32_bf16 v[136:139], a[104:107], a[16:19], v[136:139]
ds_read_b64_tr_b16 a[68:69], v13 offset:8
v_mfma_f32_16x16x32_bf16 v[168:171], a[104:107], a[20:23], v[168:171]
ds_read_b64_tr_b16 a[70:71], v13 offset:264
v_mfma_f32_16x16x32_bf16 v[200:203], a[104:107], a[24:27], v[200:203]
s_add_u32 m0, s43, 16928
v_mfma_f32_16x16x32_bf16 v[232:235], a[104:107], a[28:31], v[232:235]
ds_read_b64_tr_b16 a[72:73], v13 offset:64
buffer_load_dwordx4 v1, s[12:15], s61 offen offset:1024 nt lds
v_mfma_f32_16x16x32_bf16 v[236:239], a[108:111], a[28:31], v[236:239]
ds_read_b64_tr_b16 a[74:75], v13 offset:320
v_mfma_f32_16x16x32_bf16 v[204:207], a[108:111], a[24:27], v[204:207]
ds_read_b64_tr_b16 a[76:77], v13 offset:72
v_mfma_f32_16x16x32_bf16 v[172:175], a[108:111], a[20:23], v[172:175]
ds_read_b64_tr_b16 a[78:79], v13 offset:328
v_mfma_f32_16x16x32_bf16 v[140:143], a[108:111], a[16:19], v[140:143]
ds_read_b64_tr_b16 a[80:81], v13 offset:128
v_mfma_f32_16x16x32_bf16 v[144:147], a[112:115], a[16:19], v[144:147]
v_mfma_f32_16x16x32_bf16 v[176:179], a[112:115], a[20:23], v[176:179]
s_add_u32 m0, s43, 16960
ds_read_b64_tr_b16 a[82:83], v13 offset:384
v_mfma_f32_16x16x32_bf16 v[208:211], a[112:115], a[24:27], v[208:211]
ds_read_b64_tr_b16 a[84:85], v13 offset:136
buffer_load_dwordx4 v1, s[12:15], s61 offen offset:2048 nt lds
v_mfma_f32_16x16x32_bf16 v[240:243], a[112:115], a[28:31], v[240:243]
ds_read_b64_tr_b16 a[86:87], v13 offset:392
v_mfma_f32_16x16x32_bf16 v[244:247], a[116:119], a[28:31], v[244:247]
ds_read_b64_tr_b16 a[88:89], v13 offset:192
v_mfma_f32_16x16x32_bf16 v[212:215], a[116:119], a[24:27], v[212:215]
ds_read_b64_tr_b16 a[90:91], v13 offset:448
v_mfma_f32_16x16x32_bf16 v[180:183], a[116:119], a[20:23], v[180:183]
v_mfma_f32_16x16x32_bf16 v[148:151], a[116:119], a[16:19], v[148:151]
ds_read_b64_tr_b16 a[92:93], v13 offset:200
v_mfma_f32_16x16x32_bf16 v[152:155], a[120:123], a[16:19], v[152:155]
s_add_u32 m0, s43, 16992
ds_read_b64_tr_b16 a[94:95], v13 offset:456
v_mfma_f32_16x16x32_bf16 v[184:187], a[120:123], a[20:23], v[184:187]
buffer_load_dwordx4 v1, s[12:15], s61 offen offset:3072 nt lds
v_mfma_f32_16x16x32_bf16 v[216:219], a[120:123], a[24:27], v[216:219]
s_mov_b32 s47, s48
v_mfma_f32_16x16x32_bf16 v[248:251], a[120:123], a[28:31], v[248:251]
v_mfma_f32_16x16x32_bf16 v[252:255], a[124:127], a[28:31], v[252:255]
v_mfma_f32_16x16x32_bf16 v[220:223], a[124:127], a[24:27], v[220:223]
v_mfma_f32_16x16x32_bf16 v[188:191], a[124:127], a[20:23], v[188:191]
v_mfma_f32_16x16x32_bf16 v[156:159], a[124:127], a[16:19], v[156:159]
s_waitcnt lgkmcnt(14)
v_mfma_f32_16x16x32_bf16 a[32:35], a[64:67], a[0:3], a[32:35]
v_add_u32 v12, s49, v5
v_mfma_f32_16x16x32_bf16 a[36:39], a[64:67], a[4:7], a[36:39]
ds_read_b128 a[16:19], v12 offset:0
v_mfma_f32_16x16x32_bf16 a[40:43], a[64:67], a[8:11], a[40:43]
ds_read_b128 a[20:23], v12 offset:2048
v_mfma_f32_16x16x32_bf16 a[44:47], a[64:67], a[12:15], a[44:47]
s_waitcnt lgkmcnt(14)
s_add_u32 s61, s53, 1
ds_read_b128 a[24:27], v12 offset:4096
v_mfma_f32_16x16x32_bf16 v[28:31], a[68:71], a[12:15], v[28:31]
s_and_b32 s61, s61, 15
s_lshl_b32 s61, s61, 14
ds_read_b128 a[28:31], v12 offset:6144
v_mfma_f32_16x16x32_bf16 v[24:27], a[68:71], a[8:11], v[24:27]
s_add_u32 s61, s61, s35
s_add_u32 m0, s43, 84480
v_mfma_f32_16x16x32_bf16 v[20:23], a[68:71], a[4:7], v[20:23]
buffer_load_dwordx4 v1, s[16:19], s61 offen offset:0 nt lds
v_mfma_f32_16x16x32_bf16 v[16:19], a[68:71], a[0:3], v[16:19]
s_waitcnt lgkmcnt(14)
ds_read_b32 v6, v11 offset:0
v_mfma_f32_16x16x32_bf16 v[32:35], a[72:75], a[0:3], v[32:35]
s_add_u32 s48, s47, 16896
ds_read_b32 v7, v11 offset:256
v_mfma_f32_16x16x32_bf16 v[36:39], a[72:75], a[4:7], v[36:39]
s_cmp_eq_u32 s48, 67584
s_cselect_b32 s48, 16896, s48
ds_read_b32 v8, v11 offset:512
v_mfma_f32_16x16x32_bf16 v[40:43], a[72:75], a[8:11], v[40:43]
s_waitcnt lgkmcnt(15)
ds_read_b32 v9, v11 offset:768
v_mfma_f32_16x16x32_bf16 v[44:47], a[72:75], a[12:15], v[44:47]
s_add_u32 m0, s43, 84512
v_add_u32 v14, s48, v10
v_mfma_f32_16x16x32_bf16 v[60:63], a[76:79], a[12:15], v[60:63]
buffer_load_dwordx4 v1, s[16:19], s61 offen offset:1024 nt lds
v_mfma_f32_16x16x32_bf16 v[56:59], a[76:79], a[8:11], v[56:59]
s_waitcnt vmcnt(6)
v_mfma_f32_16x16x32_bf16 v[52:55], a[76:79], a[4:7], v[52:55]
s_barrier
ds_read_b64_tr_b16 a[96:97], v14 offset:0
v_mfma_f32_16x16x32_bf16 v[48:51], a[76:79], a[0:3], v[48:51]
s_waitcnt lgkmcnt(15)
ds_read_b64_tr_b16 a[98:99], v14 offset:256
v_mfma_f32_16x16x32_bf16 v[64:67], a[80:83], a[0:3], v[64:67]
ds_read_b64_tr_b16 a[100:101], v14 offset:8
v_mfma_f32_16x16x32_bf16 v[68:71], a[80:83], a[4:7], v[68:71]
ds_read_b64_tr_b16 a[102:103], v14 offset:264
v_mfma_f32_16x16x32_bf16 v[72:75], a[80:83], a[8:11], v[72:75]
ds_read_b64_tr_b16 a[104:105], v14 offset:64
v_mfma_f32_16x16x32_bf16 v[76:79], a[80:83], a[12:15], v[76:79]
s_waitcnt lgkmcnt(15)
ds_read_b64_tr_b16 a[106:107], v14 offset:320
v_mfma_f32_16x16x32_bf16 v[92:95], a[84:87], a[12:15], v[92:95]
ds_read_b64_tr_b16 a[108:109], v14 offset:72
v_mfma_f32_16x16x32_bf16 v[88:91], a[84:87], a[8:11], v[88:91]
ds_read_b64_tr_b16 a[110:111], v14 offset:328
v_mfma_f32_16x16x32_bf16 v[84:87], a[84:87], a[4:7], v[84:87]
s_waitcnt lgkmcnt(11)
buffer_load_dword v10, v6, s[12:15], s35 offen
v_mfma_f32_16x16x32_bf16 v[80:83], a[84:87], a[0:3], v[80:83]
ds_read_b64_tr_b16 a[112:113], v14 offset:128
v_mfma_f32_16x16x32_bf16 v[96:99], a[88:91], a[0:3], v[96:99]
ds_read_b64_tr_b16 a[114:115], v14 offset:384
v_mfma_f32_16x16x32_bf16 v[100:103], a[88:91], a[4:7], v[100:103]
ds_read_b64_tr_b16 a[116:117], v14 offset:136
v_mfma_f32_16x16x32_bf16 v[104:107], a[88:91], a[8:11], v[104:107]
ds_read_b64_tr_b16 a[118:119], v14 offset:392
v_mfma_f32_16x16x32_bf16 v[108:111], a[88:91], a[12:15], v[108:111]
ds_read_b64_tr_b16 a[120:121], v14 offset:192
v_mfma_f32_16x16x32_bf16 v[124:127], a[92:95], a[12:15], v[124:127]
ds_read_b64_tr_b16 a[122:123], v14 offset:448
v_mfma_f32_16x16x32_bf16 v[120:123], a[92:95], a[8:11], v[120:123]
ds_read_b64_tr_b16 a[124:125], v14 offset:200
v_mfma_f32_16x16x32_bf16 v[116:119], a[92:95], a[4:7], v[116:119]
s_add_u32 m0, s43, 84544
ds_read_b64_tr_b16 a[126:127], v14 offset:456
v_mfma_f32_16x16x32_bf16 v[112:115], a[92:95], a[0:3], v[112:115]
s_waitcnt lgkmcnt(14)
buffer_load_dwordx4 v1, s[16:19], s61 offen offset:2048 nt lds
v_mfma_f32_16x16x32_bf16 a[32:35], a[96:99], a[16:19], a[32:35]
v_mfma_f32_16x16x32_bf16 a[36:39], a[96:99], a[20:23], a[36:39]
ds_read_b64_tr_b16 a[64:65], v13 offset:8448
v_mfma_f32_16x16x32_bf16 a[40:43], a[96:99], a[24:27], a[40:43]
ds_read_b64_tr_b16 a[66:67], v13 offset:8704
v_mfma_f32_16x16x32_bf16 a[44:47], a[96:99], a[28:31], a[44:47]
s_waitcnt lgkmcnt(14)
s_add_u32 m0, s43, 84576
ds_read_b64_tr_b16 a[68:69], v13 offset:8456
v_mfma_f32_16x16x32_bf16 v[28:31], a[100:103], a[28:31], v[28:31]
buffer_load_dwordx4 v1, s[16:19], s61 offen offset:3072 nt lds
v_mfma_f32_16x16x32_bf16 v[24:27], a[100:103], a[24:27], v[24:27]
ds_read_b64_tr_b16 a[70:71], v13 offset:8712
v_mfma_f32_16x16x32_bf16 v[20:23], a[100:103], a[20:23], v[20:23]
ds_read_b64_tr_b16 a[72:73], v13 offset:8512
v_mfma_f32_16x16x32_bf16 v[16:19], a[100:103], a[16:19], v[16:19]
s_waitcnt lgkmcnt(15)
ds_read_b64_tr_b16 a[74:75], v13 offset:8768
v_mfma_f32_16x16x32_bf16 v[32:35], a[104:107], a[16:19], v[32:35]
ds_read_b64_tr_b16 a[76:77], v13 offset:8520
v_mfma_f32_16x16x32_bf16 v[36:39], a[104:107], a[20:23], v[36:39]
ds_read_b64_tr_b16 a[78:79], v13 offset:8776
v_mfma_f32_16x16x32_bf16 v[40:43], a[104:107], a[24:27], v[40:43]
ds_read_b64_tr_b16 a[80:81], v13 offset:8576
v_accvgpr_read_b32 v2, a32
v_accvgpr_read_b32 v3, a33
v_accvgpr_read_b32 v4, a34
v_accvgpr_read_b32 v5, a35
v_mul_f32 v2, s54, v2
v_mul_f32 v3, s54, v3
v_mul_f32 v4, s54, v4
v_mul_f32 v5, s54, v5
v_mfma_f32_16x16x32_bf16 v[44:47], a[104:107], a[28:31], v[44:47]
s_waitcnt lgkmcnt(15)
ds_read_b64_tr_b16 a[82:83], v13 offset:8832
v_mfma_f32_16x16x32_bf16 v[60:63], a[108:111], a[28:31], v[60:63]
buffer_load_dword v10, v7, s[12:15], s35 offen
v_mfma_f32_16x16x32_bf16 v[56:59], a[108:111], a[24:27], v[56:59]
ds_read_b64_tr_b16 a[84:85], v13 offset:8584
v_mfma_f32_16x16x32_bf16 v[52:55], a[108:111], a[20:23], v[52:55]
ds_read_b64_tr_b16 a[86:87], v13 offset:8840
v_mul_f32 v16, s54, v16
v_mul_f32 v17, s54, v17
v_mul_f32 v18, s54, v18
v_mul_f32 v19, s54, v19
v_cvt_pk_bf16_f32 v2, v2, v3
v_cvt_pk_bf16_f32 v3, v4, v5
v_mul_f32 v20, s54, v20
v_mul_f32 v21, s54, v21
v_mul_f32 v22, s54, v22
v_mul_f32 v23, s54, v23
v_cvt_pk_bf16_f32 v16, v16, v17
v_mfma_f32_16x16x32_bf16 v[48:51], a[108:111], a[16:19], v[48:51]
ds_read_b64_tr_b16 a[88:89], v13 offset:8640
v_cvt_pk_bf16_f32 v17, v18, v19
v_accvgpr_write_b32 a128, v2
v_accvgpr_write_b32 a129, v3
v_mfma_f32_16x16x32_bf16 v[64:67], a[112:115], a[16:19], v[64:67]
ds_read_b64_tr_b16 a[90:91], v13 offset:8896
v_accvgpr_read_b32 v2, a36
v_accvgpr_read_b32 v3, a37
v_mfma_f32_16x16x32_bf16 v[68:71], a[112:115], a[20:23], v[68:71]
ds_read_b64_tr_b16 a[92:93], v13 offset:8648
v_accvgpr_read_b32 v4, a38
v_accvgpr_read_b32 v5, a39
v_mul_f32 v2, s54, v2
v_mfma_f32_16x16x32_bf16 v[72:75], a[112:115], a[24:27], v[72:75]
ds_read_b64_tr_b16 a[94:95], v13 offset:8904
v_mul_f32 v3, s54, v3
v_mul_f32 v4, s54, v4
v_mul_f32 v5, s54, v5
v_mfma_f32_16x16x32_bf16 v[76:79], a[112:115], a[28:31], v[76:79]
s_waitcnt lgkmcnt(15)
v_cvt_pk_bf16_f32 v20, v20, v21
v_cvt_pk_bf16_f32 v21, v22, v23
v_accvgpr_write_b32 a130, v16
v_accvgpr_write_b32 a131, v17
v_mfma_f32_16x16x32_bf16 v[92:95], a[116:119], a[28:31], v[92:95]
v_mul_f32 v24, s54, v24
v_mul_f32 v25, s54, v25
v_mul_f32 v26, s54, v26
v_mul_f32 v27, s54, v27
v_mfma_f32_16x16x32_bf16 v[88:91], a[116:119], a[24:27], v[88:91]
v_cvt_pk_bf16_f32 v2, v2, v3
v_cvt_pk_bf16_f32 v3, v4, v5
v_accvgpr_write_b32 a146, v20
v_accvgpr_write_b32 a147, v21
v_mfma_f32_16x16x32_bf16 v[84:87], a[116:119], a[20:23], v[84:87]
buffer_load_dword v10, v8, s[12:15], s35 offen
v_mul_f32 v28, s54, v28
v_mfma_f32_16x16x32_bf16 v[80:83], a[116:119], a[16:19], v[80:83]
v_mul_f32 v29, s54, v29
v_mul_f32 v30, s54, v30
v_mul_f32 v31, s54, v31
v_cvt_pk_bf16_f32 v24, v24, v25
v_mfma_f32_16x16x32_bf16 v[96:99], a[120:123], a[16:19], v[96:99]
v_cvt_pk_bf16_f32 v25, v26, v27
v_accvgpr_write_b32 a144, v2
v_accvgpr_write_b32 a145, v3
v_accvgpr_read_b32 v2, a40
v_mfma_f32_16x16x32_bf16 v[100:103], a[120:123], a[20:23], v[100:103]
v_accvgpr_read_b32 v3, a41
v_accvgpr_read_b32 v4, a42
v_accvgpr_read_b32 v5, a43
v_mul_f32 v2, s54, v2
v_mfma_f32_16x16x32_bf16 v[104:107], a[120:123], a[24:27], v[104:107]
v_mul_f32 v3, s54, v3
v_mul_f32 v4, s54, v4
v_mul_f32 v5, s54, v5
v_cvt_pk_bf16_f32 v28, v28, v29
v_mfma_f32_16x16x32_bf16 v[108:111], a[120:123], a[28:31], v[108:111]
s_waitcnt lgkmcnt(0)
v_cvt_pk_bf16_f32 v29, v30, v31
v_accvgpr_write_b32 a162, v24
v_accvgpr_write_b32 a163, v25
v_mul_f32 v32, s54, v32
v_mfma_f32_16x16x32_bf16 v[124:127], a[124:127], a[28:31], v[124:127]
s_add_u32 s61, s53, 2
s_barrier
v_mul_f32 v33, s54, v33
v_mul_f32 v34, s54, v34
v_mul_f32 v35, s54, v35
v_mfma_f32_16x16x32_bf16 v[120:123], a[124:127], a[24:27], v[120:123]
s_and_b32 s61, s61, 15
s_lshl_b32 s61, s61, 14
v_cvt_pk_bf16_f32 v2, v2, v3
v_cvt_pk_bf16_f32 v3, v4, v5
v_accvgpr_write_b32 a178, v28
v_accvgpr_write_b32 a179, v29
v_mfma_f32_16x16x32_bf16 v[116:119], a[124:127], a[20:23], v[116:119]
s_add_u32 s61, s61, s35
s_add_u32 m0, s43, 33792
v_mul_f32 v36, s54, v36
v_mul_f32 v37, s54, v37
v_mul_f32 v38, s54, v38
v_mul_f32 v39, s54, v39
v_mfma_f32_16x16x32_bf16 v[112:115], a[124:127], a[16:19], v[112:115]
buffer_load_dwordx4 v1, s[12:15], s61 offen offset:0 nt lds
v_cvt_pk_bf16_f32 v32, v32, v33
v_cvt_pk_bf16_f32 v33, v34, v35
v_mfma_f32_16x16x32_bf16 v[128:131], a[64:67], a[0:3], v[128:131]
ds_read_b64_tr_b16 a[96:97], v14 offset:8448
v_accvgpr_write_b32 a160, v2
v_accvgpr_write_b32 a161, v3
v_accvgpr_read_b32 v2, a44
v_mfma_f32_16x16x32_bf16 v[160:163], a[64:67], a[4:7], v[160:163]
ds_read_b64_tr_b16 a[98:99], v14 offset:8704
v_accvgpr_read_b32 v3, a45
v_accvgpr_read_b32 v4, a46
v_accvgpr_read_b32 v5, a47
v_mfma_f32_16x16x32_bf16 v[192:195], a[64:67], a[8:11], v[192:195]
ds_read_b64_tr_b16 a[100:101], v14 offset:8456
v_mul_f32 v2, s54, v2
v_mul_f32 v3, s54, v3
v_mfma_f32_16x16x32_bf16 v[224:227], a[64:67], a[12:15], v[224:227]
ds_read_b64_tr_b16 a[102:103], v14 offset:8712
v_mul_f32 v4, s54, v4
v_mul_f32 v5, s54, v5
v_cvt_pk_bf16_f32 v36, v36, v37
v_mfma_f32_16x16x32_bf16 v[228:231], a[68:71], a[12:15], v[228:231]
ds_read_b64_tr_b16 a[104:105], v14 offset:8512
v_cvt_pk_bf16_f32 v37, v38, v39
v_accvgpr_write_b32 a132, v32
v_accvgpr_write_b32 a133, v33
v_mfma_f32_16x16x32_bf16 v[196:199], a[68:71], a[8:11], v[196:199]
ds_read_b64_tr_b16 a[106:107], v14 offset:8768
v_mul_f32 v40, s54, v40
v_mul_f32 v41, s54, v41
v_mul_f32 v42, s54, v42
v_mfma_f32_16x16x32_bf16 v[164:167], a[68:71], a[4:7], v[164:167]
s_add_u32 m0, s43, 33824
ds_read_b64_tr_b16 a[108:109], v14 offset:8520
v_mul_f32 v43, s54, v43
v_cvt_pk_bf16_f32 v2, v2, v3
v_cvt_pk_bf16_f32 v3, v4, v5
v_mfma_f32_16x16x32_bf16 v[132:135], a[68:71], a[0:3], v[132:135]
buffer_load_dwordx4 v1, s[12:15], s61 offen offset:1024 nt lds
v_accvgpr_write_b32 a148, v36
v_accvgpr_write_b32 a149, v37
v_mfma_f32_16x16x32_bf16 v[136:139], a[72:75], a[0:3], v[136:139]
ds_read_b64_tr_b16 a[110:111], v14 offset:8776
v_mul_f32 v44, s54, v44
v_mul_f32 v45, s54, v45
v_mfma_f32_16x16x32_bf16 v[168:171], a[72:75], a[4:7], v[168:171]
ds_read_b64_tr_b16 a[112:113], v14 offset:8576
v_mul_f32 v46, s54, v46
v_mul_f32 v47, s54, v47
v_cvt_pk_bf16_f32 v40, v40, v41
v_mfma_f32_16x16x32_bf16 v[200:203], a[72:75], a[8:11], v[200:203]
ds_read_b64_tr_b16 a[114:115], v14 offset:8832
v_cvt_pk_bf16_f32 v41, v42, v43
v_accvgpr_write_b32 a176, v2
v_accvgpr_write_b32 a177, v3
v_mfma_f32_16x16x32_bf16 v[232:235], a[72:75], a[12:15], v[232:235]
ds_read_b64_tr_b16 a[116:117], v14 offset:8584
v_and_b32 v2, 15, v0
v_bfe_u32 v4, v0, 4, 2
v_mul_u32_u24 v2, 1056, v2
v_mfma_f32_16x16x32_bf16 v[236:239], a[76:79], a[12:15], v[236:239]
ds_read_b64_tr_b16 a[118:119], v14 offset:8840
v_bfe_u32 v3, v0, 2, 4
v_lshl_add_u32 v2, v4, 4, v2
v_mul_u32_u24 v3, 1056, v3
v_mfma_f32_16x16x32_bf16 v[204:207], a[76:79], a[8:11], v[204:207]
ds_read_b64_tr_b16 a[120:121], v14 offset:8640
v_and_b32 v5, 3, v0
v_lshl_add_u32 v3, v5, 3, v3
v_add_u32 v3, 67584, v3
v_mfma_f32_16x16x32_bf16 v[172:175], a[76:79], a[4:7], v[172:175]
s_add_u32 m0, s43, 33856
ds_read_b64_tr_b16 a[122:123], v14 offset:8896
v_mov_b32 v5, v3
v_mul_f32 v48, s54, v48
v_mfma_f32_16x16x32_bf16 v[140:143], a[76:79], a[0:3], v[140:143]
buffer_load_dwordx4 v1, s[12:15], s61 offen offset:2048 nt lds
v_mul_f32 v49, s54, v49
v_mul_f32 v50, s54, v50
v_mfma_f32_16x16x32_bf16 v[144:147], a[80:83], a[0:3], v[144:147]
ds_read_b64_tr_b16 a[124:125], v14 offset:8648
v_mul_f32 v51, s54, v51
v_cvt_pk_bf16_f32 v44, v44, v45
v_cvt_pk_bf16_f32 v45, v46, v47
v_mfma_f32_16x16x32_bf16 v[176:179], a[80:83], a[4:7], v[176:179]
ds_read_b64_tr_b16 a[126:127], v14 offset:8904
v_accvgpr_write_b32 a164, v40
v_accvgpr_write_b32 a165, v41
v_mul_f32 v52, s54, v52
v_mfma_f32_16x16x32_bf16 v[208:211], a[80:83], a[8:11], v[208:211]
v_mul_f32 v53, s54, v53
v_mul_f32 v54, s54, v54
v_mul_f32 v55, s54, v55
v_cvt_pk_bf16_f32 v48, v48, v49
v_mfma_f32_16x16x32_bf16 v[240:243], a[80:83], a[12:15], v[240:243]
v_cvt_pk_bf16_f32 v49, v50, v51
v_accvgpr_write_b32 a180, v44
v_accvgpr_write_b32 a181, v45
v_mul_f32 v56, s54, v56
v_mfma_f32_16x16x32_bf16 v[244:247], a[84:87], a[12:15], v[244:247]
v_mul_f32 v57, s54, v57
v_mul_f32 v58, s54, v58
v_mul_f32 v59, s54, v59
v_mfma_f32_16x16x32_bf16 v[212:215], a[84:87], a[8:11], v[212:215]
v_cvt_pk_bf16_f32 v52, v52, v53
v_cvt_pk_bf16_f32 v53, v54, v55
v_accvgpr_write_b32 a134, v48
v_accvgpr_write_b32 a135, v49
v_mfma_f32_16x16x32_bf16 v[180:183], a[84:87], a[4:7], v[180:183]
s_add_u32 m0, s43, 33888
v_mul_f32 v60, s54, v60
v_mul_f32 v61, s54, v61
v_mul_f32 v62, s54, v62
v_mul_f32 v63, s54, v63
v_mfma_f32_16x16x32_bf16 v[148:151], a[84:87], a[0:3], v[148:151]
buffer_load_dwordx4 v1, s[12:15], s61 offen offset:3072 nt lds
v_cvt_pk_bf16_f32 v56, v56, v57
v_cvt_pk_bf16_f32 v57, v58, v59
v_mfma_f32_16x16x32_bf16 v[152:155], a[88:91], a[0:3], v[152:155]
v_accvgpr_write_b32 a150, v52
v_accvgpr_write_b32 a151, v53
v_mul_f32 v64, s54, v64
v_mul_f32 v65, s54, v65
v_mfma_f32_16x16x32_bf16 v[184:187], a[88:91], a[4:7], v[184:187]
v_mul_f32 v66, s54, v66
v_mul_f32 v67, s54, v67
v_cvt_pk_bf16_f32 v60, v60, v61
v_mfma_f32_16x16x32_bf16 v[216:219], a[88:91], a[8:11], v[216:219]
v_cvt_pk_bf16_f32 v61, v62, v63
v_accvgpr_write_b32 a166, v56
v_accvgpr_write_b32 a167, v57
v_mul_f32 v68, s54, v68
v_mfma_f32_16x16x32_bf16 v[248:251], a[88:91], a[12:15], v[248:251]
v_mul_f32 v69, s54, v69
v_mul_f32 v70, s54, v70
v_mul_f32 v71, s54, v71
v_cvt_pk_bf16_f32 v64, v64, v65
v_mfma_f32_16x16x32_bf16 v[252:255], a[92:95], a[12:15], v[252:255]
v_cvt_pk_bf16_f32 v65, v66, v67
v_accvgpr_write_b32 a182, v60
v_accvgpr_write_b32 a183, v61
v_mul_f32 v72, s54, v72
v_mfma_f32_16x16x32_bf16 v[220:223], a[92:95], a[8:11], v[220:223]
s_waitcnt lgkmcnt(14)
v_mul_f32 v73, s54, v73
v_mul_f32 v74, s54, v74
v_mul_f32 v75, s54, v75
v_cvt_pk_bf16_f32 v68, v68, v69
v_mfma_f32_16x16x32_bf16 v[188:191], a[92:95], a[4:7], v[188:191]
s_add_u32 s61, s53, 2
v_cvt_pk_bf16_f32 v69, v70, v71
v_accvgpr_write_b32 a136, v64
v_accvgpr_write_b32 a137, v65
v_mul_f32 v76, s54, v76
v_mfma_f32_16x16x32_bf16 v[156:159], a[92:95], a[0:3], v[156:159]
s_and_b32 s61, s61, 15
s_lshl_b32 s61, s61, 14
v_mul_f32 v77, s54, v77
v_mul_f32 v78, s54, v78
v_mul_f32 v79, s54, v79
v_mfma_f32_16x16x32_bf16 v[128:131], a[96:99], a[16:19], v[128:131]
s_add_u32 s61, s61, s35
s_add_u32 m0, s43, 101376
v_cvt_pk_bf16_f32 v72, v72, v73
v_cvt_pk_bf16_f32 v73, v74, v75
v_accvgpr_write_b32 a152, v68
v_accvgpr_write_b32 a153, v69
v_mfma_f32_16x16x32_bf16 v[160:163], a[96:99], a[20:23], v[160:163]
buffer_load_dwordx4 v1, s[16:19], s61 offen offset:0 nt lds
v_mul_f32 v80, s54, v80
v_mul_f32 v81, s54, v81
v_mfma_f32_16x16x32_bf16 v[192:195], a[96:99], a[24:27], v[192:195]
v_mul_f32 v82, s54, v82
v_mul_f32 v83, s54, v83
v_cvt_pk_bf16_f32 v76, v76, v77
v_cvt_pk_bf16_f32 v77, v78, v79
v_mfma_f32_16x16x32_bf16 v[224:227], a[96:99], a[28:31], v[224:227]
s_waitcnt lgkmcnt(12)
v_accvgpr_write_b32 a168, v72
v_accvgpr_write_b32 a169, v73
v_mul_f32 v84, s54, v84
v_mul_f32 v85, s54, v85
v_mfma_f32_16x16x32_bf16 v[228:231], a[100:103], a[28:31], v[228:231]
ds_read_b128 a[0:3], v2 offset:0
v_mul_f32 v86, s54, v86
v_mul_f32 v87, s54, v87
v_cvt_pk_bf16_f32 v80, v80, v81
v_cvt_pk_bf16_f32 v81, v82, v83
v_mfma_f32_16x16x32_bf16 v[196:199], a[100:103], a[24:27], v[196:199]
buffer_load_dword v10, v9, s[12:15], s35 offen
v_accvgpr_write_b32 a184, v76
v_mfma_f32_16x16x32_bf16 v[164:167], a[100:103], a[20:23], v[164:167]
ds_read_b128 a[4:7], v2 offset:64
v_accvgpr_write_b32 a185, v77
v_mul_f32 v88, s54, v88
v_mul_f32 v89, s54, v89
v_mul_f32 v90, s54, v90
v_mfma_f32_16x16x32_bf16 v[132:135], a[100:103], a[16:19], v[132:135]
s_waitcnt lgkmcnt(12)
ds_read_b128 a[8:11], v2 offset:128
v_mul_f32 v91, s54, v91
v_cvt_pk_bf16_f32 v84, v84, v85
v_cvt_pk_bf16_f32 v85, v86, v87
v_accvgpr_write_b32 a138, v80
v_mfma_f32_16x16x32_bf16 v[136:139], a[104:107], a[16:19], v[136:139]
s_add_u32 m0, s43, 101408
ds_read_b128 a[12:15], v2 offset:192
v_accvgpr_write_b32 a139, v81
v_mul_f32 v92, s54, v92
v_mul_f32 v93, s54, v93
v_mul_f32 v94, s54, v94
v_mfma_f32_16x16x32_bf16 v[168:171], a[104:107], a[20:23], v[168:171]
buffer_load_dwordx4 v1, s[16:19], s61 offen offset:1024 nt lds
v_mul_f32 v95, s54, v95
v_cvt_pk_bf16_f32 v88, v88, v89
v_mfma_f32_16x16x32_bf16 v[200:203], a[104:107], a[24:27], v[200:203]
ds_read_b128 a[32:35], v2 offset:512
v_cvt_pk_bf16_f32 v89, v90, v91
v_accvgpr_write_b32 a154, v84
v_accvgpr_write_b32 a155, v85
v_mul_f32 v96, s54, v96
v_mfma_f32_16x16x32_bf16 v[232:235], a[104:107], a[28:31], v[232:235]
s_waitcnt lgkmcnt(13)
ds_read_b128 a[36:39], v2 offset:576
v_mul_f32 v97, s54, v97
v_mul_f32 v98, s54, v98
v_mul_f32 v99, s54, v99
v_mfma_f32_16x16x32_bf16 v[236:239], a[108:111], a[28:31], v[236:239]
ds_read_b128 a[40:43], v2 offset:640
v_cvt_pk_bf16_f32 v92, v92, v93
v_cvt_pk_bf16_f32 v93, v94, v95
v_accvgpr_write_b32 a170, v88
v_accvgpr_write_b32 a171, v89
v_mfma_f32_16x16x32_bf16 v[204:207], a[108:111], a[24:27], v[204:207]
ds_read_b128 a[44:47], v2 offset:704
v_mul_f32 v100, s54, v100
v_mul_f32 v101, s54, v101
v_mul_f32 v102, s54, v102
v_mul_f32 v103, s54, v103
v_mfma_f32_16x16x32_bf16 v[172:175], a[108:111], a[20:23], v[172:175]
ds_read_b128 a[48:51], v2 offset:768
v_cvt_pk_bf16_f32 v96, v96, v97
v_cvt_pk_bf16_f32 v97, v98, v99
v_accvgpr_write_b32 a186, v92
v_accvgpr_write_b32 a187, v93
v_mfma_f32_16x16x32_bf16 v[140:143], a[108:111], a[16:19], v[140:143]
s_waitcnt lgkmcnt(15)
ds_read_b128 a[52:55], v2 offset:832
v_mul_f32 v104, s54, v104
v_mul_f32 v105, s54, v105
v_mul_f32 v106, s54, v106
v_mul_f32 v107, s54, v107
v_mfma_f32_16x16x32_bf16 v[144:147], a[112:115], a[16:19], v[144:147]
s_add_u32 m0, s43, 101440
ds_read_b128 a[56:59], v2 offset:896
v_cvt_pk_bf16_f32 v100, v100, v101
v_cvt_pk_bf16_f32 v101, v102, v103
v_accvgpr_write_b32 a140, v96
v_accvgpr_write_b32 a141, v97
v_mfma_f32_16x16x32_bf16 v[176:179], a[112:115], a[20:23], v[176:179]
buffer_load_dwordx4 v1, s[16:19], s61 offen offset:2048 nt lds
v_mul_f32 v108, s54, v108
v_mfma_f32_16x16x32_bf16 v[208:211], a[112:115], a[24:27], v[208:211]
ds_read_b128 a[60:63], v2 offset:960
v_mul_f32 v109, s54, v109
v_mul_f32 v110, s54, v110
v_mul_f32 v111, s54, v111
v_cvt_pk_bf16_f32 v104, v104, v105
v_mfma_f32_16x16x32_bf16 v[240:243], a[112:115], a[28:31], v[240:243]
s_waitcnt lgkmcnt(15)
v_cvt_pk_bf16_f32 v105, v106, v107
v_accvgpr_write_b32 a156, v100
v_accvgpr_write_b32 a157, v101
v_mul_f32 v112, s54, v112
v_mfma_f32_16x16x32_bf16 v[244:247], a[116:119], a[28:31], v[244:247]
v_mul_f32 v113, s54, v113
v_mul_f32 v114, s54, v114
v_mul_f32 v115, s54, v115
v_cvt_pk_bf16_f32 v108, v108, v109
v_mfma_f32_16x16x32_bf16 v[212:215], a[116:119], a[24:27], v[212:215]
v_cvt_pk_bf16_f32 v109, v110, v111
v_accvgpr_write_b32 a172, v104
v_accvgpr_write_b32 a173, v105
v_mul_f32 v116, s54, v116
v_mfma_f32_16x16x32_bf16 v[180:183], a[116:119], a[20:23], v[180:183]
v_mul_f32 v117, s54, v117
v_mul_f32 v118, s54, v118
v_mul_f32 v119, s54, v119
v_cvt_pk_bf16_f32 v112, v112, v113
v_mfma_f32_16x16x32_bf16 v[148:151], a[116:119], a[16:19], v[148:151]
s_waitcnt lgkmcnt(14)
v_cvt_pk_bf16_f32 v113, v114, v115
v_accvgpr_write_b32 a188, v108
v_accvgpr_write_b32 a189, v109
v_mfma_f32_16x16x32_bf16 v[152:155], a[120:123], a[16:19], v[152:155]
s_add_u32 m0, s43, 101472
v_mul_f32 v120, s54, v120
v_mul_f32 v121, s54, v121
v_mul_f32 v122, s54, v122
v_mul_f32 v123, s54, v123
v_mfma_f32_16x16x32_bf16 v[184:187], a[120:123], a[20:23], v[184:187]
buffer_load_dwordx4 v1, s[16:19], s61 offen offset:3072 nt lds
v_cvt_pk_bf16_f32 v116, v116, v117
v_cvt_pk_bf16_f32 v117, v118, v119
v_mfma_f32_16x16x32_bf16 v[216:219], a[120:123], a[24:27], v[216:219]
v_accvgpr_write_b32 a142, v112
v_accvgpr_write_b32 a143, v113
v_mul_f32 v124, s54, v124
v_mul_f32 v125, s54, v125
v_mfma_f32_16x16x32_bf16 v[248:251], a[120:123], a[28:31], v[248:251]
s_waitcnt lgkmcnt(12)
v_mul_f32 v126, s54, v126
v_mul_f32 v127, s54, v127
v_cvt_pk_bf16_f32 v120, v120, v121
v_cvt_pk_bf16_f32 v121, v122, v123
v_mfma_f32_16x16x32_bf16 v[252:255], a[124:127], a[28:31], v[252:255]
s_mov_b32 s47, 0
v_accvgpr_write_b32 a158, v116
v_accvgpr_write_b32 a159, v117
v_cvt_pk_bf16_f32 v124, v124, v125
v_cvt_pk_bf16_f32 v125, v126, v127
v_mfma_f32_16x16x32_bf16 v[220:223], a[124:127], a[24:27], v[220:223]
s_mov_b32 s57, 50688
v_accvgpr_write_b32 a174, v120
v_accvgpr_write_b32 a175, v121
v_accvgpr_write_b32 a190, v124
v_mfma_f32_16x16x32_bf16 v[188:191], a[124:127], a[20:23], v[188:191]
s_add_u32 s50, s35, 49152
v_accvgpr_write_b32 a191, v125
v_and_b32 v16, 3, v0
v_cmp_eq_u32 vcc, 0, v16
v_mov_b32 v17, 0x3f803f80
v_mfma_f32_16x16x32_bf16 v[156:159], a[124:127], a[16:19], v[156:159]
v_cndmask_b32 v16, 0, v17, vcc
v_mov_b32 v17, v16
v_mov_b32 v18, v16
v_mov_b32 v19, v16
ds_read_b128 a[16:19], v2 offset:256
ds_read_b128 a[20:23], v2 offset:320
ds_read_b128 a[24:27], v2 offset:384
ds_read_b128 a[28:31], v2 offset:448
s_waitcnt lgkmcnt(15)
v_mfma_f32_16x16x32_bf16 v[68:71], a[0:3], a[128:131], 0
s_waitcnt lgkmcnt(13)
v_mfma_f32_16x16x32_bf16 v[68:71], a[4:7], a[132:135], v[68:71]
s_waitcnt lgkmcnt(12)
v_mfma_f32_16x16x32_bf16 v[68:71], a[8:11], a[136:139], v[68:71]
v_mfma_f32_16x16x32_bf16 v[68:71], a[12:15], a[140:143], v[68:71]
s_waitcnt lgkmcnt(3)
s_nop 6
v_max3_f32 v11, v68, v69, v70
v_max_f32 v11, v11, v71
v_mov_b32 v12, v11
s_nop 1
v_permlane32_swap_b32 v11, v12
v_max_f32 v11, v11, v12
v_mov_b32 v12, v11
s_nop 1
v_permlane16_swap_b32 v11, v12
v_max_f32 v11, v11, v12
v_sub_f32 v36, 0, v11
v_sub_f32 v37, 0, v11
v_sub_f32 v38, 0, v11
v_sub_f32 v39, 0, v11
s_nop 1
v_mfma_f32_16x16x32_bf16 v[72:75], a[16:19], a[128:131], v[36:39]
s_waitcnt lgkmcnt(2)
v_mul_f32 v128, s54, v128
v_mul_f32 v129, s54, v129
v_mfma_f32_16x16x32_bf16 v[72:75], a[20:23], a[132:135], v[72:75]
s_waitcnt lgkmcnt(1)
v_mul_f32 v130, s54, v130
v_mul_f32 v131, s54, v131
v_mfma_f32_16x16x32_bf16 v[72:75], a[24:27], a[136:139], v[72:75]
s_waitcnt lgkmcnt(0)
v_mul_f32 v132, s54, v132
v_mul_f32 v133, s54, v133
v_mfma_f32_16x16x32_bf16 v[72:75], a[28:31], a[140:143], v[72:75]
v_mul_f32 v134, s54, v134
v_mul_f32 v135, s54, v135
v_mfma_f32_16x16x32_bf16 v[76:79], a[32:35], a[128:131], v[36:39]
v_cvt_pk_bf16_f32 v128, v128, v129
v_cvt_pk_bf16_f32 v129, v130, v131
v_mfma_f32_16x16x32_bf16 v[76:79], a[36:39], a[132:135], v[76:79]
v_mul_f32 v136, s54, v136
v_mul_f32 v137, s54, v137
v_mfma_f32_16x16x32_bf16 v[76:79], a[40:43], a[136:139], v[76:79]
v_mul_f32 v138, s54, v138
v_mul_f32 v139, s54, v139
v_mfma_f32_16x16x32_bf16 v[76:79], a[44:47], a[140:143], v[76:79]
v_cvt_pk_bf16_f32 v132, v132, v133
v_cvt_pk_bf16_f32 v133, v134, v135
v_mfma_f32_16x16x32_bf16 v[80:83], a[48:51], a[128:131], v[36:39]
v_accvgpr_write_b32 a192, v128
v_accvgpr_write_b32 a193, v129
v_mfma_f32_16x16x32_bf16 v[80:83], a[52:55], a[132:135], v[80:83]
v_mul_f32 v140, s54, v140
v_mul_f32 v141, s54, v141
v_mfma_f32_16x16x32_bf16 v[80:83], a[56:59], a[136:139], v[80:83]
v_mul_f32 v142, s54, v142
v_mul_f32 v143, s54, v143
v_mfma_f32_16x16x32_bf16 v[80:83], a[60:63], a[140:143], v[80:83]
v_cvt_pk_bf16_f32 v136, v136, v137
v_cvt_pk_bf16_f32 v137, v138, v139
v_mfma_f32_16x16x32_bf16 v[84:87], a[0:3], a[144:147], 0
v_add_f32 v68, v68, v36
v_add_f32 v69, v69, v36
v_add_f32 v70, v70, v36
v_add_f32 v71, v71, v36
v_mfma_f32_16x16x32_bf16 v[84:87], a[4:7], a[148:151], v[84:87]
v_exp_f32 v68, v68
v_exp_f32 v69, v69
s_nop 0
v_cvt_pk_bf16_f32 v52, v68, v69
v_mfma_f32_16x16x32_bf16 v[84:87], a[8:11], a[152:155], v[84:87]
v_exp_f32 v70, v70
v_exp_f32 v71, v71
s_nop 0
v_cvt_pk_bf16_f32 v53, v70, v71
v_mfma_f32_16x16x32_bf16 v[84:87], a[12:15], a[156:159], v[84:87]
ds_read_b64_tr_b16 a[64:65], v5 offset:0
ds_read_b64_tr_b16 a[66:67], v5 offset:256
ds_read_b64_tr_b16 a[68:69], v5 offset:512
ds_read_b64_tr_b16 a[70:71], v5 offset:768
ds_read_b64_tr_b16 a[72:73], v5 offset:32
ds_read_b64_tr_b16 a[74:75], v5 offset:288
ds_read_b64_tr_b16 a[76:77], v5 offset:544
s_nop 0
v_max3_f32 v11, v84, v85, v86
v_max_f32 v11, v11, v87
v_mov_b32 v12, v11
s_nop 1
v_permlane32_swap_b32 v11, v12
v_max_f32 v11, v11, v12
v_mov_b32 v12, v11
s_nop 1
v_permlane16_swap_b32 v11, v12
v_max_f32 v11, v11, v12
v_sub_f32 v40, 0, v11
v_sub_f32 v41, 0, v11
v_sub_f32 v42, 0, v11
v_sub_f32 v43, 0, v11
s_nop 1
v_mfma_f32_16x16x32_bf16 v[88:91], a[16:19], a[144:147], v[40:43]
v_accvgpr_write_b32 a194, v132
v_accvgpr_write_b32 a195, v133
v_exp_f32 v72, v72
v_exp_f32 v73, v73
s_nop 0
v_cvt_pk_bf16_f32 v54, v72, v73
v_mfma_f32_16x16x32_bf16 v[88:91], a[20:23], a[148:151], v[88:91]
ds_read_b64_tr_b16 a[78:79], v5 offset:800
ds_read_b64_tr_b16 a[80:81], v5 offset:64
v_mul_f32 v144, s54, v144
v_mul_f32 v145, s54, v145
v_mul_f32 v146, s54, v146
v_exp_f32 v74, v74
v_mfma_f32_16x16x32_bf16 v[88:91], a[24:27], a[152:155], v[88:91]
v_mul_f32 v147, s54, v147
v_cvt_pk_bf16_f32 v140, v140, v141
v_cvt_pk_bf16_f32 v141, v142, v143
v_exp_f32 v75, v75
s_nop 0
v_cvt_pk_bf16_f32 v55, v74, v75
v_exp_f32 v76, v76
v_mfma_f32_16x16x32_bf16 v[88:91], a[28:31], a[156:159], v[88:91]
ds_read_b64_tr_b16 a[82:83], v5 offset:320
v_accvgpr_write_b32 a196, v136
v_accvgpr_write_b32 a197, v137
v_mul_f32 v148, s54, v148
v_exp_f32 v77, v77
s_nop 0
v_cvt_pk_bf16_f32 v56, v76, v77
v_mfma_f32_16x16x32_bf16 v[92:95], a[32:35], a[144:147], v[40:43]
v_mul_f32 v149, s54, v149
v_mul_f32 v150, s54, v150
v_exp_f32 v78, v78
v_exp_f32 v79, v79
s_nop 0
v_cvt_pk_bf16_f32 v57, v78, v79
v_mfma_f32_16x16x32_bf16 v[92:95], a[36:39], a[148:151], v[92:95]
ds_read_b64_tr_b16 a[84:85], v5 offset:576
ds_read_b64_tr_b16 a[86:87], v5 offset:832
v_mul_f32 v151, s54, v151
v_cvt_pk_bf16_f32 v144, v144, v145
v_cvt_pk_bf16_f32 v145, v146, v147
v_exp_f32 v80, v80
v_mfma_f32_16x16x32_bf16 v[92:95], a[40:43], a[152:155], v[92:95]
v_accvgpr_write_b32 a198, v140
v_accvgpr_write_b32 a199, v141
v_exp_f32 v81, v81
s_nop 0
v_cvt_pk_bf16_f32 v58, v80, v81
v_exp_f32 v82, v82
v_mfma_f32_16x16x32_bf16 v[92:95], a[44:47], a[156:159], v[92:95]
ds_read_b64_tr_b16 a[88:89], v5 offset:96
v_mul_f32 v152, s54, v152
v_mul_f32 v153, s54, v153
v_mul_f32 v154, s54, v154
v_exp_f32 v83, v83
s_nop 0
v_cvt_pk_bf16_f32 v59, v82, v83
v_mfma_f32_16x16x32_bf16 v[96:99], a[48:51], a[144:147], v[40:43]
v_mul_f32 v155, s54, v155
v_cvt_pk_bf16_f32 v148, v148, v149
v_cvt_pk_bf16_f32 v149, v150, v151
v_accvgpr_write_b32 a200, v144
v_accvgpr_write_b32 a201, v145
v_mul_f32 v156, s54, v156
v_mul_f32 v157, s54, v157
v_mul_f32 v158, s54, v158
v_mfma_f32_16x16x32_bf16 v[96:99], a[52:55], a[148:151], v[96:99]
ds_read_b64_tr_b16 a[90:91], v5 offset:352
ds_read_b64_tr_b16 a[92:93], v5 offset:608
v_mul_f32 v159, s54, v159
v_cvt_pk_bf16_f32 v152, v152, v153
v_cvt_pk_bf16_f32 v153, v154, v155
v_accvgpr_write_b32 a202, v148
v_accvgpr_write_b32 a203, v149
v_mfma_f32_16x16x32_bf16 v[96:99], a[56:59], a[152:155], v[96:99]
v_cvt_pk_bf16_f32 v156, v156, v157
v_cvt_pk_bf16_f32 v157, v158, v159
v_accvgpr_write_b32 a204, v152
v_accvgpr_write_b32 a205, v153
v_accvgpr_write_b32 a206, v156
v_accvgpr_write_b32 a207, v157
v_mfma_f32_16x16x32_bf16 v[96:99], a[60:63], a[156:159], v[96:99]
ds_read_b64_tr_b16 a[94:95], v5 offset:864
ds_read_b64_tr_b16 a[96:97], v5 offset:128
ds_read_b64_tr_b16 a[98:99], v5 offset:384
ds_read_b64_tr_b16 a[100:101], v5 offset:640
ds_read_b64_tr_b16 a[102:103], v5 offset:896
ds_read_b64_tr_b16 a[104:105], v5 offset:160
ds_read_b64_tr_b16 a[106:107], v5 offset:416
ds_read_b64_tr_b16 a[108:109], v5 offset:672
v_mfma_f32_16x16x32_bf16 v[68:71], a[0:3], a[160:163], 0
v_add_f32 v84, v84, v40
v_add_f32 v85, v85, v40
v_add_f32 v86, v86, v40
v_mfma_f32_16x16x32_bf16 v[68:71], a[4:7], a[164:167], v[68:71]
ds_read_b64_tr_b16 a[110:111], v5 offset:928
ds_read_b64_tr_b16 a[112:113], v5 offset:192
v_add_f32 v87, v87, v40
v_mfma_f32_16x16x32_bf16 v[68:71], a[8:11], a[168:171], v[68:71]
v_exp_f32 v84, v84
v_mfma_f32_16x16x32_bf16 v[68:71], a[12:15], a[172:175], v[68:71]
s_waitcnt lgkmcnt(15)
ds_read_b64_tr_b16 a[114:115], v5 offset:448
v_exp_f32 v85, v85
v_mfma_f32_16x16x32_bf16 v[128:131], a[64:67], v[52:55], 0
v_mul_f32 v160, s54, v160
v_cvt_pk_bf16_f32 v60, v84, v85
v_exp_f32 v86, v86
v_mfma_f32_16x16x32_bf16 v[128:131], a[68:71], v[56:59], v[128:131]
ds_read_b64_tr_b16 a[116:117], v5 offset:704
ds_read_b64_tr_b16 a[118:119], v5 offset:960
v_mul_f32 v161, s54, v161
v_mul_f32 v162, s54, v162
v_mfma_f32_16x16x32_bf16 v[132:135], a[76:79], v[56:59], 0
v_mul_f32 v163, s54, v163
v_exp_f32 v87, v87
s_nop 0
v_cvt_pk_bf16_f32 v61, v86, v87
v_mfma_f32_16x16x32_bf16 v[132:135], a[72:75], v[52:55], v[132:135]
ds_read_b64_tr_b16 a[120:121], v5 offset:224
v_max3_f32 v11, v68, v69, v70
v_max_f32 v11, v11, v71
v_mul_f32 v164, s54, v164
v_mfma_f32_16x16x32_bf16 v[136:139], a[80:83], v[52:55], 0
s_waitcnt lgkmcnt(15)
v_mov_b32 v12, v11
v_mul_f32 v165, s54, v165
v_exp_f32 v88, v88
v_mfma_f32_16x16x32_bf16 v[136:139], a[84:87], v[56:59], v[136:139]
s_waitcnt lgkmcnt(13)
ds_read_b64_tr_b16 a[122:123], v5 offset:480
ds_read_b64_tr_b16 a[124:125], v5 offset:736
v_mul_f32 v166, s54, v166
v_mul_f32 v167, s54, v167
v_mfma_f32_16x16x32_bf16 v[140:143], a[92:95], v[56:59], 0
v_permlane32_swap_b32 v11, v12
v_max_f32 v11, v11, v12
v_cvt_pk_bf16_f32 v160, v160, v161
v_cvt_pk_bf16_f32 v161, v162, v163
v_mfma_f32_16x16x32_bf16 v[140:143], a[88:91], v[52:55], v[140:143]
s_waitcnt lgkmcnt(13)
ds_read_b64_tr_b16 a[126:127], v5 offset:992
v_mov_b32 v12, v11
v_mul_f32 v168, s54, v168
v_mfma_f32_16x16x32_bf16 v[144:147], a[96:99], v[52:55], 0
s_waitcnt lgkmcnt(12)
v_permlane16_swap_b32 v11, v12
v_mul_f32 v169, s54, v169
v_exp_f32 v89, v89
v_mfma_f32_16x16x32_bf16 v[144:147], a[100:103], v[56:59], v[144:147]
s_waitcnt lgkmcnt(8)
v_max_f32 v11, v11, v12
v_sub_f32 v44, 0, v11
v_mul_f32 v170, s54, v170
v_cvt_pk_bf16_f32 v62, v88, v89
v_mfma_f32_16x16x32_bf16 v[148:151], a[108:111], v[56:59], 0
v_sub_f32 v45, 0, v11
v_sub_f32 v46, 0, v11
v_sub_f32 v47, 0, v11
v_mul_f32 v171, s54, v171
v_mfma_f32_16x16x32_bf16 v[148:151], a[104:107], v[52:55], v[148:151]
v_cvt_pk_bf16_f32 v164, v164, v165
v_cvt_pk_bf16_f32 v165, v166, v167
v_exp_f32 v90, v90
v_mfma_f32_16x16x32_bf16 v[72:75], a[16:19], a[160:163], v[44:47]
v_accvgpr_write_b32 a208, v160
v_exp_f32 v91, v91
s_nop 0
v_cvt_pk_bf16_f32 v63, v90, v91
v_mfma_f32_16x16x32_bf16 v[72:75], a[20:23], a[164:167], v[72:75]
v_accvgpr_write_b32 a209, v161
v_mul_f32 v172, s54, v172
v_exp_f32 v92, v92
v_mfma_f32_16x16x32_bf16 v[72:75], a[24:27], a[168:171], v[72:75]
v_mul_f32 v173, s54, v173
v_exp_f32 v93, v93
s_nop 0
v_cvt_pk_bf16_f32 v64, v92, v93
v_mfma_f32_16x16x32_bf16 v[72:75], a[28:31], a[172:175], v[72:75]
v_mul_f32 v174, s54, v174
v_mul_f32 v175, s54, v175
v_exp_f32 v94, v94
v_mfma_f32_16x16x32_bf16 v[76:79], a[32:35], a[160:163], v[44:47]
v_cvt_pk_bf16_f32 v168, v168, v169
v_exp_f32 v95, v95
s_nop 0
v_cvt_pk_bf16_f32 v65, v94, v95
v_mfma_f32_16x16x32_bf16 v[76:79], a[36:39], a[164:167], v[76:79]
v_cvt_pk_bf16_f32 v169, v170, v171
v_accvgpr_write_b32 a210, v164
v_exp_f32 v96, v96
v_mfma_f32_16x16x32_bf16 v[76:79], a[40:43], a[168:171], v[76:79]
v_accvgpr_write_b32 a211, v165
v_exp_f32 v97, v97
s_nop 0
v_cvt_pk_bf16_f32 v66, v96, v97
v_mfma_f32_16x16x32_bf16 v[76:79], a[44:47], a[172:175], v[76:79]
v_mul_f32 v176, s54, v176
v_mul_f32 v177, s54, v177
v_exp_f32 v98, v98
v_mfma_f32_16x16x32_bf16 v[80:83], a[48:51], a[160:163], v[44:47]
v_mul_f32 v178, s54, v178
v_exp_f32 v99, v99
s_nop 0
v_cvt_pk_bf16_f32 v67, v98, v99
v_mfma_f32_16x16x32_bf16 v[80:83], a[52:55], a[164:167], v[80:83]
v_mul_f32 v179, s54, v179
v_cvt_pk_bf16_f32 v172, v172, v173
v_cvt_pk_bf16_f32 v173, v174, v175
v_accvgpr_write_b32 a212, v168
v_mfma_f32_16x16x32_bf16 v[80:83], a[56:59], a[168:171], v[80:83]
v_accvgpr_write_b32 a213, v169
v_mul_f32 v180, s54, v180
v_mul_f32 v181, s54, v181
v_mfma_f32_16x16x32_bf16 v[80:83], a[60:63], a[172:175], v[80:83]
s_waitcnt lgkmcnt(6)
v_mul_f32 v182, s54, v182
v_mul_f32 v183, s54, v183
v_cvt_pk_bf16_f32 v176, v176, v177
v_cvt_pk_bf16_f32 v177, v178, v179
v_mfma_f32_16x16x32_bf16 v[152:155], a[112:115], v[52:55], 0
s_waitcnt lgkmcnt(4)
v_accvgpr_write_b32 a214, v172
v_accvgpr_write_b32 a215, v173
v_mul_f32 v184, s54, v184
v_mul_f32 v185, s54, v185
v_mfma_f32_16x16x32_bf16 v[152:155], a[116:119], v[56:59], v[152:155]
s_waitcnt lgkmcnt(0)
v_mul_f32 v186, s54, v186
v_mul_f32 v187, s54, v187
v_cvt_pk_bf16_f32 v180, v180, v181
v_cvt_pk_bf16_f32 v181, v182, v183
v_mfma_f32_16x16x32_bf16 v[156:159], a[124:127], v[56:59], 0
v_accvgpr_write_b32 a216, v176
v_accvgpr_write_b32 a217, v177
v_mul_f32 v188, s54, v188
v_mul_f32 v189, s54, v189
v_mfma_f32_16x16x32_bf16 v[156:159], a[120:123], v[52:55], v[156:159]
v_mul_f32 v190, s54, v190
v_mul_f32 v191, s54, v191
v_cvt_pk_bf16_f32 v184, v184, v185
v_cvt_pk_bf16_f32 v185, v186, v187
v_mfma_f32_16x16x32_bf16 v[20:23], v[16:19], v[52:55], 0
v_accvgpr_write_b32 a218, v180
v_accvgpr_write_b32 a219, v181
v_cvt_pk_bf16_f32 v188, v188, v189
v_cvt_pk_bf16_f32 v189, v190, v191
v_mfma_f32_16x16x32_bf16 v[20:23], v[16:19], v[56:59], v[20:23]
v_accvgpr_write_b32 a220, v184
v_accvgpr_write_b32 a221, v185
v_accvgpr_write_b32 a222, v188
v_accvgpr_write_b32 a223, v189
v_mfma_f32_16x16x32_bf16 v[84:87], a[0:3], a[176:179], 0
s_add_u32 s48, s47, 16896
v_add_f32 v68, v68, v44
v_add_f32 v69, v69, v44
v_add_f32 v70, v70, v44
v_mfma_f32_16x16x32_bf16 v[84:87], a[4:7], a[180:183], v[84:87]
s_cmp_eq_u32 s48, 67584
v_add_f32 v71, v71, v44
v_exp_f32 v68, v68
v_mfma_f32_16x16x32_bf16 v[84:87], a[8:11], a[184:187], v[84:87]
s_cselect_b32 s48, 0, s48
v_exp_f32 v69, v69
s_nop 0
v_cvt_pk_bf16_f32 v52, v68, v69
v_mfma_f32_16x16x32_bf16 v[84:87], a[12:15], a[188:191], v[84:87]
s_waitcnt vmcnt(11)
v_add_u32 v4, s48, v2
v_exp_f32 v70, v70
v_mfma_f32_16x16x32_bf16 v[160:163], a[64:67], v[60:63], 0
s_barrier
v_mul_f32 v192, s54, v192
v_exp_f32 v71, v71
s_nop 0
v_cvt_pk_bf16_f32 v53, v70, v71
v_mfma_f32_16x16x32_bf16 v[160:163], a[68:71], v[64:67], v[160:163]
ds_read_b128 a[0:3], v4 offset:0
v_mul_f32 v193, s54, v193
v_exp_f32 v72, v72
v_mfma_f32_16x16x32_bf16 v[164:167], a[76:79], v[64:67], 0
s_add_u32 s49, s57, s43
v_mul_f32 v194, s54, v194
v_mul_f32 v195, s54, v195
v_exp_f32 v73, v73
s_nop 0
v_cvt_pk_bf16_f32 v54, v72, v73
v_mfma_f32_16x16x32_bf16 v[164:167], a[72:75], v[60:63], v[164:167]
ds_read_b128 a[4:7], v4 offset:64
v_max3_f32 v11, v84, v85, v86
v_max_f32 v11, v11, v87
v_mul_f32 v196, s54, v196
v_mfma_f32_16x16x32_bf16 v[168:171], a[80:83], v[60:63], 0
v_mov_b32 v12, v11
v_mul_f32 v197, s54, v197
v_exp_f32 v74, v74
v_mfma_f32_16x16x32_bf16 v[168:171], a[84:87], v[64:67], v[168:171]
ds_read_b128 a[8:11], v4 offset:128
v_mul_f32 v198, s54, v198
v_exp_f32 v75, v75
v_mfma_f32_16x16x32_bf16 v[172:175], a[92:95], v[64:67], 0
v_permlane32_swap_b32 v11, v12
v_max_f32 v11, v11, v12
v_mul_f32 v199, s54, v199
v_cvt_pk_bf16_f32 v55, v74, v75
v_mfma_f32_16x16x32_bf16 v[172:175], a[88:91], v[60:63], v[172:175]
ds_read_b128 a[12:15], v4 offset:192
v_mov_b32 v12, v11
v_cvt_pk_bf16_f32 v192, v192, v193
v_cvt_pk_bf16_f32 v193, v194, v195
v_mfma_f32_16x16x32_bf16 v[176:179], a[96:99], v[60:63], 0
v_permlane16_swap_b32 v11, v12
v_mul_f32 v200, s54, v200
v_mul_f32 v201, s54, v201
v_exp_f32 v76, v76
v_mfma_f32_16x16x32_bf16 v[176:179], a[100:103], v[64:67], v[176:179]
v_max_f32 v11, v11, v12
v_sub_f32 v48, 0, v11
v_mul_f32 v202, s54, v202
v_mul_f32 v203, s54, v203
v_mfma_f32_16x16x32_bf16 v[180:183], a[108:111], v[64:67], 0
v_sub_f32 v49, 0, v11
v_sub_f32 v50, 0, v11
v_sub_f32 v51, 0, v11
v_cvt_pk_bf16_f32 v196, v196, v197
v_mfma_f32_16x16x32_bf16 v[180:183], a[104:107], v[60:63], v[180:183]
v_cvt_pk_bf16_f32 v197, v198, v199
v_exp_f32 v77, v77
s_nop 0
v_cvt_pk_bf16_f32 v56, v76, v77
v_mfma_f32_16x16x32_bf16 v[88:91], a[16:19], a[176:179], v[48:51]
v_accvgpr_write_b32 a224, v192
v_accvgpr_write_b32 a225, v193
v_exp_f32 v78, v78
v_mfma_f32_16x16x32_bf16 v[88:91], a[20:23], a[180:183], v[88:91]
v_mul_f32 v204, s54, v204
v_exp_f32 v79, v79
s_nop 0
v_cvt_pk_bf16_f32 v57, v78, v79
v_mfma_f32_16x16x32_bf16 v[88:91], a[24:27], a[184:187], v[88:91]
v_mul_f32 v205, s54, v205
v_mul_f32 v206, s54, v206
v_mul_f32 v207, s54, v207
v_exp_f32 v80, v80
v_mfma_f32_16x16x32_bf16 v[88:91], a[28:31], a[188:191], v[88:91]
v_cvt_pk_bf16_f32 v200, v200, v201
v_exp_f32 v81, v81
s_nop 0
v_cvt_pk_bf16_f32 v58, v80, v81
v_mfma_f32_16x16x32_bf16 v[92:95], a[32:35], a[176:179], v[48:51]
ds_read_b128 a[16:19], v4 offset:256
v_cvt_pk_bf16_f32 v201, v202, v203
v_exp_f32 v82, v82
v_mfma_f32_16x16x32_bf16 v[92:95], a[36:39], a[180:183], v[92:95]
ds_read_b128 a[20:23], v4 offset:320
v_accvgpr_write_b32 a226, v196
v_exp_f32 v83, v83
v_mfma_f32_16x16x32_bf16 v[92:95], a[40:43], a[184:187], v[92:95]
ds_read_b128 a[24:27], v4 offset:384
v_accvgpr_write_b32 a227, v197
v_mul_f32 v208, s54, v208
v_cvt_pk_bf16_f32 v59, v82, v83
v_mfma_f32_16x16x32_bf16 v[92:95], a[44:47], a[188:191], v[92:95]
ds_read_b128 a[28:31], v4 offset:448
v_mul_f32 v209, s54, v209
v_mul_f32 v210, s54, v210
v_mul_f32 v211, s54, v211
v_mfma_f32_16x16x32_bf16 v[96:99], a[48:51], a[176:179], v[48:51]
ds_read_b128 a[32:35], v4 offset:512
v_cvt_pk_bf16_f32 v204, v204, v205
v_cvt_pk_bf16_f32 v205, v206, v207
v_accvgpr_write_b32 a228, v200
v_accvgpr_write_b32 a229, v201
v_mfma_f32_16x16x32_bf16 v[96:99], a[52:55], a[180:183], v[96:99]
ds_read_b128 a[36:39], v4 offset:576
v_mul_f32 v212, s54, v212
v_mul_f32 v213, s54, v213
v_mul_f32 v214, s54, v214
v_mfma_f32_16x16x32_bf16 v[96:99], a[56:59], a[184:187], v[96:99]
ds_read_b128 a[40:43], v4 offset:640
v_mul_f32 v215, s54, v215
v_cvt_pk_bf16_f32 v208, v208, v209
v_cvt_pk_bf16_f32 v209, v210, v211
v_mfma_f32_16x16x32_bf16 v[96:99], a[60:63], a[188:191], v[96:99]
ds_read_b128 a[44:47], v4 offset:704
v_accvgpr_write_b32 a230, v204
v_accvgpr_write_b32 a231, v205
v_mul_f32 v216, s54, v216
v_mfma_f32_16x16x32_bf16 v[184:187], a[112:115], v[60:63], 0
ds_read_b128 a[48:51], v4 offset:768
v_mul_f32 v217, s54, v217
v_mul_f32 v218, s54, v218
v_mul_f32 v219, s54, v219
v_mfma_f32_16x16x32_bf16 v[184:187], a[116:119], v[64:67], v[184:187]
ds_read_b128 a[52:55], v4 offset:832
v_cvt_pk_bf16_f32 v212, v212, v213
v_cvt_pk_bf16_f32 v213, v214, v215
v_accvgpr_write_b32 a232, v208
v_mfma_f32_16x16x32_bf16 v[188:191], a[124:127], v[64:67], 0
ds_read_b128 a[56:59], v4 offset:896
v_accvgpr_write_b32 a233, v209
v_mul_f32 v220, s54, v220
v_mul_f32 v221, s54, v221
v_mul_f32 v222, s54, v222
v_mfma_f32_16x16x32_bf16 v[188:191], a[120:123], v[60:63], v[188:191]
ds_read_b128 a[60:63], v4 offset:960
v_mul_f32 v223, s54, v223
v_cvt_pk_bf16_f32 v216, v216, v217
v_cvt_pk_bf16_f32 v217, v218, v219
v_mfma_f32_16x16x32_bf16 v[24:27], v[16:19], v[60:63], 0
v_accvgpr_write_b32 a234, v212
v_accvgpr_write_b32 a235, v213
v_cvt_pk_bf16_f32 v220, v220, v221
v_cvt_pk_bf16_f32 v221, v222, v223
v_mfma_f32_16x16x32_bf16 v[24:27], v[16:19], v[64:67], v[24:27]
v_accvgpr_write_b32 a236, v216
v_accvgpr_write_b32 a237, v217
v_accvgpr_write_b32 a238, v220
v_accvgpr_write_b32 a239, v221
s_waitcnt lgkmcnt(15)
v_mfma_f32_16x16x32_bf16 v[68:71], a[0:3], a[128:131], v[36:39]
s_waitcnt lgkmcnt(14)
v_add_f32 v84, v84, v48
v_add_f32 v85, v85, v48
v_mfma_f32_16x16x32_bf16 v[68:71], a[4:7], a[132:135], v[68:71]
s_waitcnt lgkmcnt(13)
v_add_u32 v5, s48, v3
v_add_f32 v86, v86, v48
v_mfma_f32_16x16x32_bf16 v[68:71], a[8:11], a[136:139], v[68:71]
s_waitcnt lgkmcnt(12)
v_add_f32 v87, v87, v48
v_mfma_f32_16x16x32_bf16 v[68:71], a[12:15], a[140:143], v[68:71]
v_exp_f32 v84, v84
v_mfma_f32_16x16x32_bf16 v[192:195], a[64:67], v[52:55], 0
s_add_u32 m0, s49, 0
v_mul_f32 v224, s54, v224
v_mul_f32 v225, s54, v225
v_exp_f32 v85, v85
v_mfma_f32_16x16x32_bf16 v[192:195], a[68:71], v[56:59], v[192:195]
buffer_load_dwordx4 v1, s[12:15], s50 offen offset:0 nt lds
v_mul_f32 v226, s54, v226
v_mul_f32 v227, s54, v227
v_mfma_f32_16x16x32_bf16 v[196:199], a[76:79], v[56:59], 0
v_mul_f32 v228, s54, v228
v_mul_f32 v229, s54, v229
v_mul_f32 v230, s54, v230
v_cvt_pk_bf16_f32 v60, v84, v85
v_mfma_f32_16x16x32_bf16 v[196:199], a[72:75], v[52:55], v[196:199]
s_waitcnt lgkmcnt(11)
v_mul_f32 v231, s54, v231
v_cvt_pk_bf16_f32 v224, v224, v225
v_exp_f32 v86, v86
v_mfma_f32_16x16x32_bf16 v[72:75], a[16:19], a[128:131], v[36:39]
s_waitcnt lgkmcnt(10)
v_cvt_pk_bf16_f32 v225, v226, v227
v_mul_f32 v232, s54, v232
v_exp_f32 v87, v87
v_mfma_f32_16x16x32_bf16 v[72:75], a[20:23], a[132:135], v[72:75]
s_waitcnt lgkmcnt(9)
v_mul_f32 v233, s54, v233
v_mul_f32 v234, s54, v234
v_mul_f32 v235, s54, v235
v_cvt_pk_bf16_f32 v61, v86, v87
v_mfma_f32_16x16x32_bf16 v[72:75], a[24:27], a[136:139], v[72:75]
s_waitcnt lgkmcnt(8)
v_cvt_pk_bf16_f32 v228, v228, v229
v_cvt_pk_bf16_f32 v229, v230, v231
v_exp_f32 v88, v88
v_mfma_f32_16x16x32_bf16 v[72:75], a[28:31], a[140:143], v[72:75]
v_accvgpr_write_b32 a240, v224
v_accvgpr_write_b32 a241, v225
v_mul_f32 v236, s54, v236
v_exp_f32 v89, v89
v_mfma_f32_16x16x32_bf16 v[200:203], a[80:83], v[52:55], 0
s_add_u32 m0, s49, 32
v_mul_f32 v237, s54, v237
v_mul_f32 v238, s54, v238
v_mul_f32 v239, s54, v239
v_cvt_pk_bf16_f32 v62, v88, v89
v_mfma_f32_16x16x32_bf16 v[200:203], a[84:87], v[56:59], v[200:203]
buffer_load_dwordx4 v1, s[12:15], s50 offen offset:1024 nt lds
v_cvt_pk_bf16_f32 v232, v232, v233
v_cvt_pk_bf16_f32 v233, v234, v235
v_mfma_f32_16x16x32_bf16 v[204:207], a[92:95], v[56:59], 0
v_accvgpr_write_b32 a242, v228
v_accvgpr_write_b32 a243, v229
v_exp_f32 v90, v90
v_mfma_f32_16x16x32_bf16 v[204:207], a[88:91], v[52:55], v[204:207]
s_waitcnt lgkmcnt(7)
v_mul_f32 v240, s54, v240
v_mul_f32 v241, s54, v241
v_exp_f32 v91, v91
v_mfma_f32_16x16x32_bf16 v[76:79], a[32:35], a[128:131], v[36:39]
s_waitcnt lgkmcnt(6)
v_mul_f32 v242, s54, v242
v_mul_f32 v243, s54, v243
v_cvt_pk_bf16_f32 v236, v236, v237
v_cvt_pk_bf16_f32 v63, v90, v91
v_mfma_f32_16x16x32_bf16 v[76:79], a[36:39], a[132:135], v[76:79]
s_waitcnt lgkmcnt(5)
v_cvt_pk_bf16_f32 v237, v238, v239
v_accvgpr_write_b32 a244, v232
v_exp_f32 v92, v92
v_mfma_f32_16x16x32_bf16 v[76:79], a[40:43], a[136:139], v[76:79]
s_waitcnt lgkmcnt(4)
v_accvgpr_write_b32 a245, v233
v_mul_f32 v244, s54, v244
v_exp_f32 v93, v93
v_mfma_f32_16x16x32_bf16 v[76:79], a[44:47], a[140:143], v[76:79]
v_mul_f32 v245, s54, v245
v_mul_f32 v246, s54, v246
v_mul_f32 v247, s54, v247
v_cvt_pk_bf16_f32 v64, v92, v93
v_mfma_f32_16x16x32_bf16 v[208:211], a[96:99], v[52:55], 0
s_add_u32 m0, s49, 64
v_cvt_pk_bf16_f32 v240, v240, v241
v_cvt_pk_bf16_f32 v241, v242, v243
v_exp_f32 v94, v94
v_mfma_f32_16x16x32_bf16 v[208:211], a[100:103], v[56:59], v[208:211]
buffer_load_dwordx4 v1, s[12:15], s50 offen offset:2048 nt lds
v_accvgpr_write_b32 a246, v236
v_accvgpr_write_b32 a247, v237
v_mfma_f32_16x16x32_bf16 v[212:215], a[108:111], v[56:59], 0
v_mul_f32 v248, s54, v248
v_mul_f32 v249, s54, v249
v_exp_f32 v95, v95
v_mfma_f32_16x16x32_bf16 v[212:215], a[104:107], v[52:55], v[212:215]
s_waitcnt lgkmcnt(3)
v_mul_f32 v250, s54, v250
v_mul_f32 v251, s54, v251
v_cvt_pk_bf16_f32 v244, v244, v245
v_cvt_pk_bf16_f32 v65, v94, v95
v_mfma_f32_16x16x32_bf16 v[80:83], a[48:51], a[128:131], v[36:39]
s_waitcnt lgkmcnt(2)
v_cvt_pk_bf16_f32 v245, v246, v247
v_accvgpr_write_b32 a248, v240
v_exp_f32 v96, v96
v_mfma_f32_16x16x32_bf16 v[80:83], a[52:55], a[132:135], v[80:83]
s_waitcnt lgkmcnt(1)
v_accvgpr_write_b32 a249, v241
v_mul_f32 v252, s54, v252
v_exp_f32 v97, v97
v_mfma_f32_16x16x32_bf16 v[80:83], a[56:59], a[136:139], v[80:83]
s_waitcnt lgkmcnt(0)
v_mul_f32 v253, s54, v253
v_mul_f32 v254, s54, v254
v_mul_f32 v255, s54, v255
v_cvt_pk_bf16_f32 v248, v248, v249
v_cvt_pk_bf16_f32 v66, v96, v97
v_mfma_f32_16x16x32_bf16 v[80:83], a[60:63], a[140:143], v[80:83]
v_cvt_pk_bf16_f32 v249, v250, v251
v_accvgpr_write_b32 a250, v244
v_exp_f32 v98, v98
v_mfma_f32_16x16x32_bf16 v[216:219], a[112:115], v[52:55], 0
s_add_u32 m0, s49, 96
v_accvgpr_write_b32 a251, v245
v_cvt_pk_bf16_f32 v252, v252, v253
v_exp_f32 v99, v99
v_mfma_f32_16x16x32_bf16 v[216:219], a[116:119], v[56:59], v[216:219]
buffer_load_dwordx4 v1, s[12:15], s50 offen offset:3072 nt lds
v_cvt_pk_bf16_f32 v253, v254, v255
v_accvgpr_write_b32 a252, v248
v_mfma_f32_16x16x32_bf16 v[220:223], a[124:127], v[56:59], 0
v_accvgpr_write_b32 a253, v249
v_accvgpr_write_b32 a254, v252
v_accvgpr_write_b32 a255, v253
v_cvt_pk_bf16_f32 v67, v98, v99
v_mfma_f32_16x16x32_bf16 v[220:223], a[120:123], v[52:55], v[220:223]
v_mov_b32 v121, 0
v_and_b32 v7, 63, v0
v_min_u32 v7, 9, v7
s_mul_i32 s61, s40, 10
v_mfma_f32_16x16x32_bf16 v[28:31], v[16:19], v[52:55], 0
v_add_u32 v7, s61, v7
s_bfe_u32 s61, s2, 0x30003
v_lshl_add_u32 v7, v7, 3, s61
v_lshlrev_b32 v13, 7, v7
v_mfma_f32_16x16x32_bf16 v[28:31], v[16:19], v[56:59], v[28:31]
v_add_u32 v7, (C_LAST - K1_PC), v13
v_min_u32 v7, (LOOP_B - K1_PC - 4), v7
global_load_dword v125, v7, s[78:79]
v_mfma_f32_16x16x32_bf16 v[84:87], a[0:3], a[144:147], v[40:43]
v_exp_f32 v68, v68
v_mfma_f32_16x16x32_bf16 v[84:87], a[4:7], a[148:151], v[84:87]
v_exp_f32 v69, v69
v_mfma_f32_16x16x32_bf16 v[84:87], a[8:11], a[152:155], v[84:87]
v_cvt_pk_bf16_f32 v52, v68, v69
v_mfma_f32_16x16x32_bf16 v[84:87], a[12:15], a[156:159], v[84:87]
v_exp_f32 v70, v70
v_mfma_f32_16x16x32_bf16 v[224:227], a[64:67], v[60:63], 0
s_add_u32 m0, s49, 67584
v_exp_f32 v71, v71
v_mfma_f32_16x16x32_bf16 v[224:227], a[68:71], v[64:67], v[224:227]
buffer_load_dwordx4 v1, s[16:19], s50 offen offset:0 nt lds
v_mfma_f32_16x16x32_bf16 v[228:231], a[76:79], v[64:67], 0
v_cvt_pk_bf16_f32 v53, v70, v71
v_mfma_f32_16x16x32_bf16 v[228:231], a[72:75], v[60:63], v[228:231]
ds_read_b64_tr_b16 a[64:65], v5 offset:0
v_mfma_f32_16x16x32_bf16 v[88:91], a[16:19], a[144:147], v[40:43]
v_exp_f32 v72, v72
v_mfma_f32_16x16x32_bf16 v[88:91], a[20:23], a[148:151], v[88:91]
ds_read_b64_tr_b16 a[66:67], v5 offset:256
ds_read_b64_tr_b16 a[68:69], v5 offset:512
v_mfma_f32_16x16x32_bf16 v[88:91], a[24:27], a[152:155], v[88:91]
v_exp_f32 v73, v73
v_mfma_f32_16x16x32_bf16 v[88:91], a[28:31], a[156:159], v[88:91]
ds_read_b64_tr_b16 a[70:71], v5 offset:768
v_cvt_pk_bf16_f32 v54, v72, v73
v_mfma_f32_16x16x32_bf16 v[232:235], a[80:83], v[60:63], 0
v_exp_f32 v74, v74
v_mfma_f32_16x16x32_bf16 v[232:235], a[84:87], v[64:67], v[232:235]
ds_read_b64_tr_b16 a[72:73], v5 offset:32
ds_read_b64_tr_b16 a[74:75], v5 offset:288
v_mfma_f32_16x16x32_bf16 v[236:239], a[92:95], v[64:67], 0
v_exp_f32 v75, v75
v_mfma_f32_16x16x32_bf16 v[236:239], a[88:91], v[60:63], v[236:239]
ds_read_b64_tr_b16 a[76:77], v5 offset:544
v_cvt_pk_bf16_f32 v55, v74, v75
v_mfma_f32_16x16x32_bf16 v[92:95], a[32:35], a[144:147], v[40:43]
v_exp_f32 v76, v76
v_mfma_f32_16x16x32_bf16 v[92:95], a[36:39], a[148:151], v[92:95]
ds_read_b64_tr_b16 a[78:79], v5 offset:800
ds_read_b64_tr_b16 a[80:81], v5 offset:64
v_mfma_f32_16x16x32_bf16 v[92:95], a[40:43], a[152:155], v[92:95]
v_exp_f32 v77, v77
v_mfma_f32_16x16x32_bf16 v[92:95], a[44:47], a[156:159], v[92:95]
ds_read_b64_tr_b16 a[82:83], v5 offset:320
v_cvt_pk_bf16_f32 v56, v76, v77
v_mfma_f32_16x16x32_bf16 v[240:243], a[96:99], v[60:63], 0
v_exp_f32 v78, v78
v_mfma_f32_16x16x32_bf16 v[240:243], a[100:103], v[64:67], v[240:243]
ds_read_b64_tr_b16 a[84:85], v5 offset:576
ds_read_b64_tr_b16 a[86:87], v5 offset:832
v_mfma_f32_16x16x32_bf16 v[244:247], a[108:111], v[64:67], 0
v_exp_f32 v79, v79
v_mfma_f32_16x16x32_bf16 v[244:247], a[104:107], v[60:63], v[244:247]
ds_read_b64_tr_b16 a[88:89], v5 offset:96
v_cvt_pk_bf16_f32 v57, v78, v79
v_mfma_f32_16x16x32_bf16 v[96:99], a[48:51], a[144:147], v[40:43]
v_exp_f32 v80, v80
v_mfma_f32_16x16x32_bf16 v[96:99], a[52:55], a[148:151], v[96:99]
ds_read_b64_tr_b16 a[90:91], v5 offset:352
ds_read_b64_tr_b16 a[92:93], v5 offset:608
v_mfma_f32_16x16x32_bf16 v[96:99], a[56:59], a[152:155], v[96:99]
v_exp_f32 v81, v81
v_mfma_f32_16x16x32_bf16 v[96:99], a[60:63], a[156:159], v[96:99]
ds_read_b64_tr_b16 a[94:95], v5 offset:864
v_cvt_pk_bf16_f32 v58, v80, v81
v_mfma_f32_16x16x32_bf16 v[248:251], a[112:115], v[60:63], 0
v_exp_f32 v82, v82
v_mfma_f32_16x16x32_bf16 v[248:251], a[116:119], v[64:67], v[248:251]
ds_read_b64_tr_b16 a[96:97], v5 offset:128
ds_read_b64_tr_b16 a[98:99], v5 offset:384
v_mfma_f32_16x16x32_bf16 v[252:255], a[124:127], v[64:67], 0
v_exp_f32 v83, v83
v_mfma_f32_16x16x32_bf16 v[252:255], a[120:123], v[60:63], v[252:255]
ds_read_b64_tr_b16 a[100:101], v5 offset:640
v_cvt_pk_bf16_f32 v59, v82, v83
v_mfma_f32_16x16x32_bf16 v[32:35], v[16:19], v[60:63], 0
ds_read_b64_tr_b16 a[102:103], v5 offset:896
ds_read_b64_tr_b16 a[104:105], v5 offset:160
v_mfma_f32_16x16x32_bf16 v[32:35], v[16:19], v[64:67], v[32:35]
ds_read_b64_tr_b16 a[106:107], v5 offset:416
ds_read_b64_tr_b16 a[108:109], v5 offset:672
s_mov_b32 s51, 14
LOOP_A:
v_mfma_f32_16x16x32_bf16 v[68:71], a[0:3], a[160:163], v[44:47]
v_exp_f32 v84, v84
v_mfma_f32_16x16x32_bf16 v[68:71], a[4:7], a[164:167], v[68:71]
ds_read_b64_tr_b16 a[110:111], v5 offset:928
ds_read_b64_tr_b16 a[112:113], v5 offset:192
v_mfma_f32_16x16x32_bf16 v[68:71], a[8:11], a[168:171], v[68:71]
v_exp_f32 v85, v85
v_mfma_f32_16x16x32_bf16 v[68:71], a[12:15], a[172:175], v[68:71]
s_waitcnt lgkmcnt(15)
ds_read_b64_tr_b16 a[114:115], v5 offset:448
v_cvt_pk_bf16_f32 v60, v84, v85
v_mfma_f32_16x16x32_bf16 v[128:131], a[64:67], v[52:55], v[128:131]
v_exp_f32 v86, v86
v_mfma_f32_16x16x32_bf16 v[128:131], a[68:71], v[56:59], v[128:131]
ds_read_b64_tr_b16 a[116:117], v5 offset:704
ds_read_b64_tr_b16 a[118:119], v5 offset:960
v_mfma_f32_16x16x32_bf16 v[132:135], a[76:79], v[56:59], v[132:135]
v_exp_f32 v87, v87
v_mfma_f32_16x16x32_bf16 v[132:135], a[72:75], v[52:55], v[132:135]
ds_read_b64_tr_b16 a[120:121], v5 offset:224
v_cvt_pk_bf16_f32 v61, v86, v87
v_mfma_f32_16x16x32_bf16 v[72:75], a[16:19], a[160:163], v[44:47]
v_exp_f32 v88, v88
v_mfma_f32_16x16x32_bf16 v[72:75], a[20:23], a[164:167], v[72:75]
ds_read_b64_tr_b16 a[122:123], v5 offset:480
ds_read_b64_tr_b16 a[124:125], v5 offset:736
v_mfma_f32_16x16x32_bf16 v[72:75], a[24:27], a[168:171], v[72:75]
v_exp_f32 v89, v89
v_mfma_f32_16x16x32_bf16 v[72:75], a[28:31], a[172:175], v[72:75]
s_waitcnt lgkmcnt(15)
ds_read_b64_tr_b16 a[126:127], v5 offset:992
v_cvt_pk_bf16_f32 v62, v88, v89
v_mfma_f32_16x16x32_bf16 v[136:139], a[80:83], v[52:55], v[136:139]
s_add_u32 m0, s49, 67616
v_exp_f32 v90, v90
v_mfma_f32_16x16x32_bf16 v[136:139], a[84:87], v[56:59], v[136:139]
buffer_load_dwordx4 v1, s[16:19], s50 offen offset:1024 nt lds
v_mfma_f32_16x16x32_bf16 v[140:143], a[92:95], v[56:59], v[140:143]
v_exp_f32 v91, v91
v_mfma_f32_16x16x32_bf16 v[140:143], a[88:91], v[52:55], v[140:143]
v_cvt_pk_bf16_f32 v63, v90, v91
v_mfma_f32_16x16x32_bf16 v[76:79], a[32:35], a[160:163], v[44:47]
v_exp_f32 v92, v92
v_mfma_f32_16x16x32_bf16 v[76:79], a[36:39], a[164:167], v[76:79]
v_exp_f32 v93, v93
v_mfma_f32_16x16x32_bf16 v[76:79], a[40:43], a[168:171], v[76:79]
v_cvt_pk_bf16_f32 v64, v92, v93
v_mfma_f32_16x16x32_bf16 v[76:79], a[44:47], a[172:175], v[76:79]
s_waitcnt lgkmcnt(12)
v_exp_f32 v94, v94
v_mfma_f32_16x16x32_bf16 v[144:147], a[96:99], v[52:55], v[144:147]
s_add_u32 m0, s49, 67648
v_exp_f32 v95, v95
v_mfma_f32_16x16x32_bf16 v[144:147], a[100:103], v[56:59], v[144:147]
s_waitcnt lgkmcnt(8)
buffer_load_dwordx4 v1, s[16:19], s50 offen offset:2048 nt lds
v_mfma_f32_16x16x32_bf16 v[148:151], a[108:111], v[56:59], v[148:151]
v_cvt_pk_bf16_f32 v65, v94, v95
v_mfma_f32_16x16x32_bf16 v[148:151], a[104:107], v[52:55], v[148:151]
v_exp_f32 v96, v96
v_mfma_f32_16x16x32_bf16 v[80:83], a[48:51], a[160:163], v[44:47]
v_exp_f32 v97, v97
v_mfma_f32_16x16x32_bf16 v[80:83], a[52:55], a[164:167], v[80:83]
v_cvt_pk_bf16_f32 v66, v96, v97
v_mfma_f32_16x16x32_bf16 v[80:83], a[56:59], a[168:171], v[80:83]
v_exp_f32 v98, v98
v_mfma_f32_16x16x32_bf16 v[80:83], a[60:63], a[172:175], v[80:83]
s_waitcnt lgkmcnt(4)
v_exp_f32 v99, v99
v_mfma_f32_16x16x32_bf16 v[152:155], a[112:115], v[52:55], v[152:155]
s_add_u32 m0, s49, 67680
v_cvt_pk_bf16_f32 v67, v98, v99
v_mfma_f32_16x16x32_bf16 v[152:155], a[116:119], v[56:59], v[152:155]
s_waitcnt lgkmcnt(0)
buffer_load_dwordx4 v1, s[16:19], s50 offen offset:3072 nt lds
v_mfma_f32_16x16x32_bf16 v[156:159], a[124:127], v[56:59], v[156:159]
s_mov_b32 s57, s47
v_mfma_f32_16x16x32_bf16 v[156:159], a[120:123], v[52:55], v[156:159]
s_mov_b32 s47, s48
v_mfma_f32_16x16x32_bf16 v[20:23], v[16:19], v[52:55], v[20:23]
s_add_u32 s50, s50, 16384
v_mfma_f32_16x16x32_bf16 v[20:23], v[16:19], v[56:59], v[20:23]
v_mfma_f32_16x16x32_bf16 v[84:87], a[0:3], a[176:179], v[48:51]
s_add_u32 s48, s47, 16896
v_exp_f32 v68, v68
v_mfma_f32_16x16x32_bf16 v[84:87], a[4:7], a[180:183], v[84:87]
s_cmp_eq_u32 s48, 67584
v_exp_f32 v69, v69
v_mfma_f32_16x16x32_bf16 v[84:87], a[8:11], a[184:187], v[84:87]
s_cselect_b32 s48, 0, s48
v_cvt_pk_bf16_f32 v52, v68, v69
v_mfma_f32_16x16x32_bf16 v[84:87], a[12:15], a[188:191], v[84:87]
s_waitcnt vmcnt(8)
v_add_u32 v4, s48, v2
v_mfma_f32_16x16x32_bf16 v[160:163], a[64:67], v[60:63], v[160:163]
s_barrier
v_exp_f32 v70, v70
v_mfma_f32_16x16x32_bf16 v[160:163], a[68:71], v[64:67], v[160:163]
ds_read_b128 a[0:3], v4 offset:0
v_mfma_f32_16x16x32_bf16 v[164:167], a[76:79], v[64:67], v[164:167]
s_add_u32 s49, s57, s43
v_exp_f32 v71, v71
v_mfma_f32_16x16x32_bf16 v[164:167], a[72:75], v[60:63], v[164:167]
ds_read_b128 a[4:7], v4 offset:64
v_cvt_pk_bf16_f32 v53, v70, v71
v_mfma_f32_16x16x32_bf16 v[88:91], a[16:19], a[176:179], v[48:51]
v_exp_f32 v72, v72
v_mfma_f32_16x16x32_bf16 v[88:91], a[20:23], a[180:183], v[88:91]
ds_read_b128 a[8:11], v4 offset:128
v_mfma_f32_16x16x32_bf16 v[88:91], a[24:27], a[184:187], v[88:91]
v_exp_f32 v73, v73
v_mfma_f32_16x16x32_bf16 v[88:91], a[28:31], a[188:191], v[88:91]
ds_read_b128 a[12:15], v4 offset:192
v_cvt_pk_bf16_f32 v54, v72, v73
v_mfma_f32_16x16x32_bf16 v[168:171], a[80:83], v[60:63], v[168:171]
v_exp_f32 v74, v74
v_mfma_f32_16x16x32_bf16 v[168:171], a[84:87], v[64:67], v[168:171]
ds_read_b128 a[16:19], v4 offset:256
v_mfma_f32_16x16x32_bf16 v[172:175], a[92:95], v[64:67], v[172:175]
v_exp_f32 v75, v75
v_mfma_f32_16x16x32_bf16 v[172:175], a[88:91], v[60:63], v[172:175]
ds_read_b128 a[20:23], v4 offset:320
v_cvt_pk_bf16_f32 v55, v74, v75
v_mfma_f32_16x16x32_bf16 v[92:95], a[32:35], a[176:179], v[48:51]
v_exp_f32 v76, v76
v_mfma_f32_16x16x32_bf16 v[92:95], a[36:39], a[180:183], v[92:95]
ds_read_b128 a[24:27], v4 offset:384
v_mfma_f32_16x16x32_bf16 v[92:95], a[40:43], a[184:187], v[92:95]
v_exp_f32 v77, v77
v_mfma_f32_16x16x32_bf16 v[92:95], a[44:47], a[188:191], v[92:95]
ds_read_b128 a[28:31], v4 offset:448
v_cvt_pk_bf16_f32 v56, v76, v77
v_mfma_f32_16x16x32_bf16 v[176:179], a[96:99], v[60:63], v[176:179]
v_exp_f32 v78, v78
v_mfma_f32_16x16x32_bf16 v[176:179], a[100:103], v[64:67], v[176:179]
ds_read_b128 a[32:35], v4 offset:512
v_mfma_f32_16x16x32_bf16 v[180:183], a[108:111], v[64:67], v[180:183]
v_exp_f32 v79, v79
v_mfma_f32_16x16x32_bf16 v[180:183], a[104:107], v[60:63], v[180:183]
ds_read_b128 a[36:39], v4 offset:576
v_cvt_pk_bf16_f32 v57, v78, v79
v_mfma_f32_16x16x32_bf16 v[96:99], a[48:51], a[176:179], v[48:51]
v_exp_f32 v80, v80
v_mfma_f32_16x16x32_bf16 v[96:99], a[52:55], a[180:183], v[96:99]
ds_read_b128 a[40:43], v4 offset:640
v_mfma_f32_16x16x32_bf16 v[96:99], a[56:59], a[184:187], v[96:99]
v_exp_f32 v81, v81
v_mfma_f32_16x16x32_bf16 v[96:99], a[60:63], a[188:191], v[96:99]
ds_read_b128 a[44:47], v4 offset:704
v_cvt_pk_bf16_f32 v58, v80, v81
v_mfma_f32_16x16x32_bf16 v[184:187], a[112:115], v[60:63], v[184:187]
v_exp_f32 v82, v82
v_mfma_f32_16x16x32_bf16 v[184:187], a[116:119], v[64:67], v[184:187]
ds_read_b128 a[48:51], v4 offset:768
v_mfma_f32_16x16x32_bf16 v[188:191], a[124:127], v[64:67], v[188:191]
v_exp_f32 v83, v83
v_mfma_f32_16x16x32_bf16 v[188:191], a[120:123], v[60:63], v[188:191]
ds_read_b128 a[52:55], v4 offset:832
v_cvt_pk_bf16_f32 v59, v82, v83
v_mfma_f32_16x16x32_bf16 v[24:27], v[16:19], v[60:63], v[24:27]
ds_read_b128 a[56:59], v4 offset:896
v_mfma_f32_16x16x32_bf16 v[24:27], v[16:19], v[64:67], v[24:27]
ds_read_b128 a[60:63], v4 offset:960
s_waitcnt lgkmcnt(15)
v_mfma_f32_16x16x32_bf16 v[68:71], a[0:3], a[128:131], v[36:39]
s_waitcnt lgkmcnt(14)
v_exp_f32 v84, v84
v_mfma_f32_16x16x32_bf16 v[68:71], a[4:7], a[132:135], v[68:71]
s_waitcnt lgkmcnt(13)
v_add_u32 v5, s48, v3
v_mfma_f32_16x16x32_bf16 v[68:71], a[8:11], a[136:139], v[68:71]
s_waitcnt lgkmcnt(12)
v_exp_f32 v85, v85
v_mfma_f32_16x16x32_bf16 v[68:71], a[12:15], a[140:143], v[68:71]
v_cvt_pk_bf16_f32 v60, v84, v85
v_mfma_f32_16x16x32_bf16 v[192:195], a[64:67], v[52:55], v[192:195]
s_add_u32 m0, s49, 0
v_exp_f32 v86, v86
v_mfma_f32_16x16x32_bf16 v[192:195], a[68:71], v[56:59], v[192:195]
buffer_load_dwordx4 v1, s[12:15], s50 offen offset:0 nt lds
v_mfma_f32_16x16x32_bf16 v[196:199], a[76:79], v[56:59], v[196:199]
v_exp_f32 v87, v87
v_mfma_f32_16x16x32_bf16 v[196:199], a[72:75], v[52:55], v[196:199]
s_waitcnt lgkmcnt(11)
v_cvt_pk_bf16_f32 v61, v86, v87
v_mfma_f32_16x16x32_bf16 v[72:75], a[16:19], a[128:131], v[36:39]
s_waitcnt lgkmcnt(10)
v_exp_f32 v88, v88
v_mfma_f32_16x16x32_bf16 v[72:75], a[20:23], a[132:135], v[72:75]
s_waitcnt lgkmcnt(9)
v_exp_f32 v89, v89
v_mfma_f32_16x16x32_bf16 v[72:75], a[24:27], a[136:139], v[72:75]
s_waitcnt lgkmcnt(8)
v_cvt_pk_bf16_f32 v62, v88, v89
v_mfma_f32_16x16x32_bf16 v[72:75], a[28:31], a[140:143], v[72:75]
v_exp_f32 v90, v90
v_mfma_f32_16x16x32_bf16 v[200:203], a[80:83], v[52:55], v[200:203]
s_add_u32 m0, s49, 32
v_exp_f32 v91, v91
v_mfma_f32_16x16x32_bf16 v[200:203], a[84:87], v[56:59], v[200:203]
buffer_load_dwordx4 v1, s[12:15], s50 offen offset:1024 nt lds
v_mfma_f32_16x16x32_bf16 v[204:207], a[92:95], v[56:59], v[204:207]
v_cvt_pk_bf16_f32 v63, v90, v91
v_mfma_f32_16x16x32_bf16 v[204:207], a[88:91], v[52:55], v[204:207]
s_waitcnt lgkmcnt(7)
v_exp_f32 v92, v92
v_mfma_f32_16x16x32_bf16 v[76:79], a[32:35], a[128:131], v[36:39]
s_waitcnt lgkmcnt(6)
v_exp_f32 v93, v93
v_mfma_f32_16x16x32_bf16 v[76:79], a[36:39], a[132:135], v[76:79]
s_waitcnt lgkmcnt(5)
v_cvt_pk_bf16_f32 v64, v92, v93
v_mfma_f32_16x16x32_bf16 v[76:79], a[40:43], a[136:139], v[76:79]
s_waitcnt lgkmcnt(4)
v_exp_f32 v94, v94
v_mfma_f32_16x16x32_bf16 v[76:79], a[44:47], a[140:143], v[76:79]
v_exp_f32 v95, v95
v_mfma_f32_16x16x32_bf16 v[208:211], a[96:99], v[52:55], v[208:211]
s_add_u32 m0, s49, 64
v_cvt_pk_bf16_f32 v65, v94, v95
v_mfma_f32_16x16x32_bf16 v[208:211], a[100:103], v[56:59], v[208:211]
buffer_load_dwordx4 v1, s[12:15], s50 offen offset:2048 nt lds
v_mfma_f32_16x16x32_bf16 v[212:215], a[108:111], v[56:59], v[212:215]
v_exp_f32 v96, v96
v_mfma_f32_16x16x32_bf16 v[212:215], a[104:107], v[52:55], v[212:215]
s_waitcnt lgkmcnt(3)
v_exp_f32 v97, v97
v_mfma_f32_16x16x32_bf16 v[80:83], a[48:51], a[128:131], v[36:39]
s_waitcnt lgkmcnt(2)
v_cvt_pk_bf16_f32 v66, v96, v97
v_mfma_f32_16x16x32_bf16 v[80:83], a[52:55], a[132:135], v[80:83]
s_waitcnt lgkmcnt(1)
v_exp_f32 v98, v98
v_mfma_f32_16x16x32_bf16 v[80:83], a[56:59], a[136:139], v[80:83]
s_waitcnt lgkmcnt(0)
v_exp_f32 v99, v99
v_mfma_f32_16x16x32_bf16 v[80:83], a[60:63], a[140:143], v[80:83]
v_cvt_pk_bf16_f32 v67, v98, v99
v_mfma_f32_16x16x32_bf16 v[216:219], a[112:115], v[52:55], v[216:219]
s_add_u32 m0, s49, 96
v_mfma_f32_16x16x32_bf16 v[216:219], a[116:119], v[56:59], v[216:219]
buffer_load_dwordx4 v1, s[12:15], s50 offen offset:3072 nt lds
v_mfma_f32_16x16x32_bf16 v[220:223], a[124:127], v[56:59], v[220:223]
v_mfma_f32_16x16x32_bf16 v[220:223], a[120:123], v[52:55], v[220:223]
v_mfma_f32_16x16x32_bf16 v[28:31], v[16:19], v[52:55], v[28:31]
v_mfma_f32_16x16x32_bf16 v[28:31], v[16:19], v[56:59], v[28:31]
v_mfma_f32_16x16x32_bf16 v[84:87], a[0:3], a[144:147], v[40:43]
v_exp_f32 v68, v68
v_mfma_f32_16x16x32_bf16 v[84:87], a[4:7], a[148:151], v[84:87]
v_exp_f32 v69, v69
v_mfma_f32_16x16x32_bf16 v[84:87], a[8:11], a[152:155], v[84:87]
v_cvt_pk_bf16_f32 v52, v68, v69
v_mfma_f32_16x16x32_bf16 v[84:87], a[12:15], a[156:159], v[84:87]
v_exp_f32 v70, v70
v_mfma_f32_16x16x32_bf16 v[224:227], a[64:67], v[60:63], v[224:227]
s_add_u32 m0, s49, 67584
v_exp_f32 v71, v71
v_mfma_f32_16x16x32_bf16 v[224:227], a[68:71], v[64:67], v[224:227]
buffer_load_dwordx4 v1, s[16:19], s50 offen offset:0 nt lds
v_mfma_f32_16x16x32_bf16 v[228:231], a[76:79], v[64:67], v[228:231]
v_cvt_pk_bf16_f32 v53, v70, v71
v_mfma_f32_16x16x32_bf16 v[228:231], a[72:75], v[60:63], v[228:231]
ds_read_b64_tr_b16 a[64:65], v5 offset:0
v_mfma_f32_16x16x32_bf16 v[88:91], a[16:19], a[144:147], v[40:43]
v_exp_f32 v72, v72
v_mfma_f32_16x16x32_bf16 v[88:91], a[20:23], a[148:151], v[88:91]
ds_read_b64_tr_b16 a[66:67], v5 offset:256
ds_read_b64_tr_b16 a[68:69], v5 offset:512
v_mfma_f32_16x16x32_bf16 v[88:91], a[24:27], a[152:155], v[88:91]
v_exp_f32 v73, v73
v_mfma_f32_16x16x32_bf16 v[88:91], a[28:31], a[156:159], v[88:91]
ds_read_b64_tr_b16 a[70:71], v5 offset:768
v_cvt_pk_bf16_f32 v54, v72, v73
v_mfma_f32_16x16x32_bf16 v[232:235], a[80:83], v[60:63], v[232:235]
v_exp_f32 v74, v74
v_mfma_f32_16x16x32_bf16 v[232:235], a[84:87], v[64:67], v[232:235]
ds_read_b64_tr_b16 a[72:73], v5 offset:32
ds_read_b64_tr_b16 a[74:75], v5 offset:288
v_mfma_f32_16x16x32_bf16 v[236:239], a[92:95], v[64:67], v[236:239]
v_exp_f32 v75, v75
v_mfma_f32_16x16x32_bf16 v[236:239], a[88:91], v[60:63], v[236:239]
ds_read_b64_tr_b16 a[76:77], v5 offset:544
v_cvt_pk_bf16_f32 v55, v74, v75
v_mfma_f32_16x16x32_bf16 v[92:95], a[32:35], a[144:147], v[40:43]
v_exp_f32 v76, v76
v_mfma_f32_16x16x32_bf16 v[92:95], a[36:39], a[148:151], v[92:95]
ds_read_b64_tr_b16 a[78:79], v5 offset:800
ds_read_b64_tr_b16 a[80:81], v5 offset:64
v_mfma_f32_16x16x32_bf16 v[92:95], a[40:43], a[152:155], v[92:95]
v_exp_f32 v77, v77
v_mfma_f32_16x16x32_bf16 v[92:95], a[44:47], a[156:159], v[92:95]
ds_read_b64_tr_b16 a[82:83], v5 offset:320
v_cvt_pk_bf16_f32 v56, v76, v77
v_mfma_f32_16x16x32_bf16 v[240:243], a[96:99], v[60:63], v[240:243]
v_exp_f32 v78, v78
v_mfma_f32_16x16x32_bf16 v[240:243], a[100:103], v[64:67], v[240:243]
ds_read_b64_tr_b16 a[84:85], v5 offset:576
ds_read_b64_tr_b16 a[86:87], v5 offset:832
v_mfma_f32_16x16x32_bf16 v[244:247], a[108:111], v[64:67], v[244:247]
v_exp_f32 v79, v79
v_mfma_f32_16x16x32_bf16 v[244:247], a[104:107], v[60:63], v[244:247]
ds_read_b64_tr_b16 a[88:89], v5 offset:96
v_cvt_pk_bf16_f32 v57, v78, v79
v_mfma_f32_16x16x32_bf16 v[96:99], a[48:51], a[144:147], v[40:43]
v_exp_f32 v80, v80
v_mfma_f32_16x16x32_bf16 v[96:99], a[52:55], a[148:151], v[96:99]
ds_read_b64_tr_b16 a[90:91], v5 offset:352
ds_read_b64_tr_b16 a[92:93], v5 offset:608
v_mfma_f32_16x16x32_bf16 v[96:99], a[56:59], a[152:155], v[96:99]
v_exp_f32 v81, v81
v_mfma_f32_16x16x32_bf16 v[96:99], a[60:63], a[156:159], v[96:99]
ds_read_b64_tr_b16 a[94:95], v5 offset:864
v_cvt_pk_bf16_f32 v58, v80, v81
v_mfma_f32_16x16x32_bf16 v[248:251], a[112:115], v[60:63], v[248:251]
v_exp_f32 v82, v82
v_mfma_f32_16x16x32_bf16 v[248:251], a[116:119], v[64:67], v[248:251]
ds_read_b64_tr_b16 a[96:97], v5 offset:128
ds_read_b64_tr_b16 a[98:99], v5 offset:384
v_mfma_f32_16x16x32_bf16 v[252:255], a[124:127], v[64:67], v[252:255]
v_exp_f32 v83, v83
v_mfma_f32_16x16x32_bf16 v[252:255], a[120:123], v[60:63], v[252:255]
ds_read_b64_tr_b16 a[100:101], v5 offset:640
v_cvt_pk_bf16_f32 v59, v82, v83
v_mfma_f32_16x16x32_bf16 v[32:35], v[16:19], v[60:63], v[32:35]
s_sub_u32 s51, s51, 1
ds_read_b64_tr_b16 a[102:103], v5 offset:896
ds_read_b64_tr_b16 a[104:105], v5 offset:160
v_mfma_f32_16x16x32_bf16 v[32:35], v[16:19], v[64:67], v[32:35]
s_cmp_lg_u32 s51, 0
ds_read_b64_tr_b16 a[106:107], v5 offset:416
ds_read_b64_tr_b16 a[108:109], v5 offset:672
s_cbranch_scc1 LOOP_A
C_LAST:
v_mfma_f32_16x16x32_bf16 v[68:71], a[0:3], a[160:163], v[44:47]
v_exp_f32 v84, v84
v_mfma_f32_16x16x32_bf16 v[68:71], a[4:7], a[164:167], v[68:71]
ds_read_b64_tr_b16 a[110:111], v5 offset:928
ds_read_b64_tr_b16 a[112:113], v5 offset:192
v_mfma_f32_16x16x32_bf16 v[68:71], a[8:11], a[168:171], v[68:71]
v_exp_f32 v85, v85
v_mfma_f32_16x16x32_bf16 v[68:71], a[12:15], a[172:175], v[68:71]
s_waitcnt lgkmcnt(15)
ds_read_b64_tr_b16 a[114:115], v5 offset:448
v_cvt_pk_bf16_f32 v60, v84, v85
v_mfma_f32_16x16x32_bf16 v[128:131], a[64:67], v[52:55], v[128:131]
s_add_u32 s4, s32, s26
s_addc_u32 s5, s33, 0
v_exp_f32 v86, v86
v_mfma_f32_16x16x32_bf16 v[128:131], a[68:71], v[56:59], v[128:131]
ds_read_b64_tr_b16 a[116:117], v5 offset:704
ds_read_b64_tr_b16 a[118:119], v5 offset:960
s_mov_b32 s6, 1048576
v_mfma_f32_16x16x32_bf16 v[132:135], a[76:79], v[56:59], v[132:135]
s_mov_b32 s7, 0x20000
v_exp_f32 v87, v87
v_mfma_f32_16x16x32_bf16 v[132:135], a[72:75], v[52:55], v[132:135]
ds_read_b64_tr_b16 a[120:121], v5 offset:224
s_add_u32 s8, s36, s27
s_addc_u32 s9, s37, 0
v_cvt_pk_bf16_f32 v61, v86, v87
v_mfma_f32_16x16x32_bf16 v[72:75], a[16:19], a[160:163], v[44:47]
s_sub_u32 s10, 0x200000, s27
s_mov_b32 s11, 0x20000
v_exp_f32 v88, v88
v_mfma_f32_16x16x32_bf16 v[72:75], a[20:23], a[164:167], v[72:75]
ds_read_b64_tr_b16 a[122:123], v5 offset:480
ds_read_b64_tr_b16 a[124:125], v5 offset:736
s_lshl_b32 s61, s40, 13
v_mfma_f32_16x16x32_bf16 v[72:75], a[24:27], a[168:171], v[72:75]
s_lshl_b32 s62, s92, 15
v_exp_f32 v89, v89
v_mfma_f32_16x16x32_bf16 v[72:75], a[28:31], a[172:175], v[72:75]
s_waitcnt lgkmcnt(15)
ds_read_b64_tr_b16 a[126:127], v5 offset:992
s_add_u32 s61, s61, s62
v_cvt_pk_bf16_f32 v62, v88, v89
v_mfma_f32_16x16x32_bf16 v[136:139], a[80:83], v[52:55], v[136:139]
s_add_u32 m0, s49, 67616
v_add_u32 v116, s61, v1
v_exp_f32 v90, v90
v_mfma_f32_16x16x32_bf16 v[136:139], a[84:87], v[56:59], v[136:139]
buffer_load_dwordx4 v1, s[16:19], s50 offen offset:1024 nt lds
v_add_u32 v117, 4096, v116
v_mfma_f32_16x16x32_bf16 v[140:143], a[92:95], v[56:59], v[140:143]
v_bfe_u32 v7, v0, 5, 1
v_exp_f32 v91, v91
v_mfma_f32_16x16x32_bf16 v[140:143], a[88:91], v[52:55], v[140:143]
v_bfe_u32 v8, v0, 4, 1
v_lshlrev_b32 v7, 5, v7
v_cvt_pk_bf16_f32 v63, v90, v91
v_mfma_f32_16x16x32_bf16 v[76:79], a[32:35], a[160:163], v[44:47]
v_lshl_add_u32 v7, v8, 4, v7
v_exp_f32 v92, v92
v_mfma_f32_16x16x32_bf16 v[76:79], a[36:39], a[164:167], v[76:79]
v_bfe_u32 v8, v0, 7, 1
v_exp_f32 v93, v93
v_mfma_f32_16x16x32_bf16 v[76:79], a[40:43], a[168:171], v[76:79]
v_lshl_add_u32 v7, v8, 6, v7
v_bfe_u32 v8, v0, 6, 1
v_lshl_add_u32 v7, v8, 3, v7
v_cvt_pk_bf16_f32 v64, v92, v93
v_mfma_f32_16x16x32_bf16 v[76:79], a[44:47], a[172:175], v[76:79]
s_waitcnt lgkmcnt(12)
v_and_b32 v8, 15, v0
v_exp_f32 v94, v94
v_mfma_f32_16x16x32_bf16 v[144:147], a[96:99], v[52:55], v[144:147]
s_add_u32 m0, s49, 67648
v_lshlrev_b32 v8, 4, v8
v_exp_f32 v95, v95
v_mfma_f32_16x16x32_bf16 v[144:147], a[100:103], v[56:59], v[144:147]
s_waitcnt lgkmcnt(8)
buffer_load_dwordx4 v1, s[16:19], s50 offen offset:2048 nt lds
v_lshl_add_u32 v118, v7, 10, v8
v_mfma_f32_16x16x32_bf16 v[148:151], a[108:111], v[56:59], v[148:151]
v_add_u32 v119, 4096, v118
v_and_b32 v7, 63, v0
v_cvt_pk_bf16_f32 v65, v94, v95
v_mfma_f32_16x16x32_bf16 v[148:151], a[104:107], v[52:55], v[148:151]
v_cmp_gt_u32 vcc, 64, v7
v_exp_f32 v96, v96
v_mfma_f32_16x16x32_bf16 v[80:83], a[48:51], a[160:163], v[44:47]
s_mul_i32 s61, s40, 64
v_exp_f32 v97, v97
v_mfma_f32_16x16x32_bf16 v[80:83], a[52:55], a[164:167], v[80:83]
s_waitcnt lgkmcnt(4)
v_add_u32 v7, s61, v7
v_lshlrev_b32 v7, 7, v7
v_cvt_pk_bf16_f32 v66, v96, v97
v_mfma_f32_16x16x32_bf16 v[80:83], a[56:59], a[168:171], v[80:83]
s_lshr_b32 s61, s2, 3
v_exp_f32 v98, v98
v_mfma_f32_16x16x32_bf16 v[80:83], a[60:63], a[172:175], v[80:83]
s_lshl_b32 s61, s61, 16
v_exp_f32 v99, v99
v_mfma_f32_16x16x32_bf16 v[152:155], a[112:115], v[52:55], v[152:155]
s_add_u32 m0, s49, 67680
v_add_u32 v7, s61, v7
v_mov_b32 v8, 0x40000000
v_cndmask_b32 v124, v8, v7, vcc
v_cvt_pk_bf16_f32 v67, v98, v99
v_mfma_f32_16x16x32_bf16 v[152:155], a[116:119], v[56:59], v[152:155]
s_waitcnt lgkmcnt(0)
buffer_load_dwordx4 v1, s[16:19], s50 offen offset:3072 nt lds
s_mov_b32 s91, 0
v_mfma_f32_16x16x32_bf16 v[156:159], a[124:127], v[56:59], v[156:159]
s_mov_b32 s57, s47
s_mov_b32 s88, 0
s_mov_b32 s89, 0
s_mov_b32 s60, s40
v_mfma_f32_16x16x32_bf16 v[156:159], a[120:123], v[52:55], v[156:159]
s_mov_b32 s47, s48
s_mov_b64 s[24:25], s[20:21]
s_add_u32 s26, s40, 1
s_lshl_b32 s26, s26, 14
v_mfma_f32_16x16x32_bf16 v[20:23], v[16:19], v[52:55], v[20:23]
s_add_u32 s50, s50, 16384
s_mov_b32 s27, 0x20000
s_mov_b32 s72, 0
s_mov_b32 s73, 0
v_mfma_f32_16x16x32_bf16 v[20:23], v[16:19], v[56:59], v[20:23]
v_mov_b32 v10, 0x4b800000
s_lshl_b32 s61, s40, 14
v_add_u32 v6, s61, v1
v_mfma_f32_16x16x32_bf16 v[84:87], a[0:3], a[176:179], v[48:51]
s_add_u32 s48, s47, 16896
v_exp_f32 v68, v68
v_mfma_f32_16x16x32_bf16 v[84:87], a[4:7], a[180:183], v[84:87]
s_cmp_eq_u32 s48, 67584
v_exp_f32 v69, v69
v_mfma_f32_16x16x32_bf16 v[84:87], a[8:11], a[184:187], v[84:87]
s_cselect_b32 s48, 0, s48
v_cvt_pk_bf16_f32 v52, v68, v69
v_mfma_f32_16x16x32_bf16 v[84:87], a[12:15], a[188:191], v[84:87]
s_waitcnt vmcnt(8)
v_add_u32 v4, s48, v2
v_mfma_f32_16x16x32_bf16 v[160:163], a[64:67], v[60:63], v[160:163]
s_barrier
v_rcp_f32 v9, v20
v_exp_f32 v70, v70
v_mfma_f32_16x16x32_bf16 v[160:163], a[68:71], v[64:67], v[160:163]
ds_read_b128 a[0:3], v4 offset:0
v_cmp_nle_f32 vcc, v20, v10
v_mfma_f32_16x16x32_bf16 v[164:167], a[76:79], v[64:67], v[164:167]
s_add_u32 s49, s57, s43
s_cmp_lg_u64 vcc, 0
s_cselect_b32 s52, 1, 0
s_cselect_b64 s[58:59], 0, -1
s_or_b32 s56, s56, s52
v_exp_f32 v71, v71
v_mfma_f32_16x16x32_bf16 v[164:167], a[72:75], v[60:63], v[164:167]
ds_read_b128 a[4:7], v4 offset:64
s_mov_b32 s52, 0
v_cvt_pk_bf16_f32 v53, v70, v71
v_mfma_f32_16x16x32_bf16 v[88:91], a[16:19], a[176:179], v[48:51]
v_mul_f32 v128, v128, v9
v_exp_f32 v72, v72
v_mfma_f32_16x16x32_bf16 v[88:91], a[20:23], a[180:183], v[88:91]
ds_read_b128 a[8:11], v4 offset:128
v_mul_f32 v129, v129, v9
v_mul_f32 v130, v130, v9
v_mfma_f32_16x16x32_bf16 v[88:91], a[24:27], a[184:187], v[88:91]
v_mul_f32 v131, v131, v9
v_exp_f32 v73, v73
v_mfma_f32_16x16x32_bf16 v[88:91], a[28:31], a[188:191], v[88:91]
ds_read_b128 a[12:15], v4 offset:192
v_mul_f32 v132, v132, v9
v_cvt_pk_bf16_f32 v54, v72, v73
v_mfma_f32_16x16x32_bf16 v[168:171], a[80:83], v[60:63], v[168:171]
v_mul_f32 v133, v133, v9
v_exp_f32 v74, v74
v_mfma_f32_16x16x32_bf16 v[168:171], a[84:87], v[64:67], v[168:171]
ds_read_b128 a[16:19], v4 offset:256
v_mul_f32 v134, v134, v9
v_mul_f32 v135, v135, v9
v_mfma_f32_16x16x32_bf16 v[172:175], a[92:95], v[64:67], v[172:175]
v_cvt_pk_bf16_f32 v100, v128, v129
v_exp_f32 v75, v75
v_mfma_f32_16x16x32_bf16 v[172:175], a[88:91], v[60:63], v[172:175]
ds_read_b128 a[20:23], v4 offset:320
v_cvt_pk_bf16_f32 v101, v130, v131
v_cvt_pk_bf16_f32 v55, v74, v75
v_mfma_f32_16x16x32_bf16 v[92:95], a[32:35], a[176:179], v[48:51]
v_mul_f32 v136, v136, v9
v_exp_f32 v76, v76
v_mfma_f32_16x16x32_bf16 v[92:95], a[36:39], a[180:183], v[92:95]
ds_read_b128 a[24:27], v4 offset:384
v_mul_f32 v137, v137, v9
v_mul_f32 v138, v138, v9
v_mfma_f32_16x16x32_bf16 v[92:95], a[40:43], a[184:187], v[92:95]
v_mul_f32 v139, v139, v9
v_cvt_pk_bf16_f32 v102, v132, v133
v_exp_f32 v77, v77
v_mfma_f32_16x16x32_bf16 v[92:95], a[44:47], a[188:191], v[92:95]
ds_read_b128 a[28:31], v4 offset:448
v_cvt_pk_bf16_f32 v103, v134, v135
v_cvt_pk_bf16_f32 v56, v76, v77
v_mfma_f32_16x16x32_bf16 v[176:179], a[96:99], v[60:63], v[176:179]
v_mul_f32 v140, v140, v9
v_exp_f32 v78, v78
v_mfma_f32_16x16x32_bf16 v[176:179], a[100:103], v[64:67], v[176:179]
ds_read_b128 a[32:35], v4 offset:512
v_mul_f32 v141, v141, v9
v_mul_f32 v142, v142, v9
v_mfma_f32_16x16x32_bf16 v[180:183], a[108:111], v[64:67], v[180:183]
v_mul_f32 v143, v143, v9
v_exp_f32 v79, v79
v_mfma_f32_16x16x32_bf16 v[180:183], a[104:107], v[60:63], v[180:183]
ds_read_b128 a[36:39], v4 offset:576
v_cvt_pk_bf16_f32 v104, v136, v137
v_cvt_pk_bf16_f32 v57, v78, v79
v_mfma_f32_16x16x32_bf16 v[96:99], a[48:51], a[176:179], v[48:51]
v_cvt_pk_bf16_f32 v105, v138, v139
v_exp_f32 v80, v80
v_mfma_f32_16x16x32_bf16 v[96:99], a[52:55], a[180:183], v[96:99]
ds_read_b128 a[40:43], v4 offset:640
buffer_store_dwordx4 v[100:103], v6, s[20:23], s52 offen offset:0 sc1
v_mfma_f32_16x16x32_bf16 v[96:99], a[56:59], a[184:187], v[96:99]
v_mul_f32 v144, v144, v9
v_exp_f32 v81, v81
v_mfma_f32_16x16x32_bf16 v[96:99], a[60:63], a[188:191], v[96:99]
ds_read_b128 a[44:47], v4 offset:704
v_mul_f32 v145, v145, v9
v_cvt_pk_bf16_f32 v58, v80, v81
v_mfma_f32_16x16x32_bf16 v[184:187], a[112:115], v[60:63], v[184:187]
v_mul_f32 v146, v146, v9
v_exp_f32 v82, v82
v_mfma_f32_16x16x32_bf16 v[184:187], a[116:119], v[64:67], v[184:187]
ds_read_b128 a[48:51], v4 offset:768
v_mul_f32 v147, v147, v9
v_cvt_pk_bf16_f32 v106, v140, v141
v_mfma_f32_16x16x32_bf16 v[188:191], a[124:127], v[64:67], v[188:191]
v_cvt_pk_bf16_f32 v107, v142, v143
v_exp_f32 v83, v83
v_mfma_f32_16x16x32_bf16 v[188:191], a[120:123], v[60:63], v[188:191]
ds_read_b128 a[52:55], v4 offset:832
v_mul_f32 v148, v148, v9
v_cvt_pk_bf16_f32 v59, v82, v83
v_mfma_f32_16x16x32_bf16 v[24:27], v[16:19], v[60:63], v[24:27]
ds_read_b128 a[56:59], v4 offset:896
v_mul_f32 v149, v149, v9
v_mul_f32 v150, v150, v9
v_mfma_f32_16x16x32_bf16 v[24:27], v[16:19], v[64:67], v[24:27]
ds_read_b128 a[60:63], v4 offset:960
v_mul_f32 v151, v151, v9
v_cvt_pk_bf16_f32 v108, v144, v145
s_waitcnt lgkmcnt(15)
v_mfma_f32_16x16x32_bf16 v[68:71], a[0:3], a[192:195], 0
s_waitcnt lgkmcnt(14)
v_exp_f32 v84, v84
v_mfma_f32_16x16x32_bf16 v[68:71], a[4:7], a[196:199], v[68:71]
s_waitcnt lgkmcnt(13)
v_add_u32 v5, s48, v3
v_mfma_f32_16x16x32_bf16 v[68:71], a[8:11], a[200:203], v[68:71]
s_waitcnt lgkmcnt(12)
v_exp_f32 v85, v85
v_mfma_f32_16x16x32_bf16 v[68:71], a[12:15], a[204:207], v[68:71]
v_cvt_pk_bf16_f32 v60, v84, v85
v_mfma_f32_16x16x32_bf16 v[192:195], a[64:67], v[52:55], v[192:195]
s_add_u32 m0, s49, 0
v_cvt_pk_bf16_f32 v109, v146, v147
v_exp_f32 v86, v86
v_mfma_f32_16x16x32_bf16 v[192:195], a[68:71], v[56:59], v[192:195]
buffer_load_dwordx4 v1, s[12:15], s50 offen offset:0 nt lds
buffer_store_dwordx4 v[104:107], v6, s[20:23], s52 offen offset:1024 sc1
v_mfma_f32_16x16x32_bf16 v[196:199], a[76:79], v[56:59], v[196:199]
v_mul_f32 v152, v152, v9
v_exp_f32 v87, v87
v_mfma_f32_16x16x32_bf16 v[196:199], a[72:75], v[52:55], v[196:199]
v_max3_f32 v11, v68, v69, v70
v_max_f32 v11, v11, v71
v_mul_f32 v153, v153, v9
v_mul_f32 v154, v154, v9
v_mfma_f32_16x16x32_bf16 v[200:203], a[80:83], v[52:55], v[200:203]
v_mov_b32 v12, v11
v_mul_f32 v155, v155, v9
v_cvt_pk_bf16_f32 v61, v86, v87
v_mfma_f32_16x16x32_bf16 v[200:203], a[84:87], v[56:59], v[200:203]
v_cvt_pk_bf16_f32 v110, v148, v149
v_exp_f32 v88, v88
v_mfma_f32_16x16x32_bf16 v[204:207], a[92:95], v[56:59], v[204:207]
v_permlane32_swap_b32 v11, v12
v_max_f32 v11, v11, v12
v_cvt_pk_bf16_f32 v111, v150, v151
v_mul_f32 v156, v156, v9
v_mfma_f32_16x16x32_bf16 v[204:207], a[88:91], v[52:55], v[204:207]
v_mov_b32 v12, v11
v_mul_f32 v157, v157, v9
v_mul_f32 v158, v158, v9
v_mfma_f32_16x16x32_bf16 v[208:211], a[96:99], v[52:55], v[208:211]
s_add_u32 m0, s49, 32
v_permlane16_swap_b32 v11, v12
v_mul_f32 v159, v159, v9
v_cvt_pk_bf16_f32 v112, v152, v153
v_cvt_pk_bf16_f32 v113, v154, v155
v_mfma_f32_16x16x32_bf16 v[208:211], a[100:103], v[56:59], v[208:211]
buffer_load_dwordx4 v1, s[12:15], s50 offen offset:1024 nt lds
v_max_f32 v11, v11, v12
v_sub_f32 v36, 0, v11
v_mfma_f32_16x16x32_bf16 v[212:215], a[108:111], v[56:59], v[212:215]
v_sub_f32 v37, 0, v11
v_sub_f32 v38, 0, v11
v_sub_f32 v39, 0, v11
v_mfma_f32_16x16x32_bf16 v[212:215], a[104:107], v[52:55], v[212:215]
s_waitcnt lgkmcnt(11)
buffer_store_dwordx4 v[108:111], v6, s[20:23], s52 offen offset:2048 sc1
v_exp_f32 v89, v89
v_mfma_f32_16x16x32_bf16 v[72:75], a[16:19], a[192:195], v[36:39]
s_waitcnt lgkmcnt(10)
v_cvt_pk_bf16_f32 v114, v156, v157
v_cvt_pk_bf16_f32 v62, v88, v89
v_mfma_f32_16x16x32_bf16 v[72:75], a[20:23], a[196:199], v[72:75]
s_waitcnt lgkmcnt(9)
v_cvt_pk_bf16_f32 v115, v158, v159
buffer_store_dwordx4 v[112:115], v6, s[20:23], s52 offen offset:3072 sc1
v_exp_f32 v90, v90
v_mfma_f32_16x16x32_bf16 v[72:75], a[24:27], a[200:203], v[72:75]
s_waitcnt lgkmcnt(8)
v_exp_f32 v91, v91
v_mfma_f32_16x16x32_bf16 v[72:75], a[28:31], a[204:207], v[72:75]
s_waitcnt lgkmcnt(6)
v_rcp_f32 v9, v24
v_cvt_pk_bf16_f32 v63, v90, v91
v_mfma_f32_16x16x32_bf16 v[76:79], a[32:35], a[192:195], v[36:39]
s_add_u32 m0, s49, 64
v_cmp_nle_f32 vcc, v24, v10
s_nop 0
s_cmp_lg_u64 vcc, 0
s_cselect_b32 s52, 2, 0
s_cselect_b64 s[58:59], 0, -1
s_or_b32 s56, s56, s52
v_exp_f32 v92, v92
v_mfma_f32_16x16x32_bf16 v[76:79], a[36:39], a[196:199], v[76:79]
s_waitcnt lgkmcnt(5)
buffer_load_dwordx4 v1, s[12:15], s50 offen offset:2048 nt lds
s_mov_b32 s52, 4096
v_mfma_f32_16x16x32_bf16 v[76:79], a[40:43], a[200:203], v[76:79]
s_waitcnt lgkmcnt(4)
v_mul_f32 v160, v160, v9
v_mul_f32 v161, v161, v9
v_exp_f32 v93, v93
v_mfma_f32_16x16x32_bf16 v[76:79], a[44:47], a[204:207], v[76:79]
s_waitcnt lgkmcnt(3)
v_mul_f32 v162, v162, v9
v_mul_f32 v163, v163, v9
v_cvt_pk_bf16_f32 v64, v92, v93
v_mfma_f32_16x16x32_bf16 v[80:83], a[48:51], a[192:195], v[36:39]
s_waitcnt lgkmcnt(2)
v_mul_f32 v164, v164, v9
v_exp_f32 v94, v94
v_mfma_f32_16x16x32_bf16 v[80:83], a[52:55], a[196:199], v[80:83]
s_waitcnt lgkmcnt(1)
v_mul_f32 v165, v165, v9
v_mul_f32 v166, v166, v9
v_exp_f32 v95, v95
v_mfma_f32_16x16x32_bf16 v[80:83], a[56:59], a[200:203], v[80:83]
s_waitcnt lgkmcnt(0)
v_mul_f32 v167, v167, v9
v_cvt_pk_bf16_f32 v100, v160, v161
v_cvt_pk_bf16_f32 v65, v94, v95
v_mfma_f32_16x16x32_bf16 v[80:83], a[60:63], a[204:207], v[80:83]
v_cvt_pk_bf16_f32 v101, v162, v163
v_mul_f32 v168, v168, v9
v_exp_f32 v96, v96
v_mfma_f32_16x16x32_bf16 v[216:219], a[112:115], v[52:55], v[216:219]
s_add_u32 m0, s49, 96
v_mul_f32 v169, v169, v9
v_exp_f32 v97, v97
v_mfma_f32_16x16x32_bf16 v[216:219], a[116:119], v[56:59], v[216:219]
buffer_load_dwordx4 v1, s[12:15], s50 offen offset:3072 nt lds
v_mul_f32 v170, v170, v9
v_mfma_f32_16x16x32_bf16 v[220:223], a[124:127], v[56:59], v[220:223]
v_mul_f32 v171, v171, v9
v_cvt_pk_bf16_f32 v102, v164, v165
v_cvt_pk_bf16_f32 v103, v166, v167
v_cvt_pk_bf16_f32 v66, v96, v97
v_mfma_f32_16x16x32_bf16 v[220:223], a[120:123], v[52:55], v[220:223]
v_mul_f32 v172, v172, v9
v_exp_f32 v98, v98
v_mfma_f32_16x16x32_bf16 v[28:31], v[16:19], v[52:55], v[28:31]
v_mul_f32 v173, v173, v9
v_mul_f32 v174, v174, v9
v_exp_f32 v99, v99
v_mfma_f32_16x16x32_bf16 v[28:31], v[16:19], v[56:59], v[28:31]
v_mul_f32 v175, v175, v9
v_cvt_pk_bf16_f32 v104, v168, v169
v_cvt_pk_bf16_f32 v67, v98, v99
v_mfma_f32_16x16x32_bf16 v[84:87], a[0:3], a[208:211], 0
v_add_f32 v68, v68, v36
v_add_f32 v69, v69, v36
v_add_f32 v70, v70, v36
v_mfma_f32_16x16x32_bf16 v[84:87], a[4:7], a[212:215], v[84:87]
v_add_f32 v71, v71, v36
v_exp_f32 v68, v68
v_mfma_f32_16x16x32_bf16 v[84:87], a[8:11], a[216:219], v[84:87]
v_exp_f32 v69, v69
s_nop 0
v_cvt_pk_bf16_f32 v52, v68, v69
v_mfma_f32_16x16x32_bf16 v[84:87], a[12:15], a[220:223], v[84:87]
v_exp_f32 v70, v70
v_mfma_f32_16x16x32_bf16 v[224:227], a[64:67], v[60:63], v[224:227]
s_add_u32 m0, s49, 67584
v_exp_f32 v71, v71
s_nop 0
v_cvt_pk_bf16_f32 v53, v70, v71
v_mfma_f32_16x16x32_bf16 v[224:227], a[68:71], v[64:67], v[224:227]
buffer_load_dwordx4 v1, s[16:19], s50 offen offset:0 nt lds
v_cvt_pk_bf16_f32 v105, v170, v171
buffer_store_dwordx4 v[100:103], v6, s[20:23], s52 offen offset:0 sc1
v_mfma_f32_16x16x32_bf16 v[228:231], a[76:79], v[64:67], v[228:231]
v_exp_f32 v72, v72
v_mfma_f32_16x16x32_bf16 v[228:231], a[72:75], v[60:63], v[228:231]
ds_read_b64_tr_b16 a[64:65], v5 offset:0
v_max3_f32 v11, v84, v85, v86
v_max_f32 v11, v11, v87
v_mul_f32 v176, v176, v9
v_mfma_f32_16x16x32_bf16 v[232:235], a[80:83], v[60:63], v[232:235]
v_mov_b32 v12, v11
v_exp_f32 v73, v73
v_mfma_f32_16x16x32_bf16 v[232:235], a[84:87], v[64:67], v[232:235]
ds_read_b64_tr_b16 a[66:67], v5 offset:256
ds_read_b64_tr_b16 a[68:69], v5 offset:512
v_cvt_pk_bf16_f32 v54, v72, v73
v_mfma_f32_16x16x32_bf16 v[236:239], a[92:95], v[64:67], v[236:239]
v_permlane32_swap_b32 v11, v12
v_max_f32 v11, v11, v12
v_mul_f32 v177, v177, v9
v_mul_f32 v178, v178, v9
v_mfma_f32_16x16x32_bf16 v[236:239], a[88:91], v[60:63], v[236:239]
ds_read_b64_tr_b16 a[70:71], v5 offset:768
v_mov_b32 v12, v11
v_mul_f32 v179, v179, v9
v_mfma_f32_16x16x32_bf16 v[240:243], a[96:99], v[60:63], v[240:243]
v_permlane16_swap_b32 v11, v12
v_cvt_pk_bf16_f32 v106, v172, v173
v_exp_f32 v74, v74
v_mfma_f32_16x16x32_bf16 v[240:243], a[100:103], v[64:67], v[240:243]
ds_read_b64_tr_b16 a[72:73], v5 offset:32
ds_read_b64_tr_b16 a[74:75], v5 offset:288
v_max_f32 v11, v11, v12
v_sub_f32 v40, 0, v11
v_mfma_f32_16x16x32_bf16 v[244:247], a[108:111], v[64:67], v[244:247]
v_sub_f32 v41, 0, v11
v_sub_f32 v42, 0, v11
v_sub_f32 v43, 0, v11
v_mfma_f32_16x16x32_bf16 v[244:247], a[104:107], v[60:63], v[244:247]
ds_read_b64_tr_b16 a[76:77], v5 offset:544
v_exp_f32 v75, v75
v_mfma_f32_16x16x32_bf16 v[88:91], a[16:19], a[208:211], v[40:43]
v_cvt_pk_bf16_f32 v55, v74, v75
v_exp_f32 v76, v76
v_mfma_f32_16x16x32_bf16 v[88:91], a[20:23], a[212:215], v[88:91]
ds_read_b64_tr_b16 a[78:79], v5 offset:800
ds_read_b64_tr_b16 a[80:81], v5 offset:64
v_cvt_pk_bf16_f32 v107, v174, v175
v_mul_f32 v180, v180, v9
v_mfma_f32_16x16x32_bf16 v[88:91], a[24:27], a[216:219], v[88:91]
v_exp_f32 v77, v77
s_nop 0
v_cvt_pk_bf16_f32 v56, v76, v77
v_mfma_f32_16x16x32_bf16 v[88:91], a[28:31], a[220:223], v[88:91]
ds_read_b64_tr_b16 a[82:83], v5 offset:320
v_exp_f32 v78, v78
v_mfma_f32_16x16x32_bf16 v[92:95], a[32:35], a[208:211], v[40:43]
v_mul_f32 v181, v181, v9
v_exp_f32 v79, v79
s_nop 0
v_cvt_pk_bf16_f32 v57, v78, v79
v_mfma_f32_16x16x32_bf16 v[92:95], a[36:39], a[212:215], v[92:95]
ds_read_b64_tr_b16 a[84:85], v5 offset:576
ds_read_b64_tr_b16 a[86:87], v5 offset:832
v_mul_f32 v182, v182, v9
v_mfma_f32_16x16x32_bf16 v[92:95], a[40:43], a[216:219], v[92:95]
v_mul_f32 v183, v183, v9
v_cvt_pk_bf16_f32 v108, v176, v177
v_exp_f32 v80, v80
v_mfma_f32_16x16x32_bf16 v[92:95], a[44:47], a[220:223], v[92:95]
ds_read_b64_tr_b16 a[88:89], v5 offset:96
v_exp_f32 v81, v81
v_mfma_f32_16x16x32_bf16 v[96:99], a[48:51], a[208:211], v[40:43]
v_cvt_pk_bf16_f32 v58, v80, v81
v_exp_f32 v82, v82
v_mfma_f32_16x16x32_bf16 v[96:99], a[52:55], a[212:215], v[96:99]
ds_read_b64_tr_b16 a[90:91], v5 offset:352
ds_read_b64_tr_b16 a[92:93], v5 offset:608
v_cvt_pk_bf16_f32 v109, v178, v179
buffer_store_dwordx4 v[104:107], v6, s[20:23], s52 offen offset:1024 sc1
v_mfma_f32_16x16x32_bf16 v[96:99], a[56:59], a[216:219], v[96:99]
v_exp_f32 v83, v83
s_nop 0
v_cvt_pk_bf16_f32 v59, v82, v83
v_mfma_f32_16x16x32_bf16 v[96:99], a[60:63], a[220:223], v[96:99]
ds_read_b64_tr_b16 a[94:95], v5 offset:864
v_mul_f32 v184, v184, v9
v_mul_f32 v185, v185, v9
v_mfma_f32_16x16x32_bf16 v[248:251], a[112:115], v[60:63], v[248:251]
v_mul_f32 v186, v186, v9
v_mul_f32 v187, v187, v9
v_cvt_pk_bf16_f32 v110, v180, v181
v_mfma_f32_16x16x32_bf16 v[248:251], a[116:119], v[64:67], v[248:251]
ds_read_b64_tr_b16 a[96:97], v5 offset:128
ds_read_b64_tr_b16 a[98:99], v5 offset:384
v_cvt_pk_bf16_f32 v111, v182, v183
v_mfma_f32_16x16x32_bf16 v[252:255], a[124:127], v[64:67], v[252:255]
v_mul_f32 v188, v188, v9
v_mul_f32 v189, v189, v9
v_mul_f32 v190, v190, v9
v_mul_f32 v191, v191, v9
v_mfma_f32_16x16x32_bf16 v[252:255], a[120:123], v[60:63], v[252:255]
ds_read_b64_tr_b16 a[100:101], v5 offset:640
v_cvt_pk_bf16_f32 v112, v184, v185
v_cvt_pk_bf16_f32 v113, v186, v187
v_mfma_f32_16x16x32_bf16 v[32:35], v[16:19], v[60:63], v[32:35]
ds_read_b64_tr_b16 a[102:103], v5 offset:896
ds_read_b64_tr_b16 a[104:105], v5 offset:160
buffer_store_dwordx4 v[108:111], v6, s[20:23], s52 offen offset:2048 sc1
v_mfma_f32_16x16x32_bf16 v[32:35], v[16:19], v[64:67], v[32:35]
ds_read_b64_tr_b16 a[106:107], v5 offset:416
ds_read_b64_tr_b16 a[108:109], v5 offset:672
v_cvt_pk_bf16_f32 v114, v188, v189
v_mfma_f32_16x16x32_bf16 v[68:71], a[0:3], a[224:227], 0
v_add_f32 v84, v84, v40
v_add_f32 v85, v85, v40
v_add_f32 v86, v86, v40
v_mfma_f32_16x16x32_bf16 v[68:71], a[4:7], a[228:231], v[68:71]
ds_read_b64_tr_b16 a[110:111], v5 offset:928
ds_read_b64_tr_b16 a[112:113], v5 offset:192
v_add_f32 v87, v87, v40
v_mfma_f32_16x16x32_bf16 v[68:71], a[8:11], a[232:235], v[68:71]
v_exp_f32 v84, v84
v_mfma_f32_16x16x32_bf16 v[68:71], a[12:15], a[236:239], v[68:71]
s_waitcnt lgkmcnt(15)
ds_read_b64_tr_b16 a[114:115], v5 offset:448
v_exp_f32 v85, v85
v_mfma_f32_16x16x32_bf16 v[128:131], a[64:67], v[52:55], 0
v_cvt_pk_bf16_f32 v60, v84, v85
v_exp_f32 v86, v86
v_mfma_f32_16x16x32_bf16 v[128:131], a[68:71], v[56:59], v[128:131]
ds_read_b64_tr_b16 a[116:117], v5 offset:704
ds_read_b64_tr_b16 a[118:119], v5 offset:960
v_cvt_pk_bf16_f32 v115, v190, v191
buffer_store_dwordx4 v[112:115], v6, s[20:23], s52 offen offset:3072 sc1
v_mfma_f32_16x16x32_bf16 v[132:135], a[76:79], v[56:59], 0
v_exp_f32 v87, v87
s_nop 0
v_cvt_pk_bf16_f32 v61, v86, v87
v_mfma_f32_16x16x32_bf16 v[132:135], a[72:75], v[52:55], v[132:135]
ds_read_b64_tr_b16 a[120:121], v5 offset:224
v_max3_f32 v11, v68, v69, v70
v_max_f32 v11, v11, v71
v_mfma_f32_16x16x32_bf16 v[136:139], a[80:83], v[52:55], 0
s_waitcnt lgkmcnt(15)
v_mov_b32 v12, v11
v_exp_f32 v88, v88
v_mfma_f32_16x16x32_bf16 v[136:139], a[84:87], v[56:59], v[136:139]
s_waitcnt lgkmcnt(13)
ds_read_b64_tr_b16 a[122:123], v5 offset:480
ds_read_b64_tr_b16 a[124:125], v5 offset:736
v_rcp_f32 v9, v28
v_mfma_f32_16x16x32_bf16 v[140:143], a[92:95], v[56:59], 0
v_permlane32_swap_b32 v11, v12
v_max_f32 v11, v11, v12
v_cmp_nle_f32 vcc, v28, v10
v_mfma_f32_16x16x32_bf16 v[140:143], a[88:91], v[52:55], v[140:143]
s_waitcnt lgkmcnt(13)
ds_read_b64_tr_b16 a[126:127], v5 offset:992
v_mov_b32 v12, v11
s_cmp_lg_u64 vcc, 0
s_cselect_b32 s52, 4, 0
s_cselect_b64 s[58:59], 0, -1
s_or_b32 s56, s56, s52
v_mfma_f32_16x16x32_bf16 v[144:147], a[96:99], v[52:55], 0
s_waitcnt lgkmcnt(12)
s_add_u32 m0, s49, 67616
v_permlane16_swap_b32 v11, v12
v_exp_f32 v89, v89
v_mfma_f32_16x16x32_bf16 v[144:147], a[100:103], v[56:59], v[144:147]
s_waitcnt lgkmcnt(8)
buffer_load_dwordx4 v1, s[16:19], s50 offen offset:1024 nt lds
v_max_f32 v11, v11, v12
v_sub_f32 v44, 0, v11
v_cvt_pk_bf16_f32 v62, v88, v89
v_mfma_f32_16x16x32_bf16 v[148:151], a[108:111], v[56:59], 0
v_sub_f32 v45, 0, v11
v_sub_f32 v46, 0, v11
v_sub_f32 v47, 0, v11
v_mfma_f32_16x16x32_bf16 v[148:151], a[104:107], v[52:55], v[148:151]
v_exp_f32 v90, v90
v_mfma_f32_16x16x32_bf16 v[72:75], a[16:19], a[224:227], v[44:47]
s_mov_b32 s52, 8192
v_exp_f32 v91, v91
s_nop 0
v_cvt_pk_bf16_f32 v63, v90, v91
v_mfma_f32_16x16x32_bf16 v[72:75], a[20:23], a[228:231], v[72:75]
v_mul_f32 v192, v192, v9
v_exp_f32 v92, v92
v_mfma_f32_16x16x32_bf16 v[72:75], a[24:27], a[232:235], v[72:75]
v_mul_f32 v193, v193, v9
v_exp_f32 v93, v93
s_nop 0
v_cvt_pk_bf16_f32 v64, v92, v93
v_mfma_f32_16x16x32_bf16 v[72:75], a[28:31], a[236:239], v[72:75]
v_mul_f32 v194, v194, v9
v_exp_f32 v94, v94
v_mfma_f32_16x16x32_bf16 v[76:79], a[32:35], a[224:227], v[44:47]
s_add_u32 m0, s49, 67648
v_exp_f32 v95, v95
s_nop 0
v_cvt_pk_bf16_f32 v65, v94, v95
v_mfma_f32_16x16x32_bf16 v[76:79], a[36:39], a[228:231], v[76:79]
buffer_load_dwordx4 v1, s[16:19], s50 offen offset:2048 nt lds
v_mul_f32 v195, v195, v9
v_mul_f32 v196, v196, v9
v_mfma_f32_16x16x32_bf16 v[76:79], a[40:43], a[232:235], v[76:79]
v_mul_f32 v197, v197, v9
v_exp_f32 v96, v96
v_mfma_f32_16x16x32_bf16 v[76:79], a[44:47], a[236:239], v[76:79]
v_exp_f32 v97, v97
s_nop 0
v_cvt_pk_bf16_f32 v66, v96, v97
v_mfma_f32_16x16x32_bf16 v[80:83], a[48:51], a[224:227], v[44:47]
v_mul_f32 v198, v198, v9
v_mul_f32 v199, v199, v9
v_exp_f32 v98, v98
v_mfma_f32_16x16x32_bf16 v[80:83], a[52:55], a[228:231], v[80:83]
v_exp_f32 v99, v99
s_nop 0
v_cvt_pk_bf16_f32 v67, v98, v99
v_mfma_f32_16x16x32_bf16 v[80:83], a[56:59], a[232:235], v[80:83]
v_cvt_pk_bf16_f32 v100, v192, v193
v_cvt_pk_bf16_f32 v101, v194, v195
v_mul_f32 v200, v200, v9
v_mfma_f32_16x16x32_bf16 v[80:83], a[60:63], a[236:239], v[80:83]
s_waitcnt lgkmcnt(4)
v_mul_f32 v201, v201, v9
v_mul_f32 v202, v202, v9
v_mul_f32 v203, v203, v9
v_cvt_pk_bf16_f32 v102, v196, v197
v_mfma_f32_16x16x32_bf16 v[152:155], a[112:115], v[52:55], 0
s_add_u32 m0, s49, 67680
v_cvt_pk_bf16_f32 v103, v198, v199
v_mul_f32 v204, v204, v9
v_mul_f32 v205, v205, v9
v_mfma_f32_16x16x32_bf16 v[152:155], a[116:119], v[56:59], v[152:155]
s_waitcnt lgkmcnt(0)
buffer_load_dwordx4 v1, s[16:19], s50 offen offset:3072 nt lds
v_mul_f32 v206, v206, v9
v_mul_f32 v207, v207, v9
v_mfma_f32_16x16x32_bf16 v[156:159], a[124:127], v[56:59], 0
s_mov_b32 s57, s47
v_cvt_pk_bf16_f32 v104, v200, v201
v_cvt_pk_bf16_f32 v105, v202, v203
buffer_store_dwordx4 v[100:103], v6, s[20:23], s52 offen offset:0 sc1
v_mfma_f32_16x16x32_bf16 v[156:159], a[120:123], v[52:55], v[156:159]
s_mov_b32 s47, s48
v_mul_f32 v208, v208, v9
v_mul_f32 v209, v209, v9
v_mfma_f32_16x16x32_bf16 v[20:23], v[16:19], v[52:55], 0
s_add_u32 s50, s50, 16384
v_mul_f32 v210, v210, v9
v_mul_f32 v211, v211, v9
v_cvt_pk_bf16_f32 v106, v204, v205
v_cvt_pk_bf16_f32 v107, v206, v207
v_mfma_f32_16x16x32_bf16 v[20:23], v[16:19], v[56:59], v[20:23]
v_mul_f32 v212, v212, v9
v_mul_f32 v213, v213, v9
v_mul_f32 v214, v214, v9
v_mfma_f32_16x16x32_bf16 v[84:87], a[0:3], a[240:243], 0
s_add_u32 s48, s47, 16896
v_add_f32 v68, v68, v44
v_add_f32 v69, v69, v44
v_add_f32 v70, v70, v44
v_mfma_f32_16x16x32_bf16 v[84:87], a[4:7], a[244:247], v[84:87]
s_cmp_eq_u32 s48, 67584
v_add_f32 v71, v71, v44
v_exp_f32 v68, v68
v_mfma_f32_16x16x32_bf16 v[84:87], a[8:11], a[248:251], v[84:87]
s_cselect_b32 s48, 0, s48
v_exp_f32 v69, v69
s_nop 0
v_cvt_pk_bf16_f32 v52, v68, v69
v_mfma_f32_16x16x32_bf16 v[84:87], a[12:15], a[252:255], v[84:87]
s_waitcnt vmcnt(12)
v_add_u32 v4, s48, v2
v_exp_f32 v70, v70
v_mfma_f32_16x16x32_bf16 v[160:163], a[64:67], v[60:63], 0
s_barrier
v_exp_f32 v71, v71
s_nop 0
v_cvt_pk_bf16_f32 v53, v70, v71
v_mfma_f32_16x16x32_bf16 v[160:163], a[68:71], v[64:67], v[160:163]
ds_read_b128 a[0:3], v4 offset:0
v_mul_f32 v215, v215, v9
v_exp_f32 v72, v72
v_mfma_f32_16x16x32_bf16 v[164:167], a[76:79], v[64:67], 0
s_add_u32 s49, s57, s43
v_exp_f32 v73, v73
s_nop 0
v_cvt_pk_bf16_f32 v54, v72, v73
v_mfma_f32_16x16x32_bf16 v[164:167], a[72:75], v[60:63], v[164:167]
ds_read_b128 a[4:7], v4 offset:64
v_max3_f32 v11, v84, v85, v86
v_max_f32 v11, v11, v87
v_mfma_f32_16x16x32_bf16 v[168:171], a[80:83], v[60:63], 0
v_mov_b32 v12, v11
v_exp_f32 v74, v74
v_mfma_f32_16x16x32_bf16 v[168:171], a[84:87], v[64:67], v[168:171]
ds_read_b128 a[8:11], v4 offset:128
v_cvt_pk_bf16_f32 v108, v208, v209
v_exp_f32 v75, v75
v_mfma_f32_16x16x32_bf16 v[172:175], a[92:95], v[64:67], 0
v_permlane32_swap_b32 v11, v12
v_max_f32 v11, v11, v12
v_cvt_pk_bf16_f32 v55, v74, v75
v_mfma_f32_16x16x32_bf16 v[172:175], a[88:91], v[60:63], v[172:175]
ds_read_b128 a[12:15], v4 offset:192
v_mov_b32 v12, v11
v_cvt_pk_bf16_f32 v109, v210, v211
v_mfma_f32_16x16x32_bf16 v[176:179], a[96:99], v[60:63], 0
v_permlane16_swap_b32 v11, v12
v_exp_f32 v76, v76
v_mfma_f32_16x16x32_bf16 v[176:179], a[100:103], v[64:67], v[176:179]
v_max_f32 v11, v11, v12
v_sub_f32 v48, 0, v11
buffer_store_dwordx4 v[104:107], v6, s[20:23], s52 offen offset:1024 sc1
v_mfma_f32_16x16x32_bf16 v[180:183], a[108:111], v[64:67], 0
v_sub_f32 v49, 0, v11
v_sub_f32 v50, 0, v11
v_sub_f32 v51, 0, v11
v_mfma_f32_16x16x32_bf16 v[180:183], a[104:107], v[60:63], v[180:183]
v_exp_f32 v77, v77
s_nop 0
v_cvt_pk_bf16_f32 v56, v76, v77
v_mfma_f32_16x16x32_bf16 v[88:91], a[16:19], a[240:243], v[48:51]
v_mul_f32 v216, v216, v9
v_exp_f32 v78, v78
v_mfma_f32_16x16x32_bf16 v[88:91], a[20:23], a[244:247], v[88:91]
v_mul_f32 v217, v217, v9
v_exp_f32 v79, v79
s_nop 0
v_cvt_pk_bf16_f32 v57, v78, v79
v_mfma_f32_16x16x32_bf16 v[88:91], a[24:27], a[248:251], v[88:91]
v_mul_f32 v218, v218, v9
v_exp_f32 v80, v80
v_mfma_f32_16x16x32_bf16 v[88:91], a[28:31], a[252:255], v[88:91]
v_exp_f32 v81, v81
s_nop 0
v_cvt_pk_bf16_f32 v58, v80, v81
v_mfma_f32_16x16x32_bf16 v[92:95], a[32:35], a[240:243], v[48:51]
ds_read_b128 a[16:19], v4 offset:256
v_mul_f32 v219, v219, v9
v_exp_f32 v82, v82
v_mfma_f32_16x16x32_bf16 v[92:95], a[36:39], a[244:247], v[92:95]
ds_read_b128 a[20:23], v4 offset:320
v_exp_f32 v83, v83
v_mfma_f32_16x16x32_bf16 v[92:95], a[40:43], a[248:251], v[92:95]
ds_read_b128 a[24:27], v4 offset:384
v_cvt_pk_bf16_f32 v110, v212, v213
v_cvt_pk_bf16_f32 v59, v82, v83
v_mfma_f32_16x16x32_bf16 v[92:95], a[44:47], a[252:255], v[92:95]
ds_read_b128 a[28:31], v4 offset:448
v_cvt_pk_bf16_f32 v111, v214, v215
v_mul_f32 v220, v220, v9
v_mfma_f32_16x16x32_bf16 v[96:99], a[48:51], a[240:243], v[48:51]
ds_read_b128 a[32:35], v4 offset:512
v_mul_f32 v221, v221, v9
v_mul_f32 v222, v222, v9
v_mul_f32 v223, v223, v9
v_mfma_f32_16x16x32_bf16 v[96:99], a[52:55], a[244:247], v[96:99]
ds_read_b128 a[36:39], v4 offset:576
v_cvt_pk_bf16_f32 v112, v216, v217
v_cvt_pk_bf16_f32 v113, v218, v219
v_mfma_f32_16x16x32_bf16 v[96:99], a[56:59], a[248:251], v[96:99]
ds_read_b128 a[40:43], v4 offset:640
buffer_store_dwordx4 v[108:111], v6, s[20:23], s52 offen offset:2048 sc1
v_mfma_f32_16x16x32_bf16 v[96:99], a[60:63], a[252:255], v[96:99]
ds_read_b128 a[44:47], v4 offset:704
v_cvt_pk_bf16_f32 v114, v220, v221
v_cvt_pk_bf16_f32 v115, v222, v223
v_mfma_f32_16x16x32_bf16 v[184:187], a[112:115], v[60:63], 0
ds_read_b128 a[48:51], v4 offset:768
buffer_store_dwordx4 v[112:115], v6, s[20:23], s52 offen offset:3072 sc1
v_rcp_f32 v9, v32
v_mfma_f32_16x16x32_bf16 v[184:187], a[116:119], v[64:67], v[184:187]
ds_read_b128 a[52:55], v4 offset:832
v_cmp_nle_f32 vcc, v32, v10
v_mfma_f32_16x16x32_bf16 v[188:191], a[124:127], v[64:67], 0
ds_read_b128 a[56:59], v4 offset:896
s_cmp_lg_u64 vcc, 0
s_cselect_b32 s52, 8, 0
s_cselect_b64 s[58:59], 0, -1
s_or_b32 s56, s56, s52
s_mov_b32 s52, 12288
v_mfma_f32_16x16x32_bf16 v[188:191], a[120:123], v[60:63], v[188:191]
ds_read_b128 a[60:63], v4 offset:960
v_mul_f32 v224, v224, v9
v_mul_f32 v225, v225, v9
v_mfma_f32_16x16x32_bf16 v[24:27], v[16:19], v[60:63], 0
v_mul_f32 v226, v226, v9
v_mul_f32 v227, v227, v9
v_mul_f32 v228, v228, v9
v_mul_f32 v229, v229, v9
v_mfma_f32_16x16x32_bf16 v[24:27], v[16:19], v[64:67], v[24:27]
v_mul_f32 v230, v230, v9
v_mul_f32 v231, v231, v9
v_cvt_pk_bf16_f32 v100, v224, v225
s_waitcnt lgkmcnt(15)
v_mfma_f32_16x16x32_bf16 v[68:71], a[0:3], a[192:195], v[36:39]
s_waitcnt lgkmcnt(14)
v_add_f32 v84, v84, v48
v_add_f32 v85, v85, v48
v_mfma_f32_16x16x32_bf16 v[68:71], a[4:7], a[196:199], v[68:71]
s_waitcnt lgkmcnt(13)
v_add_u32 v5, s48, v3
v_add_f32 v86, v86, v48
v_mfma_f32_16x16x32_bf16 v[68:71], a[8:11], a[200:203], v[68:71]
s_waitcnt lgkmcnt(12)
v_add_f32 v87, v87, v48
v_mfma_f32_16x16x32_bf16 v[68:71], a[12:15], a[204:207], v[68:71]
v_exp_f32 v84, v84
v_mfma_f32_16x16x32_bf16 v[192:195], a[64:67], v[52:55], 0
s_add_u32 m0, s49, 0
v_cvt_pk_bf16_f32 v101, v226, v227
v_exp_f32 v85, v85
v_mfma_f32_16x16x32_bf16 v[192:195], a[68:71], v[56:59], v[192:195]
buffer_load_dwordx4 v1, s[12:15], s50 offen offset:0 nt lds
v_mul_f32 v232, v232, v9
v_mul_f32 v233, v233, v9
v_mfma_f32_16x16x32_bf16 v[196:199], a[76:79], v[56:59], 0
v_mul_f32 v234, v234, v9
v_mul_f32 v235, v235, v9
v_cvt_pk_bf16_f32 v60, v84, v85
v_mfma_f32_16x16x32_bf16 v[196:199], a[72:75], v[52:55], v[196:199]
s_waitcnt lgkmcnt(11)
v_cvt_pk_bf16_f32 v102, v228, v229
v_exp_f32 v86, v86
v_mfma_f32_16x16x32_bf16 v[72:75], a[16:19], a[192:195], v[36:39]
s_waitcnt lgkmcnt(10)
v_cvt_pk_bf16_f32 v103, v230, v231
v_mul_f32 v236, v236, v9
v_exp_f32 v87, v87
v_mfma_f32_16x16x32_bf16 v[72:75], a[20:23], a[196:199], v[72:75]
s_waitcnt lgkmcnt(9)
v_mul_f32 v237, v237, v9
v_mul_f32 v238, v238, v9
v_cvt_pk_bf16_f32 v61, v86, v87
v_mfma_f32_16x16x32_bf16 v[72:75], a[24:27], a[200:203], v[72:75]
s_waitcnt lgkmcnt(8)
v_mul_f32 v239, v239, v9
v_exp_f32 v88, v88
v_mfma_f32_16x16x32_bf16 v[72:75], a[28:31], a[204:207], v[72:75]
v_cvt_pk_bf16_f32 v104, v232, v233
v_cvt_pk_bf16_f32 v105, v234, v235
v_exp_f32 v89, v89
v_mfma_f32_16x16x32_bf16 v[200:203], a[80:83], v[52:55], 0
s_add_u32 m0, s49, 32
buffer_store_dwordx4 v[100:103], v6, s[20:23], s52 offen offset:0 sc1
v_cvt_pk_bf16_f32 v62, v88, v89
v_mfma_f32_16x16x32_bf16 v[200:203], a[84:87], v[56:59], v[200:203]
buffer_load_dwordx4 v1, s[12:15], s50 offen offset:1024 nt lds
v_mul_f32 v240, v240, v9
v_mfma_f32_16x16x32_bf16 v[204:207], a[92:95], v[56:59], 0
v_mul_f32 v241, v241, v9
v_mul_f32 v242, v242, v9
v_exp_f32 v90, v90
v_mfma_f32_16x16x32_bf16 v[204:207], a[88:91], v[52:55], v[204:207]
s_waitcnt lgkmcnt(7)
v_mul_f32 v243, v243, v9
v_exp_f32 v91, v91
v_mfma_f32_16x16x32_bf16 v[76:79], a[32:35], a[192:195], v[36:39]
s_waitcnt lgkmcnt(6)
v_cvt_pk_bf16_f32 v106, v236, v237
v_cvt_pk_bf16_f32 v107, v238, v239
v_cvt_pk_bf16_f32 v63, v90, v91
v_mfma_f32_16x16x32_bf16 v[76:79], a[36:39], a[196:199], v[76:79]
s_waitcnt lgkmcnt(5)
v_mul_f32 v244, v244, v9
v_mul_f32 v245, v245, v9
v_exp_f32 v92, v92
v_mfma_f32_16x16x32_bf16 v[76:79], a[40:43], a[200:203], v[76:79]
s_waitcnt lgkmcnt(4)
v_mul_f32 v246, v246, v9
v_exp_f32 v93, v93
v_mfma_f32_16x16x32_bf16 v[76:79], a[44:47], a[204:207], v[76:79]
v_mul_f32 v247, v247, v9
v_cvt_pk_bf16_f32 v108, v240, v241
v_cvt_pk_bf16_f32 v64, v92, v93
v_mfma_f32_16x16x32_bf16 v[208:211], a[96:99], v[52:55], 0
s_add_u32 m0, s49, 64
v_cvt_pk_bf16_f32 v109, v242, v243
buffer_store_dwordx4 v[104:107], v6, s[20:23], s52 offen offset:1024 sc1
v_exp_f32 v94, v94
v_mfma_f32_16x16x32_bf16 v[208:211], a[100:103], v[56:59], v[208:211]
buffer_load_dwordx4 v1, s[12:15], s50 offen offset:2048 nt lds
v_mfma_f32_16x16x32_bf16 v[212:215], a[108:111], v[56:59], 0
v_mul_f32 v248, v248, v9
v_exp_f32 v95, v95
v_mfma_f32_16x16x32_bf16 v[212:215], a[104:107], v[52:55], v[212:215]
s_waitcnt lgkmcnt(3)
v_mul_f32 v249, v249, v9
v_mul_f32 v250, v250, v9
v_mul_f32 v251, v251, v9
v_cvt_pk_bf16_f32 v65, v94, v95
v_mfma_f32_16x16x32_bf16 v[80:83], a[48:51], a[192:195], v[36:39]
s_waitcnt lgkmcnt(2)
v_cvt_pk_bf16_f32 v110, v244, v245
v_exp_f32 v96, v96
v_mfma_f32_16x16x32_bf16 v[80:83], a[52:55], a[196:199], v[80:83]
s_waitcnt lgkmcnt(1)
v_cvt_pk_bf16_f32 v111, v246, v247
v_exp_f32 v97, v97
v_mfma_f32_16x16x32_bf16 v[80:83], a[56:59], a[200:203], v[80:83]
s_waitcnt lgkmcnt(0)
v_mul_f32 v252, v252, v9
v_mul_f32 v253, v253, v9
v_mul_f32 v254, v254, v9
v_cvt_pk_bf16_f32 v66, v96, v97
v_mfma_f32_16x16x32_bf16 v[80:83], a[60:63], a[204:207], v[80:83]
v_mul_f32 v255, v255, v9
v_exp_f32 v98, v98
v_mfma_f32_16x16x32_bf16 v[216:219], a[112:115], v[52:55], 0
s_add_u32 m0, s49, 96
v_cvt_pk_bf16_f32 v112, v248, v249
v_exp_f32 v99, v99
v_mfma_f32_16x16x32_bf16 v[216:219], a[116:119], v[56:59], v[216:219]
buffer_load_dwordx4 v1, s[12:15], s50 offen offset:3072 nt lds
v_cvt_pk_bf16_f32 v113, v250, v251
buffer_store_dwordx4 v[108:111], v6, s[20:23], s52 offen offset:2048 sc1
v_mfma_f32_16x16x32_bf16 v[220:223], a[124:127], v[56:59], 0
v_cvt_pk_bf16_f32 v114, v252, v253
v_cvt_pk_bf16_f32 v67, v98, v99
v_mfma_f32_16x16x32_bf16 v[220:223], a[120:123], v[52:55], v[220:223]
v_cvt_pk_bf16_f32 v115, v254, v255
buffer_store_dwordx4 v[112:115], v6, s[20:23], s52 offen offset:3072 sc1
v_mfma_f32_16x16x32_bf16 v[28:31], v[16:19], v[52:55], 0
s_and_b32 s61, s56, 15
s_cselect_b32 s61, 1, 0
v_mov_b32 v8, s61
v_mov_b32 v7, 163836
ds_or_b32 v7, v8
v_add_u32 v7, (C_T29 - K1_PC), v13
v_mfma_f32_16x16x32_bf16 v[28:31], v[16:19], v[56:59], v[28:31]
v_min_u32 v7, (SLOW - K1_PC - 4), v7
global_load_dword v125, v7, s[78:79]
v_mfma_f32_16x16x32_bf16 v[84:87], a[0:3], a[208:211], v[40:43]
v_exp_f32 v68, v68
v_mfma_f32_16x16x32_bf16 v[84:87], a[4:7], a[212:215], v[84:87]
v_exp_f32 v69, v69
v_mfma_f32_16x16x32_bf16 v[84:87], a[8:11], a[216:219], v[84:87]
v_cvt_pk_bf16_f32 v52, v68, v69
v_mfma_f32_16x16x32_bf16 v[84:87], a[12:15], a[220:223], v[84:87]
v_exp_f32 v70, v70
v_mfma_f32_16x16x32_bf16 v[224:227], a[64:67], v[60:63], 0
s_add_u32 m0, s49, 67584
v_exp_f32 v71, v71
v_mfma_f32_16x16x32_bf16 v[224:227], a[68:71], v[64:67], v[224:227]
buffer_load_dwordx4 v1, s[16:19], s50 offen offset:0 nt lds
v_mfma_f32_16x16x32_bf16 v[228:231], a[76:79], v[64:67], 0
v_cvt_pk_bf16_f32 v53, v70, v71
v_mfma_f32_16x16x32_bf16 v[228:231], a[72:75], v[60:63], v[228:231]
ds_read_b64_tr_b16 a[64:65], v5 offset:0
v_mfma_f32_16x16x32_bf16 v[88:91], a[16:19], a[208:211], v[40:43]
v_exp_f32 v72, v72
v_mfma_f32_16x16x32_bf16 v[88:91], a[20:23], a[212:215], v[88:91]
ds_read_b64_tr_b16 a[66:67], v5 offset:256
ds_read_b64_tr_b16 a[68:69], v5 offset:512
v_mfma_f32_16x16x32_bf16 v[88:91], a[24:27], a[216:219], v[88:91]
v_exp_f32 v73, v73
v_mfma_f32_16x16x32_bf16 v[88:91], a[28:31], a[220:223], v[88:91]
ds_read_b64_tr_b16 a[70:71], v5 offset:768
v_cvt_pk_bf16_f32 v54, v72, v73
v_mfma_f32_16x16x32_bf16 v[232:235], a[80:83], v[60:63], 0
v_exp_f32 v74, v74
v_mfma_f32_16x16x32_bf16 v[232:235], a[84:87], v[64:67], v[232:235]
ds_read_b64_tr_b16 a[72:73], v5 offset:32
ds_read_b64_tr_b16 a[74:75], v5 offset:288
v_mfma_f32_16x16x32_bf16 v[236:239], a[92:95], v[64:67], 0
v_exp_f32 v75, v75
v_mfma_f32_16x16x32_bf16 v[236:239], a[88:91], v[60:63], v[236:239]
ds_read_b64_tr_b16 a[76:77], v5 offset:544
v_cvt_pk_bf16_f32 v55, v74, v75
v_mfma_f32_16x16x32_bf16 v[92:95], a[32:35], a[208:211], v[40:43]
v_exp_f32 v76, v76
v_mfma_f32_16x16x32_bf16 v[92:95], a[36:39], a[212:215], v[92:95]
ds_read_b64_tr_b16 a[78:79], v5 offset:800
ds_read_b64_tr_b16 a[80:81], v5 offset:64
v_mfma_f32_16x16x32_bf16 v[92:95], a[40:43], a[216:219], v[92:95]
v_exp_f32 v77, v77
v_mfma_f32_16x16x32_bf16 v[92:95], a[44:47], a[220:223], v[92:95]
ds_read_b64_tr_b16 a[82:83], v5 offset:320
v_cvt_pk_bf16_f32 v56, v76, v77
v_mfma_f32_16x16x32_bf16 v[240:243], a[96:99], v[60:63], 0
v_exp_f32 v78, v78
v_mfma_f32_16x16x32_bf16 v[240:243], a[100:103], v[64:67], v[240:243]
ds_read_b64_tr_b16 a[84:85], v5 offset:576
ds_read_b64_tr_b16 a[86:87], v5 offset:832
v_mfma_f32_16x16x32_bf16 v[244:247], a[108:111], v[64:67], 0
v_exp_f32 v79, v79
v_mfma_f32_16x16x32_bf16 v[244:247], a[104:107], v[60:63], v[244:247]
ds_read_b64_tr_b16 a[88:89], v5 offset:96
v_cvt_pk_bf16_f32 v57, v78, v79
v_mfma_f32_16x16x32_bf16 v[96:99], a[48:51], a[208:211], v[40:43]
v_exp_f32 v80, v80
v_mfma_f32_16x16x32_bf16 v[96:99], a[52:55], a[212:215], v[96:99]
ds_read_b64_tr_b16 a[90:91], v5 offset:352
ds_read_b64_tr_b16 a[92:93], v5 offset:608
v_mfma_f32_16x16x32_bf16 v[96:99], a[56:59], a[216:219], v[96:99]
v_exp_f32 v81, v81
v_mfma_f32_16x16x32_bf16 v[96:99], a[60:63], a[220:223], v[96:99]
ds_read_b64_tr_b16 a[94:95], v5 offset:864
v_cvt_pk_bf16_f32 v58, v80, v81
v_mfma_f32_16x16x32_bf16 v[248:251], a[112:115], v[60:63], 0
v_exp_f32 v82, v82
v_mfma_f32_16x16x32_bf16 v[248:251], a[116:119], v[64:67], v[248:251]
ds_read_b64_tr_b16 a[96:97], v5 offset:128
ds_read_b64_tr_b16 a[98:99], v5 offset:384
v_mfma_f32_16x16x32_bf16 v[252:255], a[124:127], v[64:67], 0
v_exp_f32 v83, v83
v_mfma_f32_16x16x32_bf16 v[252:255], a[120:123], v[60:63], v[252:255]
ds_read_b64_tr_b16 a[100:101], v5 offset:640
v_cvt_pk_bf16_f32 v59, v82, v83
v_mfma_f32_16x16x32_bf16 v[32:35], v[16:19], v[60:63], 0
ds_read_b64_tr_b16 a[102:103], v5 offset:896
ds_read_b64_tr_b16 a[104:105], v5 offset:160
v_mfma_f32_16x16x32_bf16 v[32:35], v[16:19], v[64:67], v[32:35]
ds_read_b64_tr_b16 a[106:107], v5 offset:416
ds_read_b64_tr_b16 a[108:109], v5 offset:672
s_mov_b32 s51, 12
LOOP_B:
v_mfma_f32_16x16x32_bf16 v[68:71], a[0:3], a[224:227], v[44:47]
v_exp_f32 v84, v84
v_mfma_f32_16x16x32_bf16 v[68:71], a[4:7], a[228:231], v[68:71]
ds_read_b64_tr_b16 a[110:111], v5 offset:928
ds_read_b64_tr_b16 a[112:113], v5 offset:192
v_mfma_f32_16x16x32_bf16 v[68:71], a[8:11], a[232:235], v[68:71]
v_exp_f32 v85, v85
v_mfma_f32_16x16x32_bf16 v[68:71], a[12:15], a[236:239], v[68:71]
s_waitcnt lgkmcnt(15)
ds_read_b64_tr_b16 a[114:115], v5 offset:448
v_cvt_pk_bf16_f32 v60, v84, v85
v_mfma_f32_16x16x32_bf16 v[128:131], a[64:67], v[52:55], v[128:131]
v_exp_f32 v86, v86
v_mfma_f32_16x16x32_bf16 v[128:131], a[68:71], v[56:59], v[128:131]
ds_read_b64_tr_b16 a[116:117], v5 offset:704
ds_read_b64_tr_b16 a[118:119], v5 offset:960
v_mfma_f32_16x16x32_bf16 v[132:135], a[76:79], v[56:59], v[132:135]
v_exp_f32 v87, v87
v_mfma_f32_16x16x32_bf16 v[132:135], a[72:75], v[52:55], v[132:135]
ds_read_b64_tr_b16 a[120:121], v5 offset:224
v_cvt_pk_bf16_f32 v61, v86, v87
v_mfma_f32_16x16x32_bf16 v[72:75], a[16:19], a[224:227], v[44:47]
v_exp_f32 v88, v88
v_mfma_f32_16x16x32_bf16 v[72:75], a[20:23], a[228:231], v[72:75]
ds_read_b64_tr_b16 a[122:123], v5 offset:480
ds_read_b64_tr_b16 a[124:125], v5 offset:736
v_mfma_f32_16x16x32_bf16 v[72:75], a[24:27], a[232:235], v[72:75]
v_exp_f32 v89, v89
v_mfma_f32_16x16x32_bf16 v[72:75], a[28:31], a[236:239], v[72:75]
s_waitcnt lgkmcnt(15)
ds_read_b64_tr_b16 a[126:127], v5 offset:992
v_cvt_pk_bf16_f32 v62, v88, v89
v_mfma_f32_16x16x32_bf16 v[136:139], a[80:83], v[52:55], v[136:139]
s_add_u32 m0, s49, 67616
v_exp_f32 v90, v90
v_mfma_f32_16x16x32_bf16 v[136:139], a[84:87], v[56:59], v[136:139]
buffer_load_dwordx4 v1, s[16:19], s50 offen offset:1024 nt lds
v_mfma_f32_16x16x32_bf16 v[140:143], a[92:95], v[56:59], v[140:143]
v_exp_f32 v91, v91
v_mfma_f32_16x16x32_bf16 v[140:143], a[88:91], v[52:55], v[140:143]
v_cvt_pk_bf16_f32 v63, v90, v91
v_mfma_f32_16x16x32_bf16 v[76:79], a[32:35], a[224:227], v[44:47]
v_exp_f32 v92, v92
v_mfma_f32_16x16x32_bf16 v[76:79], a[36:39], a[228:231], v[76:79]
v_exp_f32 v93, v93
v_mfma_f32_16x16x32_bf16 v[76:79], a[40:43], a[232:235], v[76:79]
v_cvt_pk_bf16_f32 v64, v92, v93
v_mfma_f32_16x16x32_bf16 v[76:79], a[44:47], a[236:239], v[76:79]
s_waitcnt lgkmcnt(12)
v_exp_f32 v94, v94
v_mfma_f32_16x16x32_bf16 v[144:147], a[96:99], v[52:55], v[144:147]
s_add_u32 m0, s49, 67648
v_exp_f32 v95, v95
v_mfma_f32_16x16x32_bf16 v[144:147], a[100:103], v[56:59], v[144:147]
s_waitcnt lgkmcnt(8)
buffer_load_dwordx4 v1, s[16:19], s50 offen offset:2048 nt lds
v_mfma_f32_16x16x32_bf16 v[148:151], a[108:111], v[56:59], v[148:151]
v_cvt_pk_bf16_f32 v65, v94, v95
v_mfma_f32_16x16x32_bf16 v[148:151], a[104:107], v[52:55], v[148:151]
v_exp_f32 v96, v96
v_mfma_f32_16x16x32_bf16 v[80:83], a[48:51], a[224:227], v[44:47]
v_exp_f32 v97, v97
v_mfma_f32_16x16x32_bf16 v[80:83], a[52:55], a[228:231], v[80:83]
v_cvt_pk_bf16_f32 v66, v96, v97
v_mfma_f32_16x16x32_bf16 v[80:83], a[56:59], a[232:235], v[80:83]
v_exp_f32 v98, v98
v_mfma_f32_16x16x32_bf16 v[80:83], a[60:63], a[236:239], v[80:83]
s_waitcnt lgkmcnt(4)
v_exp_f32 v99, v99
v_mfma_f32_16x16x32_bf16 v[152:155], a[112:115], v[52:55], v[152:155]
s_add_u32 m0, s49, 67680
v_cvt_pk_bf16_f32 v67, v98, v99
v_mfma_f32_16x16x32_bf16 v[152:155], a[116:119], v[56:59], v[152:155]
s_waitcnt lgkmcnt(0)
buffer_load_dwordx4 v1, s[16:19], s50 offen offset:3072 nt lds
v_mfma_f32_16x16x32_bf16 v[156:159], a[124:127], v[56:59], v[156:159]
s_mov_b32 s57, s47
v_mfma_f32_16x16x32_bf16 v[156:159], a[120:123], v[52:55], v[156:159]
s_mov_b32 s47, s48
v_mfma_f32_16x16x32_bf16 v[20:23], v[16:19], v[52:55], v[20:23]
s_add_u32 s50, s50, 16384
v_mfma_f32_16x16x32_bf16 v[20:23], v[16:19], v[56:59], v[20:23]
v_mfma_f32_16x16x32_bf16 v[84:87], a[0:3], a[240:243], v[48:51]
s_add_u32 s48, s47, 16896
v_exp_f32 v68, v68
v_mfma_f32_16x16x32_bf16 v[84:87], a[4:7], a[244:247], v[84:87]
s_cmp_eq_u32 s48, 67584
v_exp_f32 v69, v69
v_mfma_f32_16x16x32_bf16 v[84:87], a[8:11], a[248:251], v[84:87]
s_cselect_b32 s48, 0, s48
v_cvt_pk_bf16_f32 v52, v68, v69
v_mfma_f32_16x16x32_bf16 v[84:87], a[12:15], a[252:255], v[84:87]
s_waitcnt vmcnt(8)
v_add_u32 v4, s48, v2
v_mfma_f32_16x16x32_bf16 v[160:163], a[64:67], v[60:63], v[160:163]
s_barrier
v_exp_f32 v70, v70
v_mfma_f32_16x16x32_bf16 v[160:163], a[68:71], v[64:67], v[160:163]
ds_read_b128 a[0:3], v4 offset:0
v_mfma_f32_16x16x32_bf16 v[164:167], a[76:79], v[64:67], v[164:167]
s_add_u32 s49, s57, s43
v_exp_f32 v71, v71
v_mfma_f32_16x16x32_bf16 v[164:167], a[72:75], v[60:63], v[164:167]
ds_read_b128 a[4:7], v4 offset:64
v_cvt_pk_bf16_f32 v53, v70, v71
v_mfma_f32_16x16x32_bf16 v[88:91], a[16:19], a[240:243], v[48:51]
v_exp_f32 v72, v72
v_mfma_f32_16x16x32_bf16 v[88:91], a[20:23], a[244:247], v[88:91]
ds_read_b128 a[8:11], v4 offset:128
v_mfma_f32_16x16x32_bf16 v[88:91], a[24:27], a[248:251], v[88:91]
s_sub_u32 s61, s51, s95
v_exp_f32 v73, v73
v_mfma_f32_16x16x32_bf16 v[88:91], a[28:31], a[252:255], v[88:91]
ds_read_b128 a[12:15], v4 offset:192
v_cvt_pk_bf16_f32 v54, v72, v73
v_mfma_f32_16x16x32_bf16 v[168:171], a[80:83], v[60:63], v[168:171]
s_cmp_lt_u32 s61, 2
v_exp_f32 v74, v74
v_mfma_f32_16x16x32_bf16 v[168:171], a[84:87], v[64:67], v[168:171]
ds_read_b128 a[16:19], v4 offset:256
v_mfma_f32_16x16x32_bf16 v[172:175], a[92:95], v[64:67], v[172:175]
s_cbranch_scc1 PUB1
PUB1_RET:
v_exp_f32 v75, v75
v_mfma_f32_16x16x32_bf16 v[172:175], a[88:91], v[60:63], v[172:175]
ds_read_b128 a[20:23], v4 offset:320
v_cvt_pk_bf16_f32 v55, v74, v75
v_mfma_f32_16x16x32_bf16 v[92:95], a[32:35], a[240:243], v[48:51]
v_exp_f32 v76, v76
v_mfma_f32_16x16x32_bf16 v[92:95], a[36:39], a[244:247], v[92:95]
ds_read_b128 a[24:27], v4 offset:384
v_mfma_f32_16x16x32_bf16 v[92:95], a[40:43], a[248:251], v[92:95]
v_exp_f32 v77, v77
v_mfma_f32_16x16x32_bf16 v[92:95], a[44:47], a[252:255], v[92:95]
ds_read_b128 a[28:31], v4 offset:448
v_cvt_pk_bf16_f32 v56, v76, v77
v_mfma_f32_16x16x32_bf16 v[176:179], a[96:99], v[60:63], v[176:179]
v_exp_f32 v78, v78
v_mfma_f32_16x16x32_bf16 v[176:179], a[100:103], v[64:67], v[176:179]
ds_read_b128 a[32:35], v4 offset:512
v_mfma_f32_16x16x32_bf16 v[180:183], a[108:111], v[64:67], v[180:183]
v_exp_f32 v79, v79
v_mfma_f32_16x16x32_bf16 v[180:183], a[104:107], v[60:63], v[180:183]
ds_read_b128 a[36:39], v4 offset:576
v_cvt_pk_bf16_f32 v57, v78, v79
v_mfma_f32_16x16x32_bf16 v[96:99], a[48:51], a[240:243], v[48:51]
v_exp_f32 v80, v80
v_mfma_f32_16x16x32_bf16 v[96:99], a[52:55], a[244:247], v[96:99]
ds_read_b128 a[40:43], v4 offset:640
v_mfma_f32_16x16x32_bf16 v[96:99], a[56:59], a[248:251], v[96:99]
v_exp_f32 v81, v81
v_mfma_f32_16x16x32_bf16 v[96:99], a[60:63], a[252:255], v[96:99]
ds_read_b128 a[44:47], v4 offset:704
v_cvt_pk_bf16_f32 v58, v80, v81
v_mfma_f32_16x16x32_bf16 v[184:187], a[112:115], v[60:63], v[184:187]
v_exp_f32 v82, v82
v_mfma_f32_16x16x32_bf16 v[184:187], a[116:119], v[64:67], v[184:187]
ds_read_b128 a[48:51], v4 offset:768
v_mfma_f32_16x16x32_bf16 v[188:191], a[124:127], v[64:67], v[188:191]
v_exp_f32 v83, v83
v_mfma_f32_16x16x32_bf16 v[188:191], a[120:123], v[60:63], v[188:191]
ds_read_b128 a[52:55], v4 offset:832
v_cvt_pk_bf16_f32 v59, v82, v83
v_mfma_f32_16x16x32_bf16 v[24:27], v[16:19], v[60:63], v[24:27]
ds_read_b128 a[56:59], v4 offset:896
v_mfma_f32_16x16x32_bf16 v[24:27], v[16:19], v[64:67], v[24:27]
ds_read_b128 a[60:63], v4 offset:960
s_waitcnt lgkmcnt(15)
v_mfma_f32_16x16x32_bf16 v[68:71], a[0:3], a[192:195], v[36:39]
s_waitcnt lgkmcnt(14)
v_exp_f32 v84, v84
v_mfma_f32_16x16x32_bf16 v[68:71], a[4:7], a[196:199], v[68:71]
s_waitcnt lgkmcnt(13)
v_add_u32 v5, s48, v3
v_mfma_f32_16x16x32_bf16 v[68:71], a[8:11], a[200:203], v[68:71]
s_waitcnt lgkmcnt(12)
v_exp_f32 v85, v85
v_mfma_f32_16x16x32_bf16 v[68:71], a[12:15], a[204:207], v[68:71]
v_cvt_pk_bf16_f32 v60, v84, v85
v_mfma_f32_16x16x32_bf16 v[192:195], a[64:67], v[52:55], v[192:195]
s_add_u32 m0, s49, 0
v_exp_f32 v86, v86
v_mfma_f32_16x16x32_bf16 v[192:195], a[68:71], v[56:59], v[192:195]
buffer_load_dwordx4 v1, s[12:15], s50 offen offset:0 nt lds
v_mfma_f32_16x16x32_bf16 v[196:199], a[76:79], v[56:59], v[196:199]
v_exp_f32 v87, v87
v_mfma_f32_16x16x32_bf16 v[196:199], a[72:75], v[52:55], v[196:199]
s_waitcnt lgkmcnt(11)
v_cvt_pk_bf16_f32 v61, v86, v87
v_mfma_f32_16x16x32_bf16 v[72:75], a[16:19], a[192:195], v[36:39]
s_waitcnt lgkmcnt(10)
v_exp_f32 v88, v88
v_mfma_f32_16x16x32_bf16 v[72:75], a[20:23], a[196:199], v[72:75]
s_waitcnt lgkmcnt(9)
v_exp_f32 v89, v89
v_mfma_f32_16x16x32_bf16 v[72:75], a[24:27], a[200:203], v[72:75]
s_waitcnt lgkmcnt(8)
v_cvt_pk_bf16_f32 v62, v88, v89
v_mfma_f32_16x16x32_bf16 v[72:75], a[28:31], a[204:207], v[72:75]
v_exp_f32 v90, v90
v_mfma_f32_16x16x32_bf16 v[200:203], a[80:83], v[52:55], v[200:203]
s_add_u32 m0, s49, 32
v_exp_f32 v91, v91
v_mfma_f32_16x16x32_bf16 v[200:203], a[84:87], v[56:59], v[200:203]
buffer_load_dwordx4 v1, s[12:15], s50 offen offset:1024 nt lds
v_mfma_f32_16x16x32_bf16 v[204:207], a[92:95], v[56:59], v[204:207]
v_cvt_pk_bf16_f32 v63, v90, v91
v_mfma_f32_16x16x32_bf16 v[204:207], a[88:91], v[52:55], v[204:207]
s_waitcnt lgkmcnt(7)
v_exp_f32 v92, v92
v_mfma_f32_16x16x32_bf16 v[76:79], a[32:35], a[192:195], v[36:39]
s_waitcnt lgkmcnt(6)
v_exp_f32 v93, v93
v_mfma_f32_16x16x32_bf16 v[76:79], a[36:39], a[196:199], v[76:79]
s_waitcnt lgkmcnt(5)
v_cvt_pk_bf16_f32 v64, v92, v93
v_mfma_f32_16x16x32_bf16 v[76:79], a[40:43], a[200:203], v[76:79]
s_waitcnt lgkmcnt(4)
v_exp_f32 v94, v94
v_mfma_f32_16x16x32_bf16 v[76:79], a[44:47], a[204:207], v[76:79]
v_exp_f32 v95, v95
v_mfma_f32_16x16x32_bf16 v[208:211], a[96:99], v[52:55], v[208:211]
s_add_u32 m0, s49, 64
v_cvt_pk_bf16_f32 v65, v94, v95
v_mfma_f32_16x16x32_bf16 v[208:211], a[100:103], v[56:59], v[208:211]
buffer_load_dwordx4 v1, s[12:15], s50 offen offset:2048 nt lds
v_mfma_f32_16x16x32_bf16 v[212:215], a[108:111], v[56:59], v[212:215]
v_exp_f32 v96, v96
v_mfma_f32_16x16x32_bf16 v[212:215], a[104:107], v[52:55], v[212:215]
s_waitcnt lgkmcnt(3)
v_exp_f32 v97, v97
v_mfma_f32_16x16x32_bf16 v[80:83], a[48:51], a[192:195], v[36:39]
s_waitcnt lgkmcnt(2)
v_cvt_pk_bf16_f32 v66, v96, v97
v_mfma_f32_16x16x32_bf16 v[80:83], a[52:55], a[196:199], v[80:83]
s_waitcnt lgkmcnt(1)
v_exp_f32 v98, v98
v_mfma_f32_16x16x32_bf16 v[80:83], a[56:59], a[200:203], v[80:83]
s_waitcnt lgkmcnt(0)
v_exp_f32 v99, v99
v_mfma_f32_16x16x32_bf16 v[80:83], a[60:63], a[204:207], v[80:83]
v_cvt_pk_bf16_f32 v67, v98, v99
v_mfma_f32_16x16x32_bf16 v[216:219], a[112:115], v[52:55], v[216:219]
s_add_u32 m0, s49, 96
v_mfma_f32_16x16x32_bf16 v[216:219], a[116:119], v[56:59], v[216:219]
buffer_load_dwordx4 v1, s[12:15], s50 offen offset:3072 nt lds
v_mfma_f32_16x16x32_bf16 v[220:223], a[124:127], v[56:59], v[220:223]
v_mfma_f32_16x16x32_bf16 v[220:223], a[120:123], v[52:55], v[220:223]
v_mfma_f32_16x16x32_bf16 v[28:31], v[16:19], v[52:55], v[28:31]
v_mfma_f32_16x16x32_bf16 v[28:31], v[16:19], v[56:59], v[28:31]
v_mfma_f32_16x16x32_bf16 v[84:87], a[0:3], a[208:211], v[40:43]
v_exp_f32 v68, v68
v_mfma_f32_16x16x32_bf16 v[84:87], a[4:7], a[212:215], v[84:87]
v_exp_f32 v69, v69
v_mfma_f32_16x16x32_bf16 v[84:87], a[8:11], a[216:219], v[84:87]
v_cvt_pk_bf16_f32 v52, v68, v69
v_mfma_f32_16x16x32_bf16 v[84:87], a[12:15], a[220:223], v[84:87]
v_exp_f32 v70, v70
v_mfma_f32_16x16x32_bf16 v[224:227], a[64:67], v[60:63], v[224:227]
s_add_u32 m0, s49, 67584
v_exp_f32 v71, v71
v_mfma_f32_16x16x32_bf16 v[224:227], a[68:71], v[64:67], v[224:227]
buffer_load_dwordx4 v1, s[16:19], s50 offen offset:0 nt lds
v_mfma_f32_16x16x32_bf16 v[228:231], a[76:79], v[64:67], v[228:231]
v_cvt_pk_bf16_f32 v53, v70, v71
v_mfma_f32_16x16x32_bf16 v[228:231], a[72:75], v[60:63], v[228:231]
ds_read_b64_tr_b16 a[64:65], v5 offset:0
v_mfma_f32_16x16x32_bf16 v[88:91], a[16:19], a[208:211], v[40:43]
v_exp_f32 v72, v72
v_mfma_f32_16x16x32_bf16 v[88:91], a[20:23], a[212:215], v[88:91]
ds_read_b64_tr_b16 a[66:67], v5 offset:256
ds_read_b64_tr_b16 a[68:69], v5 offset:512
v_mfma_f32_16x16x32_bf16 v[88:91], a[24:27], a[216:219], v[88:91]
v_exp_f32 v73, v73
v_mfma_f32_16x16x32_bf16 v[88:91], a[28:31], a[220:223], v[88:91]
ds_read_b64_tr_b16 a[70:71], v5 offset:768
v_cvt_pk_bf16_f32 v54, v72, v73
v_mfma_f32_16x16x32_bf16 v[232:235], a[80:83], v[60:63], v[232:235]
v_exp_f32 v74, v74
v_mfma_f32_16x16x32_bf16 v[232:235], a[84:87], v[64:67], v[232:235]
ds_read_b64_tr_b16 a[72:73], v5 offset:32
ds_read_b64_tr_b16 a[74:75], v5 offset:288
v_mfma_f32_16x16x32_bf16 v[236:239], a[92:95], v[64:67], v[236:239]
v_exp_f32 v75, v75
v_mfma_f32_16x16x32_bf16 v[236:239], a[88:91], v[60:63], v[236:239]
ds_read_b64_tr_b16 a[76:77], v5 offset:544
v_cvt_pk_bf16_f32 v55, v74, v75
v_mfma_f32_16x16x32_bf16 v[92:95], a[32:35], a[208:211], v[40:43]
v_exp_f32 v76, v76
v_mfma_f32_16x16x32_bf16 v[92:95], a[36:39], a[212:215], v[92:95]
ds_read_b64_tr_b16 a[78:79], v5 offset:800
ds_read_b64_tr_b16 a[80:81], v5 offset:64
v_mfma_f32_16x16x32_bf16 v[92:95], a[40:43], a[216:219], v[92:95]
v_exp_f32 v77, v77
v_mfma_f32_16x16x32_bf16 v[92:95], a[44:47], a[220:223], v[92:95]
ds_read_b64_tr_b16 a[82:83], v5 offset:320
v_cvt_pk_bf16_f32 v56, v76, v77
v_mfma_f32_16x16x32_bf16 v[240:243], a[96:99], v[60:63], v[240:243]
v_exp_f32 v78, v78
v_mfma_f32_16x16x32_bf16 v[240:243], a[100:103], v[64:67], v[240:243]
ds_read_b64_tr_b16 a[84:85], v5 offset:576
ds_read_b64_tr_b16 a[86:87], v5 offset:832
v_mfma_f32_16x16x32_bf16 v[244:247], a[108:111], v[64:67], v[244:247]
v_exp_f32 v79, v79
v_mfma_f32_16x16x32_bf16 v[244:247], a[104:107], v[60:63], v[244:247]
ds_read_b64_tr_b16 a[88:89], v5 offset:96
v_cvt_pk_bf16_f32 v57, v78, v79
v_mfma_f32_16x16x32_bf16 v[96:99], a[48:51], a[208:211], v[40:43]
v_exp_f32 v80, v80
v_mfma_f32_16x16x32_bf16 v[96:99], a[52:55], a[212:215], v[96:99]
ds_read_b64_tr_b16 a[90:91], v5 offset:352
ds_read_b64_tr_b16 a[92:93], v5 offset:608
v_mfma_f32_16x16x32_bf16 v[96:99], a[56:59], a[216:219], v[96:99]
v_exp_f32 v81, v81
v_mfma_f32_16x16x32_bf16 v[96:99], a[60:63], a[220:223], v[96:99]
ds_read_b64_tr_b16 a[94:95], v5 offset:864
v_cvt_pk_bf16_f32 v58, v80, v81
v_mfma_f32_16x16x32_bf16 v[248:251], a[112:115], v[60:63], v[248:251]
v_exp_f32 v82, v82
v_mfma_f32_16x16x32_bf16 v[248:251], a[116:119], v[64:67], v[248:251]
ds_read_b64_tr_b16 a[96:97], v5 offset:128
ds_read_b64_tr_b16 a[98:99], v5 offset:384
v_mfma_f32_16x16x32_bf16 v[252:255], a[124:127], v[64:67], v[252:255]
v_exp_f32 v83, v83
v_mfma_f32_16x16x32_bf16 v[252:255], a[120:123], v[60:63], v[252:255]
ds_read_b64_tr_b16 a[100:101], v5 offset:640
v_cvt_pk_bf16_f32 v59, v82, v83
v_mfma_f32_16x16x32_bf16 v[32:35], v[16:19], v[60:63], v[32:35]
s_sub_u32 s51, s51, 1
ds_read_b64_tr_b16 a[102:103], v5 offset:896
ds_read_b64_tr_b16 a[104:105], v5 offset:160
v_mfma_f32_16x16x32_bf16 v[32:35], v[16:19], v[64:67], v[32:35]
s_cmp_lg_u32 s51, 0
ds_read_b64_tr_b16 a[106:107], v5 offset:416
ds_read_b64_tr_b16 a[108:109], v5 offset:672
s_cbranch_scc1 LOOP_B
C_T29:
v_mfma_f32_16x16x32_bf16 v[68:71], a[0:3], a[224:227], v[44:47]
v_exp_f32 v84, v84
v_mfma_f32_16x16x32_bf16 v[68:71], a[4:7], a[228:231], v[68:71]
ds_read_b64_tr_b16 a[110:111], v5 offset:928
ds_read_b64_tr_b16 a[112:113], v5 offset:192
v_mfma_f32_16x16x32_bf16 v[68:71], a[8:11], a[232:235], v[68:71]
v_exp_f32 v85, v85
v_mfma_f32_16x16x32_bf16 v[68:71], a[12:15], a[236:239], v[68:71]
s_waitcnt lgkmcnt(15)
ds_read_b64_tr_b16 a[114:115], v5 offset:448
v_cvt_pk_bf16_f32 v60, v84, v85
v_mfma_f32_16x16x32_bf16 v[128:131], a[64:67], v[52:55], v[128:131]
v_exp_f32 v86, v86
v_mfma_f32_16x16x32_bf16 v[128:131], a[68:71], v[56:59], v[128:131]
ds_read_b64_tr_b16 a[116:117], v5 offset:704
ds_read_b64_tr_b16 a[118:119], v5 offset:960
v_mfma_f32_16x16x32_bf16 v[132:135], a[76:79], v[56:59], v[132:135]
v_exp_f32 v87, v87
v_mfma_f32_16x16x32_bf16 v[132:135], a[72:75], v[52:55], v[132:135]
ds_read_b64_tr_b16 a[120:121], v5 offset:224
v_cvt_pk_bf16_f32 v61, v86, v87
v_mfma_f32_16x16x32_bf16 v[72:75], a[16:19], a[224:227], v[44:47]
v_exp_f32 v88, v88
v_mfma_f32_16x16x32_bf16 v[72:75], a[20:23], a[228:231], v[72:75]
ds_read_b64_tr_b16 a[122:123], v5 offset:480
ds_read_b64_tr_b16 a[124:125], v5 offset:736
v_mfma_f32_16x16x32_bf16 v[72:75], a[24:27], a[232:235], v[72:75]
v_exp_f32 v89, v89
v_mfma_f32_16x16x32_bf16 v[72:75], a[28:31], a[236:239], v[72:75]
s_waitcnt lgkmcnt(15)
ds_read_b64_tr_b16 a[126:127], v5 offset:992
v_cvt_pk_bf16_f32 v62, v88, v89
v_mfma_f32_16x16x32_bf16 v[136:139], a[80:83], v[52:55], v[136:139]
s_add_u32 m0, s49, 67616
v_exp_f32 v90, v90
v_mfma_f32_16x16x32_bf16 v[136:139], a[84:87], v[56:59], v[136:139]
buffer_load_dwordx4 v1, s[16:19], s50 offen offset:1024 nt lds
v_mfma_f32_16x16x32_bf16 v[140:143], a[92:95], v[56:59], v[140:143]
v_exp_f32 v91, v91
v_mfma_f32_16x16x32_bf16 v[140:143], a[88:91], v[52:55], v[140:143]
v_mov_b32 v7, 163836
v_cvt_pk_bf16_f32 v63, v90, v91
v_mfma_f32_16x16x32_bf16 v[76:79], a[32:35], a[224:227], v[44:47]
v_exp_f32 v92, v92
v_mfma_f32_16x16x32_bf16 v[76:79], a[36:39], a[228:231], v[76:79]
ds_read_b32 v8, v7
v_mfma_f32_16x16x32_bf16 v[76:79], a[40:43], a[232:235], v[76:79]
v_exp_f32 v93, v93
v_mfma_f32_16x16x32_bf16 v[76:79], a[44:47], a[236:239], v[76:79]
s_waitcnt lgkmcnt(13)
v_cvt_pk_bf16_f32 v64, v92, v93
v_mfma_f32_16x16x32_bf16 v[144:147], a[96:99], v[52:55], v[144:147]
s_add_u32 m0, s49, 67648
v_exp_f32 v94, v94
v_mfma_f32_16x16x32_bf16 v[144:147], a[100:103], v[56:59], v[144:147]
s_waitcnt lgkmcnt(9)
buffer_load_dwordx4 v1, s[16:19], s50 offen offset:2048 nt lds
v_mfma_f32_16x16x32_bf16 v[148:151], a[108:111], v[56:59], v[148:151]
v_exp_f32 v95, v95
v_mfma_f32_16x16x32_bf16 v[148:151], a[104:107], v[52:55], v[148:151]
v_cvt_pk_bf16_f32 v65, v94, v95
v_mfma_f32_16x16x32_bf16 v[80:83], a[48:51], a[224:227], v[44:47]
v_exp_f32 v96, v96
v_mfma_f32_16x16x32_bf16 v[80:83], a[52:55], a[228:231], v[80:83]
v_exp_f32 v97, v97
v_mfma_f32_16x16x32_bf16 v[80:83], a[56:59], a[232:235], v[80:83]
v_cvt_pk_bf16_f32 v66, v96, v97
v_mfma_f32_16x16x32_bf16 v[80:83], a[60:63], a[236:239], v[80:83]
s_waitcnt lgkmcnt(5)
v_exp_f32 v98, v98
v_mfma_f32_16x16x32_bf16 v[152:155], a[112:115], v[52:55], v[152:155]
s_add_u32 m0, s49, 67680
v_exp_f32 v99, v99
v_mfma_f32_16x16x32_bf16 v[152:155], a[116:119], v[56:59], v[152:155]
s_waitcnt lgkmcnt(1)
buffer_load_dwordx4 v1, s[16:19], s50 offen offset:3072 nt lds
v_mfma_f32_16x16x32_bf16 v[156:159], a[124:127], v[56:59], v[156:159]
s_mov_b32 s57, s47
v_cvt_pk_bf16_f32 v67, v98, v99
s_waitcnt lgkmcnt(0)
v_readfirstlane_b32 s94, v8
v_mfma_f32_16x16x32_bf16 v[156:159], a[120:123], v[52:55], v[156:159]
s_mov_b32 s47, s48
v_mfma_f32_16x16x32_bf16 v[20:23], v[16:19], v[52:55], v[20:23]
s_add_u32 s50, s50, 16384
v_mfma_f32_16x16x32_bf16 v[20:23], v[16:19], v[56:59], v[20:23]
global_load_dwordx2 v[122:123], v121, s[80:81] sc1
v_mfma_f32_16x16x32_bf16 v[84:87], a[0:3], a[240:243], v[48:51]
s_add_u32 s48, s47, 16896
v_exp_f32 v68, v68
v_mfma_f32_16x16x32_bf16 v[84:87], a[4:7], a[244:247], v[84:87]
s_cmp_eq_u32 s48, 67584
v_exp_f32 v69, v69
v_mfma_f32_16x16x32_bf16 v[84:87], a[8:11], a[248:251], v[84:87]
s_cselect_b32 s48, 0, s48
v_cvt_pk_bf16_f32 v52, v68, v69
v_mfma_f32_16x16x32_bf16 v[84:87], a[12:15], a[252:255], v[84:87]
s_waitcnt vmcnt(9)
v_add_u32 v4, s48, v2
v_mfma_f32_16x16x32_bf16 v[160:163], a[64:67], v[60:63], v[160:163]
s_barrier
v_exp_f32 v70, v70
v_mfma_f32_16x16x32_bf16 v[160:163], a[68:71], v[64:67], v[160:163]
ds_read_b128 a[0:3], v4 offset:0
v_mfma_f32_16x16x32_bf16 v[164:167], a[76:79], v[64:67], v[164:167]
s_add_u32 s49, s57, s43
v_exp_f32 v71, v71
v_mfma_f32_16x16x32_bf16 v[164:167], a[72:75], v[60:63], v[164:167]
ds_read_b128 a[4:7], v4 offset:64
v_cvt_pk_bf16_f32 v53, v70, v71
v_mfma_f32_16x16x32_bf16 v[88:91], a[16:19], a[240:243], v[48:51]
v_exp_f32 v72, v72
v_mfma_f32_16x16x32_bf16 v[88:91], a[20:23], a[244:247], v[88:91]
ds_read_b128 a[8:11], v4 offset:128
v_mfma_f32_16x16x32_bf16 v[88:91], a[24:27], a[248:251], v[88:91]
v_exp_f32 v73, v73
v_mfma_f32_16x16x32_bf16 v[88:91], a[28:31], a[252:255], v[88:91]
ds_read_b128 a[12:15], v4 offset:192
v_cvt_pk_bf16_f32 v54, v72, v73
v_mfma_f32_16x16x32_bf16 v[168:171], a[80:83], v[60:63], v[168:171]
v_exp_f32 v74, v74
v_mfma_f32_16x16x32_bf16 v[168:171], a[84:87], v[64:67], v[168:171]
ds_read_b128 a[16:19], v4 offset:256
v_mfma_f32_16x16x32_bf16 v[172:175], a[92:95], v[64:67], v[172:175]
v_exp_f32 v75, v75
v_mfma_f32_16x16x32_bf16 v[172:175], a[88:91], v[60:63], v[172:175]
ds_read_b128 a[20:23], v4 offset:320
v_cvt_pk_bf16_f32 v55, v74, v75
v_mfma_f32_16x16x32_bf16 v[92:95], a[32:35], a[240:243], v[48:51]
v_exp_f32 v76, v76
v_mfma_f32_16x16x32_bf16 v[92:95], a[36:39], a[244:247], v[92:95]
ds_read_b128 a[24:27], v4 offset:384
v_mfma_f32_16x16x32_bf16 v[92:95], a[40:43], a[248:251], v[92:95]
v_exp_f32 v77, v77
v_mfma_f32_16x16x32_bf16 v[92:95], a[44:47], a[252:255], v[92:95]
ds_read_b128 a[28:31], v4 offset:448
v_cvt_pk_bf16_f32 v56, v76, v77
v_mfma_f32_16x16x32_bf16 v[176:179], a[96:99], v[60:63], v[176:179]
v_exp_f32 v78, v78
v_mfma_f32_16x16x32_bf16 v[176:179], a[100:103], v[64:67], v[176:179]
ds_read_b128 a[32:35], v4 offset:512
v_mfma_f32_16x16x32_bf16 v[180:183], a[108:111], v[64:67], v[180:183]
v_exp_f32 v79, v79
v_mfma_f32_16x16x32_bf16 v[180:183], a[104:107], v[60:63], v[180:183]
ds_read_b128 a[36:39], v4 offset:576
v_cvt_pk_bf16_f32 v57, v78, v79
v_mfma_f32_16x16x32_bf16 v[96:99], a[48:51], a[240:243], v[48:51]
v_exp_f32 v80, v80
v_mfma_f32_16x16x32_bf16 v[96:99], a[52:55], a[244:247], v[96:99]
ds_read_b128 a[40:43], v4 offset:640
v_mfma_f32_16x16x32_bf16 v[96:99], a[56:59], a[248:251], v[96:99]
v_exp_f32 v81, v81
v_mfma_f32_16x16x32_bf16 v[96:99], a[60:63], a[252:255], v[96:99]
ds_read_b128 a[44:47], v4 offset:704
v_cvt_pk_bf16_f32 v58, v80, v81
v_mfma_f32_16x16x32_bf16 v[184:187], a[112:115], v[60:63], v[184:187]
v_exp_f32 v82, v82
v_mfma_f32_16x16x32_bf16 v[184:187], a[116:119], v[64:67], v[184:187]
ds_read_b128 a[48:51], v4 offset:768
v_mfma_f32_16x16x32_bf16 v[188:191], a[124:127], v[64:67], v[188:191]
v_exp_f32 v83, v83
v_mfma_f32_16x16x32_bf16 v[188:191], a[120:123], v[60:63], v[188:191]
ds_read_b128 a[52:55], v4 offset:832
v_cvt_pk_bf16_f32 v59, v82, v83
v_mfma_f32_16x16x32_bf16 v[24:27], v[16:19], v[60:63], v[24:27]
ds_read_b128 a[56:59], v4 offset:896
v_mfma_f32_16x16x32_bf16 v[24:27], v[16:19], v[64:67], v[24:27]
ds_read_b128 a[60:63], v4 offset:960
s_waitcnt lgkmcnt(15)
v_mfma_f32_16x16x32_bf16 v[68:71], a[0:3], a[192:195], v[36:39]
s_waitcnt lgkmcnt(14)
v_exp_f32 v84, v84
v_mfma_f32_16x16x32_bf16 v[68:71], a[4:7], a[196:199], v[68:71]
s_waitcnt lgkmcnt(13)
v_add_u32 v5, s48, v3
v_mfma_f32_16x16x32_bf16 v[68:71], a[8:11], a[200:203], v[68:71]
s_waitcnt lgkmcnt(12)
v_exp_f32 v85, v85
v_mfma_f32_16x16x32_bf16 v[68:71], a[12:15], a[204:207], v[68:71]
v_cvt_pk_bf16_f32 v60, v84, v85
v_mfma_f32_16x16x32_bf16 v[192:195], a[64:67], v[52:55], v[192:195]
s_add_u32 m0, s90, 0
v_exp_f32 v86, v86
v_mfma_f32_16x16x32_bf16 v[192:195], a[68:71], v[56:59], v[192:195]
buffer_load_dwordx4 v118, s[8:11], s89 offen offset:0  lds
v_mfma_f32_16x16x32_bf16 v[196:199], a[76:79], v[56:59], v[196:199]
v_exp_f32 v87, v87
v_mfma_f32_16x16x32_bf16 v[196:199], a[72:75], v[52:55], v[196:199]
s_waitcnt lgkmcnt(11)
v_cvt_pk_bf16_f32 v61, v86, v87
v_mfma_f32_16x16x32_bf16 v[72:75], a[16:19], a[192:195], v[36:39]
s_waitcnt lgkmcnt(10)
v_exp_f32 v88, v88
v_mfma_f32_16x16x32_bf16 v[72:75], a[20:23], a[196:199], v[72:75]
s_waitcnt lgkmcnt(9)
v_exp_f32 v89, v89
v_mfma_f32_16x16x32_bf16 v[72:75], a[24:27], a[200:203], v[72:75]
s_waitcnt lgkmcnt(8)
v_cvt_pk_bf16_f32 v62, v88, v89
v_mfma_f32_16x16x32_bf16 v[72:75], a[28:31], a[204:207], v[72:75]
v_exp_f32 v90, v90
v_mfma_f32_16x16x32_bf16 v[200:203], a[80:83], v[52:55], v[200:203]
s_add_u32 m0, s90, 32
v_exp_f32 v91, v91
v_mfma_f32_16x16x32_bf16 v[200:203], a[84:87], v[56:59], v[200:203]
buffer_load_dwordx4 v118, s[8:11], s89 offen offset:1024  lds
v_mfma_f32_16x16x32_bf16 v[204:207], a[92:95], v[56:59], v[204:207]
v_cvt_pk_bf16_f32 v63, v90, v91
v_mfma_f32_16x16x32_bf16 v[204:207], a[88:91], v[52:55], v[204:207]
s_waitcnt lgkmcnt(7)
v_exp_f32 v92, v92
v_mfma_f32_16x16x32_bf16 v[76:79], a[32:35], a[192:195], v[36:39]
s_waitcnt lgkmcnt(6)
v_exp_f32 v93, v93
v_mfma_f32_16x16x32_bf16 v[76:79], a[36:39], a[196:199], v[76:79]
s_waitcnt lgkmcnt(5)
v_cvt_pk_bf16_f32 v64, v92, v93
v_mfma_f32_16x16x32_bf16 v[76:79], a[40:43], a[200:203], v[76:79]
s_waitcnt lgkmcnt(4)
v_exp_f32 v94, v94
v_mfma_f32_16x16x32_bf16 v[76:79], a[44:47], a[204:207], v[76:79]
v_exp_f32 v95, v95
v_mfma_f32_16x16x32_bf16 v[208:211], a[96:99], v[52:55], v[208:211]
s_add_u32 m0, s90, 64
v_cvt_pk_bf16_f32 v65, v94, v95
v_mfma_f32_16x16x32_bf16 v[208:211], a[100:103], v[56:59], v[208:211]
buffer_load_dwordx4 v118, s[8:11], s89 offen offset:2048  lds
v_mfma_f32_16x16x32_bf16 v[212:215], a[108:111], v[56:59], v[212:215]
v_exp_f32 v96, v96
v_mfma_f32_16x16x32_bf16 v[212:215], a[104:107], v[52:55], v[212:215]
s_waitcnt lgkmcnt(3)
v_exp_f32 v97, v97
v_mfma_f32_16x16x32_bf16 v[80:83], a[48:51], a[192:195], v[36:39]
s_waitcnt lgkmcnt(2)
v_cvt_pk_bf16_f32 v66, v96, v97
v_mfma_f32_16x16x32_bf16 v[80:83], a[52:55], a[196:199], v[80:83]
s_waitcnt lgkmcnt(1)
v_exp_f32 v98, v98
v_mfma_f32_16x16x32_bf16 v[80:83], a[56:59], a[200:203], v[80:83]
s_waitcnt lgkmcnt(0)
v_exp_f32 v99, v99
v_mfma_f32_16x16x32_bf16 v[80:83], a[60:63], a[204:207], v[80:83]
v_cvt_pk_bf16_f32 v67, v98, v99
v_mfma_f32_16x16x32_bf16 v[216:219], a[112:115], v[52:55], v[216:219]
s_add_u32 m0, s90, 96
v_mfma_f32_16x16x32_bf16 v[216:219], a[116:119], v[56:59], v[216:219]
buffer_load_dwordx4 v118, s[8:11], s89 offen offset:3072  lds
v_mfma_f32_16x16x32_bf16 v[220:223], a[124:127], v[56:59], v[220:223]
v_mfma_f32_16x16x32_bf16 v[220:223], a[120:123], v[52:55], v[220:223]
v_mfma_f32_16x16x32_bf16 v[28:31], v[16:19], v[52:55], v[28:31]
v_mfma_f32_16x16x32_bf16 v[28:31], v[16:19], v[56:59], v[28:31]
s_waitcnt vmcnt(4)
v_readfirstlane_b32 s61, v122
v_readfirstlane_b32 s62, v123
s_cmp_eq_u32 s93, 0
s_cselect_b32 s61, s61, s62
s_and_b32 s61, s61, 0xfff8
s_or_b32 s61, s61, s94
s_cmp_eq_u32 s61, 0
s_cbranch_scc1 SPIN1
SPIN1_RET:
v_mfma_f32_16x16x32_bf16 v[84:87], a[0:3], a[208:211], v[40:43]
s_mov_b32 s63, 0
v_exp_f32 v68, v68
v_mfma_f32_16x16x32_bf16 v[84:87], a[4:7], a[212:215], v[84:87]
buffer_load_dword v125, v124, s[36:39], s63 offen
v_mfma_f32_16x16x32_bf16 v[84:87], a[8:11], a[216:219], v[84:87]
v_exp_f32 v69, v69
v_mfma_f32_16x16x32_bf16 v[84:87], a[12:15], a[220:223], v[84:87]
v_cvt_pk_bf16_f32 v52, v68, v69
v_mfma_f32_16x16x32_bf16 v[224:227], a[64:67], v[60:63], v[224:227]
s_add_u32 m0, s90, 4224
v_exp_f32 v70, v70
v_mfma_f32_16x16x32_bf16 v[224:227], a[68:71], v[64:67], v[224:227]
buffer_load_dwordx4 v119, s[8:11], s89 offen offset:0  lds
v_mfma_f32_16x16x32_bf16 v[228:231], a[76:79], v[64:67], v[228:231]
v_exp_f32 v71, v71
v_mfma_f32_16x16x32_bf16 v[228:231], a[72:75], v[60:63], v[228:231]
ds_read_b64_tr_b16 a[64:65], v5 offset:0
v_cvt_pk_bf16_f32 v53, v70, v71
v_mfma_f32_16x16x32_bf16 v[88:91], a[16:19], a[208:211], v[40:43]
v_exp_f32 v72, v72
v_mfma_f32_16x16x32_bf16 v[88:91], a[20:23], a[212:215], v[88:91]
ds_read_b64_tr_b16 a[66:67], v5 offset:256
ds_read_b64_tr_b16 a[68:69], v5 offset:512
v_mfma_f32_16x16x32_bf16 v[88:91], a[24:27], a[216:219], v[88:91]
v_exp_f32 v73, v73
v_mfma_f32_16x16x32_bf16 v[88:91], a[28:31], a[220:223], v[88:91]
ds_read_b64_tr_b16 a[70:71], v5 offset:768
v_cvt_pk_bf16_f32 v54, v72, v73
v_mfma_f32_16x16x32_bf16 v[232:235], a[80:83], v[60:63], v[232:235]
v_exp_f32 v74, v74
v_mfma_f32_16x16x32_bf16 v[232:235], a[84:87], v[64:67], v[232:235]
ds_read_b64_tr_b16 a[72:73], v5 offset:32
ds_read_b64_tr_b16 a[74:75], v5 offset:288
v_mfma_f32_16x16x32_bf16 v[236:239], a[92:95], v[64:67], v[236:239]
v_exp_f32 v75, v75
v_mfma_f32_16x16x32_bf16 v[236:239], a[88:91], v[60:63], v[236:239]
ds_read_b64_tr_b16 a[76:77], v5 offset:544
v_cvt_pk_bf16_f32 v55, v74, v75
v_mfma_f32_16x16x32_bf16 v[92:95], a[32:35], a[208:211], v[40:43]
v_exp_f32 v76, v76
v_mfma_f32_16x16x32_bf16 v[92:95], a[36:39], a[212:215], v[92:95]
ds_read_b64_tr_b16 a[78:79], v5 offset:800
ds_read_b64_tr_b16 a[80:81], v5 offset:64
v_mfma_f32_16x16x32_bf16 v[92:95], a[40:43], a[216:219], v[92:95]
v_exp_f32 v77, v77
v_mfma_f32_16x16x32_bf16 v[92:95], a[44:47], a[220:223], v[92:95]
ds_read_b64_tr_b16 a[82:83], v5 offset:320
v_cvt_pk_bf16_f32 v56, v76, v77
v_mfma_f32_16x16x32_bf16 v[240:243], a[96:99], v[60:63], v[240:243]
v_exp_f32 v78, v78
v_mfma_f32_16x16x32_bf16 v[240:243], a[100:103], v[64:67], v[240:243]
ds_read_b64_tr_b16 a[84:85], v5 offset:576
ds_read_b64_tr_b16 a[86:87], v5 offset:832
v_mfma_f32_16x16x32_bf16 v[244:247], a[108:111], v[64:67], v[244:247]
v_exp_f32 v79, v79
v_mfma_f32_16x16x32_bf16 v[244:247], a[104:107], v[60:63], v[244:247]
ds_read_b64_tr_b16 a[88:89], v5 offset:96
v_cvt_pk_bf16_f32 v57, v78, v79
v_mfma_f32_16x16x32_bf16 v[96:99], a[48:51], a[208:211], v[40:43]
v_exp_f32 v80, v80
v_mfma_f32_16x16x32_bf16 v[96:99], a[52:55], a[212:215], v[96:99]
ds_read_b64_tr_b16 a[90:91], v5 offset:352
ds_read_b64_tr_b16 a[92:93], v5 offset:608
v_mfma_f32_16x16x32_bf16 v[96:99], a[56:59], a[216:219], v[96:99]
v_exp_f32 v81, v81
v_mfma_f32_16x16x32_bf16 v[96:99], a[60:63], a[220:223], v[96:99]
ds_read_b64_tr_b16 a[94:95], v5 offset:864
v_cvt_pk_bf16_f32 v58, v80, v81
v_mfma_f32_16x16x32_bf16 v[248:251], a[112:115], v[60:63], v[248:251]
v_exp_f32 v82, v82
v_mfma_f32_16x16x32_bf16 v[248:251], a[116:119], v[64:67], v[248:251]
ds_read_b64_tr_b16 a[96:97], v5 offset:128
ds_read_b64_tr_b16 a[98:99], v5 offset:384
v_mfma_f32_16x16x32_bf16 v[252:255], a[124:127], v[64:67], v[252:255]
v_exp_f32 v83, v83
v_mfma_f32_16x16x32_bf16 v[252:255], a[120:123], v[60:63], v[252:255]
ds_read_b64_tr_b16 a[100:101], v5 offset:640
v_cvt_pk_bf16_f32 v59, v82, v83
v_mfma_f32_16x16x32_bf16 v[32:35], v[16:19], v[60:63], v[32:35]
ds_read_b64_tr_b16 a[102:103], v5 offset:896
ds_read_b64_tr_b16 a[104:105], v5 offset:160
v_mfma_f32_16x16x32_bf16 v[32:35], v[16:19], v[64:67], v[32:35]
ds_read_b64_tr_b16 a[106:107], v5 offset:416
ds_read_b64_tr_b16 a[108:109], v5 offset:672
v_mfma_f32_16x16x32_bf16 v[68:71], a[0:3], a[224:227], v[44:47]
v_exp_f32 v84, v84
v_mfma_f32_16x16x32_bf16 v[68:71], a[4:7], a[228:231], v[68:71]
ds_read_b64_tr_b16 a[110:111], v5 offset:928
ds_read_b64_tr_b16 a[112:113], v5 offset:192
v_mfma_f32_16x16x32_bf16 v[68:71], a[8:11], a[232:235], v[68:71]
v_exp_f32 v85, v85
v_mfma_f32_16x16x32_bf16 v[68:71], a[12:15], a[236:239], v[68:71]
s_waitcnt lgkmcnt(15)
ds_read_b64_tr_b16 a[114:115], v5 offset:448
v_cvt_pk_bf16_f32 v60, v84, v85
v_mfma_f32_16x16x32_bf16 v[128:131], a[64:67], v[52:55], v[128:131]
v_exp_f32 v86, v86
v_mfma_f32_16x16x32_bf16 v[128:131], a[68:71], v[56:59], v[128:131]
ds_read_b64_tr_b16 a[116:117], v5 offset:704
ds_read_b64_tr_b16 a[118:119], v5 offset:960
v_mfma_f32_16x16x32_bf16 v[132:135], a[76:79], v[56:59], v[132:135]
v_exp_f32 v87, v87
v_mfma_f32_16x16x32_bf16 v[132:135], a[72:75], v[52:55], v[132:135]
ds_read_b64_tr_b16 a[120:121], v5 offset:224
v_cvt_pk_bf16_f32 v61, v86, v87
v_mfma_f32_16x16x32_bf16 v[72:75], a[16:19], a[224:227], v[44:47]
v_exp_f32 v88, v88
v_mfma_f32_16x16x32_bf16 v[72:75], a[20:23], a[228:231], v[72:75]
ds_read_b64_tr_b16 a[122:123], v5 offset:480
ds_read_b64_tr_b16 a[124:125], v5 offset:736
v_mfma_f32_16x16x32_bf16 v[72:75], a[24:27], a[232:235], v[72:75]
v_exp_f32 v89, v89
v_mfma_f32_16x16x32_bf16 v[72:75], a[28:31], a[236:239], v[72:75]
s_waitcnt lgkmcnt(15)
ds_read_b64_tr_b16 a[126:127], v5 offset:992
v_cvt_pk_bf16_f32 v62, v88, v89
v_mfma_f32_16x16x32_bf16 v[136:139], a[80:83], v[52:55], v[136:139]
s_add_u32 m0, s90, 4256
v_exp_f32 v90, v90
v_mfma_f32_16x16x32_bf16 v[136:139], a[84:87], v[56:59], v[136:139]
buffer_load_dwordx4 v119, s[8:11], s89 offen offset:1024  lds
v_mfma_f32_16x16x32_bf16 v[140:143], a[92:95], v[56:59], v[140:143]
v_exp_f32 v91, v91
v_mfma_f32_16x16x32_bf16 v[140:143], a[88:91], v[52:55], v[140:143]
v_cvt_pk_bf16_f32 v63, v90, v91
v_mfma_f32_16x16x32_bf16 v[76:79], a[32:35], a[224:227], v[44:47]
v_exp_f32 v92, v92
v_mfma_f32_16x16x32_bf16 v[76:79], a[36:39], a[228:231], v[76:79]
v_exp_f32 v93, v93
v_mfma_f32_16x16x32_bf16 v[76:79], a[40:43], a[232:235], v[76:79]
v_cvt_pk_bf16_f32 v64, v92, v93
v_mfma_f32_16x16x32_bf16 v[76:79], a[44:47], a[236:239], v[76:79]
s_waitcnt lgkmcnt(12)
v_exp_f32 v94, v94
v_mfma_f32_16x16x32_bf16 v[144:147], a[96:99], v[52:55], v[144:147]
s_add_u32 m0, s90, 4288
v_exp_f32 v95, v95
v_mfma_f32_16x16x32_bf16 v[144:147], a[100:103], v[56:59], v[144:147]
s_waitcnt lgkmcnt(8)
buffer_load_dwordx4 v119, s[8:11], s89 offen offset:2048  lds
v_mfma_f32_16x16x32_bf16 v[148:151], a[108:111], v[56:59], v[148:151]
v_cvt_pk_bf16_f32 v65, v94, v95
v_mfma_f32_16x16x32_bf16 v[148:151], a[104:107], v[52:55], v[148:151]
v_exp_f32 v96, v96
v_mfma_f32_16x16x32_bf16 v[80:83], a[48:51], a[224:227], v[44:47]
s_mov_b32 s63, 32768
v_exp_f32 v97, v97
v_mfma_f32_16x16x32_bf16 v[80:83], a[52:55], a[228:231], v[80:83]
buffer_load_dword v125, v124, s[36:39], s63 offen
v_mfma_f32_16x16x32_bf16 v[80:83], a[56:59], a[232:235], v[80:83]
v_cvt_pk_bf16_f32 v66, v96, v97
v_mfma_f32_16x16x32_bf16 v[80:83], a[60:63], a[236:239], v[80:83]
s_waitcnt lgkmcnt(4)
v_exp_f32 v98, v98
v_mfma_f32_16x16x32_bf16 v[152:155], a[112:115], v[52:55], v[152:155]
s_add_u32 m0, s90, 4320
v_exp_f32 v99, v99
v_mfma_f32_16x16x32_bf16 v[152:155], a[116:119], v[56:59], v[152:155]
s_waitcnt lgkmcnt(0)
buffer_load_dwordx4 v119, s[8:11], s89 offen offset:3072  lds
v_mfma_f32_16x16x32_bf16 v[156:159], a[124:127], v[56:59], v[156:159]
s_mov_b32 s57, s47
v_cvt_pk_bf16_f32 v67, v98, v99
v_mfma_f32_16x16x32_bf16 v[156:159], a[120:123], v[52:55], v[156:159]
s_mov_b32 s47, s48
v_mfma_f32_16x16x32_bf16 v[20:23], v[16:19], v[52:55], v[20:23]
s_add_u32 s50, s50, 16384
v_mfma_f32_16x16x32_bf16 v[20:23], v[16:19], v[56:59], v[20:23]
s_add_u32 s89, s89, 0x40000
s_cmp_eq_u32 s89, 0x200000
s_cselect_b32 s89, 0x20000, s89
v_mfma_f32_16x16x32_bf16 v[84:87], a[0:3], a[240:243], v[48:51]
s_add_u32 s48, s47, 16896
v_exp_f32 v68, v68
v_mfma_f32_16x16x32_bf16 v[84:87], a[4:7], a[244:247], v[84:87]
s_cmp_eq_u32 s48, 67584
v_exp_f32 v69, v69
v_mfma_f32_16x16x32_bf16 v[84:87], a[8:11], a[248:251], v[84:87]
s_cselect_b32 s48, 0, s48
v_cvt_pk_bf16_f32 v52, v68, v69
v_mfma_f32_16x16x32_bf16 v[84:87], a[12:15], a[252:255], v[84:87]
s_waitcnt vmcnt(10)
v_add_u32 v4, s48, v2
v_mfma_f32_16x16x32_bf16 v[160:163], a[64:67], v[60:63], v[160:163]
s_barrier
v_exp_f32 v70, v70
v_mfma_f32_16x16x32_bf16 v[160:163], a[68:71], v[64:67], v[160:163]
ds_read_b128 a[0:3], v4 offset:0
v_mfma_f32_16x16x32_bf16 v[164:167], a[76:79], v[64:67], v[164:167]
s_add_u32 s49, s57, s43
v_exp_f32 v71, v71
v_mfma_f32_16x16x32_bf16 v[164:167], a[72:75], v[60:63], v[164:167]
ds_read_b128 a[4:7], v4 offset:64
v_cvt_pk_bf16_f32 v53, v70, v71
v_mfma_f32_16x16x32_bf16 v[88:91], a[16:19], a[240:243], v[48:51]
v_exp_f32 v72, v72
v_mfma_f32_16x16x32_bf16 v[88:91], a[20:23], a[244:247], v[88:91]
ds_read_b128 a[8:11], v4 offset:128
v_mfma_f32_16x16x32_bf16 v[88:91], a[24:27], a[248:251], v[88:91]
v_exp_f32 v73, v73
v_mfma_f32_16x16x32_bf16 v[88:91], a[28:31], a[252:255], v[88:91]
ds_read_b128 a[12:15], v4 offset:192
v_cvt_pk_bf16_f32 v54, v72, v73
v_mfma_f32_16x16x32_bf16 v[168:171], a[80:83], v[60:63], v[168:171]
v_exp_f32 v74, v74
v_mfma_f32_16x16x32_bf16 v[168:171], a[84:87], v[64:67], v[168:171]
ds_read_b128 a[16:19], v4 offset:256
v_mfma_f32_16x16x32_bf16 v[172:175], a[92:95], v[64:67], v[172:175]
v_exp_f32 v75, v75
v_mfma_f32_16x16x32_bf16 v[172:175], a[88:91], v[60:63], v[172:175]
ds_read_b128 a[20:23], v4 offset:320
v_cvt_pk_bf16_f32 v55, v74, v75
v_mfma_f32_16x16x32_bf16 v[92:95], a[32:35], a[240:243], v[48:51]
v_exp_f32 v76, v76
v_mfma_f32_16x16x32_bf16 v[92:95], a[36:39], a[244:247], v[92:95]
ds_read_b128 a[24:27], v4 offset:384
v_mfma_f32_16x16x32_bf16 v[92:95], a[40:43], a[248:251], v[92:95]
v_exp_f32 v77, v77
v_mfma_f32_16x16x32_bf16 v[92:95], a[44:47], a[252:255], v[92:95]
ds_read_b128 a[28:31], v4 offset:448
v_cvt_pk_bf16_f32 v56, v76, v77
v_mfma_f32_16x16x32_bf16 v[176:179], a[96:99], v[60:63], v[176:179]
v_exp_f32 v78, v78
v_mfma_f32_16x16x32_bf16 v[176:179], a[100:103], v[64:67], v[176:179]
ds_read_b128 a[32:35], v4 offset:512
v_mfma_f32_16x16x32_bf16 v[180:183], a[108:111], v[64:67], v[180:183]
v_exp_f32 v79, v79
v_mfma_f32_16x16x32_bf16 v[180:183], a[104:107], v[60:63], v[180:183]
ds_read_b128 a[36:39], v4 offset:576
v_cvt_pk_bf16_f32 v57, v78, v79
v_mfma_f32_16x16x32_bf16 v[96:99], a[48:51], a[240:243], v[48:51]
v_exp_f32 v80, v80
v_mfma_f32_16x16x32_bf16 v[96:99], a[52:55], a[244:247], v[96:99]
ds_read_b128 a[40:43], v4 offset:640
v_mfma_f32_16x16x32_bf16 v[96:99], a[56:59], a[248:251], v[96:99]
v_exp_f32 v81, v81
v_mfma_f32_16x16x32_bf16 v[96:99], a[60:63], a[252:255], v[96:99]
ds_read_b128 a[44:47], v4 offset:704
v_cvt_pk_bf16_f32 v58, v80, v81
v_mfma_f32_16x16x32_bf16 v[184:187], a[112:115], v[60:63], v[184:187]
v_exp_f32 v82, v82
v_mfma_f32_16x16x32_bf16 v[184:187], a[116:119], v[64:67], v[184:187]
ds_read_b128 a[48:51], v4 offset:768
v_mfma_f32_16x16x32_bf16 v[188:191], a[124:127], v[64:67], v[188:191]
v_exp_f32 v83, v83
v_mfma_f32_16x16x32_bf16 v[188:191], a[120:123], v[60:63], v[188:191]
ds_read_b128 a[52:55], v4 offset:832
v_cvt_pk_bf16_f32 v59, v82, v83
v_mfma_f32_16x16x32_bf16 v[24:27], v[16:19], v[60:63], v[24:27]
ds_read_b128 a[56:59], v4 offset:896
v_mfma_f32_16x16x32_bf16 v[24:27], v[16:19], v[64:67], v[24:27]
ds_read_b128 a[60:63], v4 offset:960
s_waitcnt lgkmcnt(15)
v_mfma_f32_16x16x32_bf16 v[68:71], a[0:3], a[192:195], v[36:39]
s_waitcnt lgkmcnt(14)
v_exp_f32 v84, v84
v_mfma_f32_16x16x32_bf16 v[68:71], a[4:7], a[196:199], v[68:71]
s_waitcnt lgkmcnt(13)
v_add_u32 v5, s48, v3
v_mfma_f32_16x16x32_bf16 v[68:71], a[8:11], a[200:203], v[68:71]
s_waitcnt lgkmcnt(12)
v_exp_f32 v85, v85
v_mfma_f32_16x16x32_bf16 v[68:71], a[12:15], a[204:207], v[68:71]
v_cvt_pk_bf16_f32 v60, v84, v85
v_mfma_f32_16x16x32_bf16 v[192:195], a[64:67], v[52:55], v[192:195]
s_add_u32 m0, s90, 67584
v_exp_f32 v86, v86
v_mfma_f32_16x16x32_bf16 v[192:195], a[68:71], v[56:59], v[192:195]
buffer_load_dwordx4 v118, s[8:11], s89 offen offset:0  lds
v_mfma_f32_16x16x32_bf16 v[196:199], a[76:79], v[56:59], v[196:199]
v_exp_f32 v87, v87
v_mfma_f32_16x16x32_bf16 v[196:199], a[72:75], v[52:55], v[196:199]
s_waitcnt lgkmcnt(11)
v_cvt_pk_bf16_f32 v61, v86, v87
v_mfma_f32_16x16x32_bf16 v[72:75], a[16:19], a[192:195], v[36:39]
s_waitcnt lgkmcnt(10)
v_exp_f32 v88, v88
v_mfma_f32_16x16x32_bf16 v[72:75], a[20:23], a[196:199], v[72:75]
s_waitcnt lgkmcnt(9)
v_exp_f32 v89, v89
v_mfma_f32_16x16x32_bf16 v[72:75], a[24:27], a[200:203], v[72:75]
s_waitcnt lgkmcnt(8)
v_cvt_pk_bf16_f32 v62, v88, v89
v_mfma_f32_16x16x32_bf16 v[72:75], a[28:31], a[204:207], v[72:75]
v_exp_f32 v90, v90
v_mfma_f32_16x16x32_bf16 v[200:203], a[80:83], v[52:55], v[200:203]
s_add_u32 m0, s90, 67616
v_exp_f32 v91, v91
v_mfma_f32_16x16x32_bf16 v[200:203], a[84:87], v[56:59], v[200:203]
buffer_load_dwordx4 v118, s[8:11], s89 offen offset:1024  lds
v_mfma_f32_16x16x32_bf16 v[204:207], a[92:95], v[56:59], v[204:207]
v_cvt_pk_bf16_f32 v63, v90, v91
v_mfma_f32_16x16x32_bf16 v[204:207], a[88:91], v[52:55], v[204:207]
s_waitcnt lgkmcnt(7)
v_exp_f32 v92, v92
v_mfma_f32_16x16x32_bf16 v[76:79], a[32:35], a[192:195], v[36:39]
s_waitcnt lgkmcnt(6)
v_exp_f32 v93, v93
v_mfma_f32_16x16x32_bf16 v[76:79], a[36:39], a[196:199], v[76:79]
s_waitcnt lgkmcnt(5)
v_cvt_pk_bf16_f32 v64, v92, v93
v_mfma_f32_16x16x32_bf16 v[76:79], a[40:43], a[200:203], v[76:79]
s_waitcnt lgkmcnt(4)
v_exp_f32 v94, v94
v_mfma_f32_16x16x32_bf16 v[76:79], a[44:47], a[204:207], v[76:79]
v_exp_f32 v95, v95
v_mfma_f32_16x16x32_bf16 v[208:211], a[96:99], v[52:55], v[208:211]
s_add_u32 m0, s90, 67648
v_cvt_pk_bf16_f32 v65, v94, v95
v_mfma_f32_16x16x32_bf16 v[208:211], a[100:103], v[56:59], v[208:211]
buffer_load_dwordx4 v118, s[8:11], s89 offen offset:2048  lds
v_mfma_f32_16x16x32_bf16 v[212:215], a[108:111], v[56:59], v[212:215]
v_exp_f32 v96, v96
v_mfma_f32_16x16x32_bf16 v[212:215], a[104:107], v[52:55], v[212:215]
s_waitcnt lgkmcnt(3)
v_exp_f32 v97, v97
v_mfma_f32_16x16x32_bf16 v[80:83], a[48:51], a[192:195], v[36:39]
s_waitcnt lgkmcnt(2)
v_cvt_pk_bf16_f32 v66, v96, v97
v_mfma_f32_16x16x32_bf16 v[80:83], a[52:55], a[196:199], v[80:83]
s_waitcnt lgkmcnt(1)
v_exp_f32 v98, v98
v_mfma_f32_16x16x32_bf16 v[80:83], a[56:59], a[200:203], v[80:83]
s_waitcnt lgkmcnt(0)
v_exp_f32 v99, v99
v_mfma_f32_16x16x32_bf16 v[80:83], a[60:63], a[204:207], v[80:83]
v_cvt_pk_bf16_f32 v67, v98, v99
v_mfma_f32_16x16x32_bf16 v[216:219], a[112:115], v[52:55], v[216:219]
s_add_u32 m0, s90, 67680
v_mfma_f32_16x16x32_bf16 v[216:219], a[116:119], v[56:59], v[216:219]
buffer_load_dwordx4 v118, s[8:11], s89 offen offset:3072  lds
v_mfma_f32_16x16x32_bf16 v[220:223], a[124:127], v[56:59], v[220:223]
v_mfma_f32_16x16x32_bf16 v[220:223], a[120:123], v[52:55], v[220:223]
v_mfma_f32_16x16x32_bf16 v[28:31], v[16:19], v[52:55], v[28:31]
v_mfma_f32_16x16x32_bf16 v[28:31], v[16:19], v[56:59], v[28:31]
v_mfma_f32_16x16x32_bf16 v[84:87], a[0:3], a[208:211], v[40:43]
v_exp_f32 v68, v68
v_mfma_f32_16x16x32_bf16 v[84:87], a[4:7], a[212:215], v[84:87]
v_exp_f32 v69, v69
v_mfma_f32_16x16x32_bf16 v[84:87], a[8:11], a[216:219], v[84:87]
v_cvt_pk_bf16_f32 v52, v68, v69
v_mfma_f32_16x16x32_bf16 v[84:87], a[12:15], a[220:223], v[84:87]
v_exp_f32 v70, v70
v_mfma_f32_16x16x32_bf16 v[224:227], a[64:67], v[60:63], v[224:227]
s_add_u32 m0, s90, 71808
v_exp_f32 v71, v71
v_mfma_f32_16x16x32_bf16 v[224:227], a[68:71], v[64:67], v[224:227]
buffer_load_dwordx4 v119, s[8:11], s89 offen offset:0  lds
v_mfma_f32_16x16x32_bf16 v[228:231], a[76:79], v[64:67], v[228:231]
v_cvt_pk_bf16_f32 v53, v70, v71
v_mfma_f32_16x16x32_bf16 v[228:231], a[72:75], v[60:63], v[228:231]
ds_read_b64_tr_b16 a[64:65], v5 offset:0
v_mfma_f32_16x16x32_bf16 v[88:91], a[16:19], a[208:211], v[40:43]
v_exp_f32 v72, v72
v_mfma_f32_16x16x32_bf16 v[88:91], a[20:23], a[212:215], v[88:91]
ds_read_b64_tr_b16 a[66:67], v5 offset:256
ds_read_b64_tr_b16 a[68:69], v5 offset:512
v_mfma_f32_16x16x32_bf16 v[88:91], a[24:27], a[216:219], v[88:91]
v_exp_f32 v73, v73
v_mfma_f32_16x16x32_bf16 v[88:91], a[28:31], a[220:223], v[88:91]
ds_read_b64_tr_b16 a[70:71], v5 offset:768
v_cvt_pk_bf16_f32 v54, v72, v73
v_mfma_f32_16x16x32_bf16 v[232:235], a[80:83], v[60:63], v[232:235]
v_exp_f32 v74, v74
v_mfma_f32_16x16x32_bf16 v[232:235], a[84:87], v[64:67], v[232:235]
ds_read_b64_tr_b16 a[72:73], v5 offset:32
ds_read_b64_tr_b16 a[74:75], v5 offset:288
v_mfma_f32_16x16x32_bf16 v[236:239], a[92:95], v[64:67], v[236:239]
v_exp_f32 v75, v75
v_mfma_f32_16x16x32_bf16 v[236:239], a[88:91], v[60:63], v[236:239]
ds_read_b64_tr_b16 a[76:77], v5 offset:544
v_cvt_pk_bf16_f32 v55, v74, v75
v_mfma_f32_16x16x32_bf16 v[92:95], a[32:35], a[208:211], v[40:43]
v_exp_f32 v76, v76
v_mfma_f32_16x16x32_bf16 v[92:95], a[36:39], a[212:215], v[92:95]
ds_read_b64_tr_b16 a[78:79], v5 offset:800
ds_read_b64_tr_b16 a[80:81], v5 offset:64
v_mfma_f32_16x16x32_bf16 v[92:95], a[40:43], a[216:219], v[92:95]
v_exp_f32 v77, v77
v_mfma_f32_16x16x32_bf16 v[92:95], a[44:47], a[220:223], v[92:95]
ds_read_b64_tr_b16 a[82:83], v5 offset:320
v_cvt_pk_bf16_f32 v56, v76, v77
v_mfma_f32_16x16x32_bf16 v[240:243], a[96:99], v[60:63], v[240:243]
v_exp_f32 v78, v78
v_mfma_f32_16x16x32_bf16 v[240:243], a[100:103], v[64:67], v[240:243]
ds_read_b64_tr_b16 a[84:85], v5 offset:576
ds_read_b64_tr_b16 a[86:87], v5 offset:832
v_mfma_f32_16x16x32_bf16 v[244:247], a[108:111], v[64:67], v[244:247]
v_exp_f32 v79, v79
v_mfma_f32_16x16x32_bf16 v[244:247], a[104:107], v[60:63], v[244:247]
ds_read_b64_tr_b16 a[88:89], v5 offset:96
v_cvt_pk_bf16_f32 v57, v78, v79
v_mfma_f32_16x16x32_bf16 v[96:99], a[48:51], a[208:211], v[40:43]
v_exp_f32 v80, v80
v_mfma_f32_16x16x32_bf16 v[96:99], a[52:55], a[212:215], v[96:99]
ds_read_b64_tr_b16 a[90:91], v5 offset:352
ds_read_b64_tr_b16 a[92:93], v5 offset:608
v_mfma_f32_16x16x32_bf16 v[96:99], a[56:59], a[216:219], v[96:99]
v_exp_f32 v81, v81
v_mfma_f32_16x16x32_bf16 v[96:99], a[60:63], a[220:223], v[96:99]
ds_read_b64_tr_b16 a[94:95], v5 offset:864
v_cvt_pk_bf16_f32 v58, v80, v81
v_mfma_f32_16x16x32_bf16 v[248:251], a[112:115], v[60:63], v[248:251]
v_exp_f32 v82, v82
v_mfma_f32_16x16x32_bf16 v[248:251], a[116:119], v[64:67], v[248:251]
ds_read_b64_tr_b16 a[96:97], v5 offset:128
ds_read_b64_tr_b16 a[98:99], v5 offset:384
v_mfma_f32_16x16x32_bf16 v[252:255], a[124:127], v[64:67], v[252:255]
v_exp_f32 v83, v83
v_mfma_f32_16x16x32_bf16 v[252:255], a[120:123], v[60:63], v[252:255]
ds_read_b64_tr_b16 a[100:101], v5 offset:640
v_cvt_pk_bf16_f32 v59, v82, v83
v_mfma_f32_16x16x32_bf16 v[32:35], v[16:19], v[60:63], v[32:35]
ds_read_b64_tr_b16 a[102:103], v5 offset:896
ds_read_b64_tr_b16 a[104:105], v5 offset:160
v_mfma_f32_16x16x32_bf16 v[32:35], v[16:19], v[64:67], v[32:35]
ds_read_b64_tr_b16 a[106:107], v5 offset:416
ds_read_b64_tr_b16 a[108:109], v5 offset:672
v_mfma_f32_16x16x32_bf16 v[68:71], a[0:3], a[224:227], v[44:47]
v_exp_f32 v84, v84
v_mfma_f32_16x16x32_bf16 v[68:71], a[4:7], a[228:231], v[68:71]
ds_read_b64_tr_b16 a[110:111], v5 offset:928
ds_read_b64_tr_b16 a[112:113], v5 offset:192
v_mfma_f32_16x16x32_bf16 v[68:71], a[8:11], a[232:235], v[68:71]
v_exp_f32 v85, v85
v_mfma_f32_16x16x32_bf16 v[68:71], a[12:15], a[236:239], v[68:71]
s_waitcnt lgkmcnt(15)
ds_read_b64_tr_b16 a[114:115], v5 offset:448
v_cvt_pk_bf16_f32 v60, v84, v85
v_mfma_f32_16x16x32_bf16 v[128:131], a[64:67], v[52:55], v[128:131]
v_exp_f32 v86, v86
v_mfma_f32_16x16x32_bf16 v[128:131], a[68:71], v[56:59], v[128:131]
ds_read_b64_tr_b16 a[116:117], v5 offset:704
ds_read_b64_tr_b16 a[118:119], v5 offset:960
v_mfma_f32_16x16x32_bf16 v[132:135], a[76:79], v[56:59], v[132:135]
v_exp_f32 v87, v87
v_mfma_f32_16x16x32_bf16 v[132:135], a[72:75], v[52:55], v[132:135]
ds_read_b64_tr_b16 a[120:121], v5 offset:224
v_cvt_pk_bf16_f32 v61, v86, v87
v_mfma_f32_16x16x32_bf16 v[72:75], a[16:19], a[224:227], v[44:47]
v_exp_f32 v88, v88
v_mfma_f32_16x16x32_bf16 v[72:75], a[20:23], a[228:231], v[72:75]
ds_read_b64_tr_b16 a[122:123], v5 offset:480
ds_read_b64_tr_b16 a[124:125], v5 offset:736
v_mfma_f32_16x16x32_bf16 v[72:75], a[24:27], a[232:235], v[72:75]
v_exp_f32 v89, v89
v_mfma_f32_16x16x32_bf16 v[72:75], a[28:31], a[236:239], v[72:75]
s_waitcnt lgkmcnt(15)
ds_read_b64_tr_b16 a[126:127], v5 offset:992
v_cvt_pk_bf16_f32 v62, v88, v89
v_mfma_f32_16x16x32_bf16 v[136:139], a[80:83], v[52:55], v[136:139]
s_add_u32 m0, s90, 71840
v_exp_f32 v90, v90
v_mfma_f32_16x16x32_bf16 v[136:139], a[84:87], v[56:59], v[136:139]
buffer_load_dwordx4 v119, s[8:11], s89 offen offset:1024  lds
v_mfma_f32_16x16x32_bf16 v[140:143], a[92:95], v[56:59], v[140:143]
v_exp_f32 v91, v91
v_mfma_f32_16x16x32_bf16 v[140:143], a[88:91], v[52:55], v[140:143]
v_cvt_pk_bf16_f32 v63, v90, v91
v_mfma_f32_16x16x32_bf16 v[76:79], a[32:35], a[224:227], v[44:47]
v_exp_f32 v92, v92
v_mfma_f32_16x16x32_bf16 v[76:79], a[36:39], a[228:231], v[76:79]
v_exp_f32 v93, v93
v_mfma_f32_16x16x32_bf16 v[76:79], a[40:43], a[232:235], v[76:79]
v_cvt_pk_bf16_f32 v64, v92, v93
v_mfma_f32_16x16x32_bf16 v[76:79], a[44:47], a[236:239], v[76:79]
s_waitcnt lgkmcnt(12)
v_exp_f32 v94, v94
v_mfma_f32_16x16x32_bf16 v[144:147], a[96:99], v[52:55], v[144:147]
s_add_u32 m0, s90, 71872
v_exp_f32 v95, v95
v_mfma_f32_16x16x32_bf16 v[144:147], a[100:103], v[56:59], v[144:147]
s_waitcnt lgkmcnt(8)
buffer_load_dwordx4 v119, s[8:11], s89 offen offset:2048  lds
v_mfma_f32_16x16x32_bf16 v[148:151], a[108:111], v[56:59], v[148:151]
v_cvt_pk_bf16_f32 v65, v94, v95
v_mfma_f32_16x16x32_bf16 v[148:151], a[104:107], v[52:55], v[148:151]
v_exp_f32 v96, v96
v_mfma_f32_16x16x32_bf16 v[80:83], a[48:51], a[224:227], v[44:47]
v_exp_f32 v97, v97
v_mfma_f32_16x16x32_bf16 v[80:83], a[52:55], a[228:231], v[80:83]
v_cvt_pk_bf16_f32 v66, v96, v97
v_mfma_f32_16x16x32_bf16 v[80:83], a[56:59], a[232:235], v[80:83]
v_exp_f32 v98, v98
v_mfma_f32_16x16x32_bf16 v[80:83], a[60:63], a[236:239], v[80:83]
s_waitcnt lgkmcnt(4)
v_exp_f32 v99, v99
v_mfma_f32_16x16x32_bf16 v[152:155], a[112:115], v[52:55], v[152:155]
s_add_u32 m0, s90, 71904
v_cvt_pk_bf16_f32 v67, v98, v99
v_mfma_f32_16x16x32_bf16 v[152:155], a[116:119], v[56:59], v[152:155]
s_waitcnt lgkmcnt(0)
buffer_load_dwordx4 v119, s[8:11], s89 offen offset:3072  lds
v_mfma_f32_16x16x32_bf16 v[156:159], a[124:127], v[56:59], v[156:159]
s_mov_b32 s57, s47
v_mfma_f32_16x16x32_bf16 v[156:159], a[120:123], v[52:55], v[156:159]
s_mov_b32 s47, s48
v_mfma_f32_16x16x32_bf16 v[20:23], v[16:19], v[52:55], v[20:23]
s_add_u32 s50, s50, 16384
v_mfma_f32_16x16x32_bf16 v[20:23], v[16:19], v[56:59], v[20:23]
s_add_u32 s89, s89, 0x40000
s_cmp_eq_u32 s89, 0x200000
s_cselect_b32 s89, 0x20000, s89
v_mfma_f32_16x16x32_bf16 v[84:87], a[0:3], a[240:243], v[48:51]
v_exp_f32 v68, v68
v_mfma_f32_16x16x32_bf16 v[84:87], a[4:7], a[244:247], v[84:87]
s_barrier
v_exp_f32 v69, v69
v_mfma_f32_16x16x32_bf16 v[84:87], a[8:11], a[248:251], v[84:87]
v_cvt_pk_bf16_f32 v52, v68, v69
v_mfma_f32_16x16x32_bf16 v[84:87], a[12:15], a[252:255], v[84:87]
s_add_u32 m0, s90, 33792
v_exp_f32 v70, v70
v_mfma_f32_16x16x32_bf16 v[160:163], a[64:67], v[60:63], v[160:163]
buffer_load_dwordx4 v118, s[8:11], s89 offen offset:0  lds
v_rcp_f32 v9, v20
v_mfma_f32_16x16x32_bf16 v[160:163], a[68:71], v[64:67], v[160:163]
v_cmp_nle_f32 vcc, v20, v10
v_exp_f32 v71, v71
v_mfma_f32_16x16x32_bf16 v[164:167], a[76:79], v[64:67], v[164:167]
s_cmp_lg_u64 vcc, 0
s_cselect_b32 s52, 16, 0
s_cselect_b64 s[58:59], 0, -1
s_or_b32 s56, s56, s52
v_mul_f32 v128, v128, v9
v_cvt_pk_bf16_f32 v53, v70, v71
v_mfma_f32_16x16x32_bf16 v[164:167], a[72:75], v[60:63], v[164:167]
s_add_u32 m0, s90, 33824
v_mul_f32 v129, v129, v9
v_exp_f32 v72, v72
v_mfma_f32_16x16x32_bf16 v[88:91], a[16:19], a[240:243], v[48:51]
buffer_load_dwordx4 v118, s[8:11], s89 offen offset:1024  lds
v_mul_f32 v130, v130, v9
v_mul_f32 v131, v131, v9
v_mfma_f32_16x16x32_bf16 v[88:91], a[20:23], a[244:247], v[88:91]
v_mul_f32 v132, v132, v9
v_exp_f32 v73, v73
v_mfma_f32_16x16x32_bf16 v[88:91], a[24:27], a[248:251], v[88:91]
v_mul_f32 v133, v133, v9
v_mul_f32 v134, v134, v9
v_mul_f32 v135, v135, v9
v_cvt_pk_bf16_f32 v54, v72, v73
v_mfma_f32_16x16x32_bf16 v[88:91], a[28:31], a[252:255], v[88:91]
s_add_u32 m0, s90, 33856
v_cvt_pk_bf16_f32 v128, v128, v129
v_exp_f32 v74, v74
v_mfma_f32_16x16x32_bf16 v[168:171], a[80:83], v[60:63], v[168:171]
buffer_load_dwordx4 v118, s[8:11], s89 offen offset:2048  lds
v_cvt_pk_bf16_f32 v129, v130, v131
v_mfma_f32_16x16x32_bf16 v[168:171], a[84:87], v[64:67], v[168:171]
v_mul_f32 v136, v136, v9
v_mul_f32 v137, v137, v9
v_exp_f32 v75, v75
v_mfma_f32_16x16x32_bf16 v[172:175], a[92:95], v[64:67], v[172:175]
v_mul_f32 v138, v138, v9
v_mul_f32 v139, v139, v9
v_cvt_pk_bf16_f32 v55, v74, v75
v_mfma_f32_16x16x32_bf16 v[172:175], a[88:91], v[60:63], v[172:175]
s_add_u32 m0, s90, 33888
v_cvt_pk_bf16_f32 v130, v132, v133
v_exp_f32 v76, v76
v_mfma_f32_16x16x32_bf16 v[92:95], a[32:35], a[240:243], v[48:51]
buffer_load_dwordx4 v118, s[8:11], s89 offen offset:3072  lds
v_cvt_pk_bf16_f32 v131, v134, v135
v_mul_f32 v140, v140, v9
v_mfma_f32_16x16x32_bf16 v[92:95], a[36:39], a[244:247], v[92:95]
v_mul_f32 v141, v141, v9
v_exp_f32 v77, v77
v_mfma_f32_16x16x32_bf16 v[92:95], a[40:43], a[248:251], v[92:95]
v_mul_f32 v142, v142, v9
v_mul_f32 v143, v143, v9
v_cvt_pk_bf16_f32 v132, v136, v137
v_cvt_pk_bf16_f32 v56, v76, v77
v_mfma_f32_16x16x32_bf16 v[92:95], a[44:47], a[252:255], v[92:95]
s_add_u32 m0, s90, 38016
v_cvt_pk_bf16_f32 v133, v138, v139
v_exp_f32 v78, v78
v_mfma_f32_16x16x32_bf16 v[176:179], a[96:99], v[60:63], v[176:179]
buffer_load_dwordx4 v119, s[8:11], s89 offen offset:0  lds
v_mul_f32 v144, v144, v9
v_mfma_f32_16x16x32_bf16 v[176:179], a[100:103], v[64:67], v[176:179]
v_mul_f32 v145, v145, v9
v_mul_f32 v146, v146, v9
v_exp_f32 v79, v79
v_mfma_f32_16x16x32_bf16 v[180:183], a[108:111], v[64:67], v[180:183]
v_mul_f32 v147, v147, v9
v_cvt_pk_bf16_f32 v134, v140, v141
v_cvt_pk_bf16_f32 v57, v78, v79
v_mfma_f32_16x16x32_bf16 v[180:183], a[104:107], v[60:63], v[180:183]
s_add_u32 m0, s90, 38048
v_cvt_pk_bf16_f32 v135, v142, v143
v_exp_f32 v80, v80
v_mfma_f32_16x16x32_bf16 v[96:99], a[48:51], a[240:243], v[48:51]
buffer_load_dwordx4 v119, s[8:11], s89 offen offset:1024  lds
v_mul_f32 v148, v148, v9
v_mul_f32 v149, v149, v9
v_mfma_f32_16x16x32_bf16 v[96:99], a[52:55], a[244:247], v[96:99]
v_mul_f32 v150, v150, v9
v_exp_f32 v81, v81
v_mfma_f32_16x16x32_bf16 v[96:99], a[56:59], a[248:251], v[96:99]
v_mul_f32 v151, v151, v9
v_cvt_pk_bf16_f32 v136, v144, v145
v_cvt_pk_bf16_f32 v58, v80, v81
v_mfma_f32_16x16x32_bf16 v[96:99], a[60:63], a[252:255], v[96:99]
s_add_u32 m0, s90, 38080
v_cvt_pk_bf16_f32 v137, v146, v147
v_mul_f32 v152, v152, v9
v_exp_f32 v82, v82
v_mfma_f32_16x16x32_bf16 v[184:187], a[112:115], v[60:63], v[184:187]
buffer_load_dwordx4 v119, s[8:11], s89 offen offset:2048  lds
v_mul_f32 v153, v153, v9
v_mfma_f32_16x16x32_bf16 v[184:187], a[116:119], v[64:67], v[184:187]
v_mul_f32 v154, v154, v9
v_mul_f32 v155, v155, v9
v_exp_f32 v83, v83
v_mfma_f32_16x16x32_bf16 v[188:191], a[124:127], v[64:67], v[188:191]
v_cvt_pk_bf16_f32 v138, v148, v149
v_cvt_pk_bf16_f32 v139, v150, v151
v_cvt_pk_bf16_f32 v59, v82, v83
v_mfma_f32_16x16x32_bf16 v[188:191], a[120:123], v[60:63], v[188:191]
s_add_u32 m0, s90, 38112
v_mul_f32 v156, v156, v9
v_mul_f32 v157, v157, v9
v_mul_f32 v158, v158, v9
v_mfma_f32_16x16x32_bf16 v[24:27], v[16:19], v[60:63], v[24:27]
buffer_load_dwordx4 v119, s[8:11], s89 offen offset:3072  lds
v_mul_f32 v159, v159, v9
v_cvt_pk_bf16_f32 v140, v152, v153
v_mfma_f32_16x16x32_bf16 v[24:27], v[16:19], v[64:67], v[24:27]
v_cvt_pk_bf16_f32 v141, v154, v155
v_cvt_pk_bf16_f32 v142, v156, v157
v_cvt_pk_bf16_f32 v143, v158, v159
v_exp_f32 v84, v84
v_exp_f32 v85, v85
v_mfma_f32_16x16x32_bf16 v[192:195], a[64:67], v[52:55], v[192:195]
s_add_u32 s89, s89, 0x40000
buffer_load_dwordx4 a[0:3], v116, s[4:7], s88 offen offset:0 sc1
v_cvt_pk_bf16_f32 v60, v84, v85
v_mfma_f32_16x16x32_bf16 v[192:195], a[68:71], v[56:59], v[192:195]
s_cmp_eq_u32 s89, 0x200000
s_cselect_b32 s89, 0x20000, s89
v_exp_f32 v86, v86
v_exp_f32 v87, v87
v_mfma_f32_16x16x32_bf16 v[196:199], a[76:79], v[56:59], v[196:199]
buffer_load_dwordx4 a[4:7], v116, s[4:7], s88 offen offset:1024 sc1
v_cvt_pk_bf16_f32 v61, v86, v87
v_mfma_f32_16x16x32_bf16 v[196:199], a[72:75], v[52:55], v[196:199]
v_rcp_f32 v9, v24
v_exp_f32 v88, v88
v_exp_f32 v89, v89
v_mfma_f32_16x16x32_bf16 v[200:203], a[80:83], v[52:55], v[200:203]
buffer_load_dwordx4 a[8:11], v116, s[4:7], s88 offen offset:2048 sc1
v_cmp_nle_f32 vcc, v24, v10
s_nop 0
s_cmp_lg_u64 vcc, 0
s_cselect_b32 s52, 32, 0
s_cselect_b64 s[58:59], 0, -1
s_or_b32 s56, s56, s52
v_mul_f32 v160, v160, v9
v_mul_f32 v161, v161, v9
v_cvt_pk_bf16_f32 v62, v88, v89
v_mfma_f32_16x16x32_bf16 v[200:203], a[84:87], v[56:59], v[200:203]
v_mul_f32 v162, v162, v9
v_mul_f32 v163, v163, v9
v_exp_f32 v90, v90
v_exp_f32 v91, v91
v_mfma_f32_16x16x32_bf16 v[204:207], a[92:95], v[56:59], v[204:207]
buffer_load_dwordx4 a[12:15], v116, s[4:7], s88 offen offset:3072 sc1
v_mul_f32 v164, v164, v9
v_mul_f32 v165, v165, v9
v_mul_f32 v166, v166, v9
v_cvt_pk_bf16_f32 v63, v90, v91
v_mfma_f32_16x16x32_bf16 v[204:207], a[88:91], v[52:55], v[204:207]
v_mul_f32 v167, v167, v9
v_cvt_pk_bf16_f32 v160, v160, v161
v_exp_f32 v92, v92
v_exp_f32 v93, v93
v_mfma_f32_16x16x32_bf16 v[208:211], a[96:99], v[52:55], v[208:211]
buffer_load_dwordx4 a[16:19], v117, s[4:7], s88 offen offset:0 sc1
v_cvt_pk_bf16_f32 v161, v162, v163
v_mul_f32 v168, v168, v9
v_mul_f32 v169, v169, v9
v_mul_f32 v170, v170, v9
v_cvt_pk_bf16_f32 v64, v92, v93
v_mfma_f32_16x16x32_bf16 v[208:211], a[100:103], v[56:59], v[208:211]
v_mul_f32 v171, v171, v9
v_cvt_pk_bf16_f32 v162, v164, v165
v_exp_f32 v94, v94
v_exp_f32 v95, v95
v_mfma_f32_16x16x32_bf16 v[212:215], a[108:111], v[56:59], v[212:215]
buffer_load_dwordx4 a[20:23], v117, s[4:7], s88 offen offset:1024 sc1
v_cvt_pk_bf16_f32 v163, v166, v167
v_mul_f32 v172, v172, v9
v_mul_f32 v173, v173, v9
v_cvt_pk_bf16_f32 v65, v94, v95
v_mfma_f32_16x16x32_bf16 v[212:215], a[104:107], v[52:55], v[212:215]
v_mul_f32 v174, v174, v9
v_mul_f32 v175, v175, v9
v_exp_f32 v96, v96
v_exp_f32 v97, v97
v_mfma_f32_16x16x32_bf16 v[216:219], a[112:115], v[52:55], v[216:219]
buffer_load_dwordx4 a[24:27], v117, s[4:7], s88 offen offset:2048 sc1
v_cvt_pk_bf16_f32 v164, v168, v169
v_cvt_pk_bf16_f32 v165, v170, v171
v_mul_f32 v176, v176, v9
v_mul_f32 v177, v177, v9
v_cvt_pk_bf16_f32 v66, v96, v97
v_mfma_f32_16x16x32_bf16 v[216:219], a[116:119], v[56:59], v[216:219]
v_mul_f32 v178, v178, v9
v_mul_f32 v179, v179, v9
v_exp_f32 v98, v98
v_exp_f32 v99, v99
v_mfma_f32_16x16x32_bf16 v[220:223], a[124:127], v[56:59], v[220:223]
buffer_load_dwordx4 a[28:31], v117, s[4:7], s88 offen offset:3072 sc1
v_cvt_pk_bf16_f32 v166, v172, v173
v_cvt_pk_bf16_f32 v167, v174, v175
v_mul_f32 v180, v180, v9
v_cvt_pk_bf16_f32 v67, v98, v99
v_mfma_f32_16x16x32_bf16 v[220:223], a[120:123], v[52:55], v[220:223]
s_add_u32 s88, s88, 0x20000
v_mul_f32 v181, v181, v9
v_mul_f32 v182, v182, v9
v_mul_f32 v183, v183, v9
v_cvt_pk_bf16_f32 v168, v176, v177
v_cvt_pk_bf16_f32 v169, v178, v179
v_mul_f32 v184, v184, v9
v_mfma_f32_16x16x32_bf16 v[28:31], v[16:19], v[52:55], v[28:31]
s_cmp_eq_u32 s88, 0x100000
s_cselect_b32 s88, 0x10000, s88
v_mul_f32 v185, v185, v9
v_mul_f32 v186, v186, v9
v_mul_f32 v187, v187, v9
v_cvt_pk_bf16_f32 v170, v180, v181
v_cvt_pk_bf16_f32 v171, v182, v183
v_mul_f32 v188, v188, v9
v_mul_f32 v189, v189, v9
v_mfma_f32_16x16x32_bf16 v[28:31], v[16:19], v[56:59], v[28:31]
v_mul_f32 v190, v190, v9
v_mul_f32 v191, v191, v9
v_cvt_pk_bf16_f32 v172, v184, v185
v_cvt_pk_bf16_f32 v173, v186, v187
v_cvt_pk_bf16_f32 v174, v188, v189
v_cvt_pk_bf16_f32 v175, v190, v191
v_mfma_f32_16x16x32_bf16 v[224:227], a[64:67], v[60:63], v[224:227]
buffer_load_dwordx4 a[32:35], v116, s[4:7], s88 offen offset:0 sc1
v_mfma_f32_16x16x32_bf16 v[224:227], a[68:71], v[64:67], v[224:227]
v_mfma_f32_16x16x32_bf16 v[228:231], a[76:79], v[64:67], v[228:231]
buffer_load_dwordx4 a[36:39], v116, s[4:7], s88 offen offset:1024 sc1
v_mfma_f32_16x16x32_bf16 v[228:231], a[72:75], v[60:63], v[228:231]
v_rcp_f32 v9, v28
v_cmp_nle_f32 vcc, v28, v10
s_nop 0
s_cmp_lg_u64 vcc, 0
s_cselect_b32 s52, 64, 0
s_cselect_b64 s[58:59], 0, -1
s_or_b32 s56, s56, s52
v_mfma_f32_16x16x32_bf16 v[232:235], a[80:83], v[60:63], v[232:235]
buffer_load_dwordx4 a[40:43], v116, s[4:7], s88 offen offset:2048 sc1
v_mul_f32 v192, v192, v9
v_mul_f32 v193, v193, v9
v_mul_f32 v194, v194, v9
v_mfma_f32_16x16x32_bf16 v[232:235], a[84:87], v[64:67], v[232:235]
v_mul_f32 v195, v195, v9
v_mul_f32 v196, v196, v9
v_mul_f32 v197, v197, v9
v_mul_f32 v198, v198, v9
v_mfma_f32_16x16x32_bf16 v[236:239], a[92:95], v[64:67], v[236:239]
buffer_load_dwordx4 a[44:47], v116, s[4:7], s88 offen offset:3072 sc1
v_mul_f32 v199, v199, v9
v_cvt_pk_bf16_f32 v144, v192, v193
v_mfma_f32_16x16x32_bf16 v[236:239], a[88:91], v[60:63], v[236:239]
v_cvt_pk_bf16_f32 v145, v194, v195
v_mul_f32 v200, v200, v9
v_mul_f32 v201, v201, v9
v_mul_f32 v202, v202, v9
v_mfma_f32_16x16x32_bf16 v[240:243], a[96:99], v[60:63], v[240:243]
buffer_load_dwordx4 a[48:51], v117, s[4:7], s88 offen offset:0 sc1
v_mul_f32 v203, v203, v9
v_cvt_pk_bf16_f32 v146, v196, v197
v_cvt_pk_bf16_f32 v147, v198, v199
v_mfma_f32_16x16x32_bf16 v[240:243], a[100:103], v[64:67], v[240:243]
v_mul_f32 v204, v204, v9
v_mul_f32 v205, v205, v9
v_mul_f32 v206, v206, v9
v_mul_f32 v207, v207, v9
v_mfma_f32_16x16x32_bf16 v[244:247], a[108:111], v[64:67], v[244:247]
buffer_load_dwordx4 a[52:55], v117, s[4:7], s88 offen offset:1024 sc1
v_cvt_pk_bf16_f32 v148, v200, v201
v_cvt_pk_bf16_f32 v149, v202, v203
v_mfma_f32_16x16x32_bf16 v[244:247], a[104:107], v[60:63], v[244:247]
v_mul_f32 v208, v208, v9
v_mul_f32 v209, v209, v9
v_mul_f32 v210, v210, v9
v_mul_f32 v211, v211, v9
v_mfma_f32_16x16x32_bf16 v[248:251], a[112:115], v[60:63], v[248:251]
buffer_load_dwordx4 a[56:59], v117, s[4:7], s88 offen offset:2048 sc1
v_cvt_pk_bf16_f32 v150, v204, v205
v_cvt_pk_bf16_f32 v151, v206, v207
v_mul_f32 v212, v212, v9
v_mfma_f32_16x16x32_bf16 v[248:251], a[116:119], v[64:67], v[248:251]
v_mul_f32 v213, v213, v9
v_mul_f32 v214, v214, v9
v_mul_f32 v215, v215, v9
v_cvt_pk_bf16_f32 v152, v208, v209
v_mfma_f32_16x16x32_bf16 v[252:255], a[124:127], v[64:67], v[252:255]
buffer_load_dwordx4 a[60:63], v117, s[4:7], s88 offen offset:3072 sc1
v_cvt_pk_bf16_f32 v153, v210, v211
v_mul_f32 v216, v216, v9
v_mfma_f32_16x16x32_bf16 v[252:255], a[120:123], v[60:63], v[252:255]
s_add_u32 s88, s88, 0x20000
v_mul_f32 v217, v217, v9
v_mul_f32 v218, v218, v9
v_mul_f32 v219, v219, v9
v_cvt_pk_bf16_f32 v154, v212, v213
v_mfma_f32_16x16x32_bf16 v[32:35], v[16:19], v[60:63], v[32:35]
s_cmp_eq_u32 s88, 0x100000
s_cselect_b32 s88, 0x10000, s88
v_cvt_pk_bf16_f32 v155, v214, v215
v_mul_f32 v220, v220, v9
v_mul_f32 v221, v221, v9
v_mul_f32 v222, v222, v9
v_mul_f32 v223, v223, v9
v_mfma_f32_16x16x32_bf16 v[32:35], v[16:19], v[64:67], v[32:35]
v_cvt_pk_bf16_f32 v156, v216, v217
v_cvt_pk_bf16_f32 v157, v218, v219
v_cvt_pk_bf16_f32 v158, v220, v221
v_cvt_pk_bf16_f32 v159, v222, v223
v_subrev_u32 v120, 67584, v3
s_waitcnt vmcnt(32)
s_barrier
s_nop 0
v_rcp_f32 v9, v32
v_cmp_nle_f32 vcc, v32, v10
buffer_load_dwordx4 a[64:67], v116, s[4:7], s88 offen offset:0 sc1
s_cmp_lg_u64 vcc, 0
s_cselect_b32 s52, 128, 0
s_cselect_b64 s[58:59], 0, -1
s_or_b32 s56, s56, s52
v_mul_f32 v224, v224, v9
s_add_u32 m0, s90, 101376
s_nop 0
buffer_load_dwordx4 v118, s[8:11], s89 offen offset:0  lds
v_mul_f32 v225, v225, v9
v_mul_f32 v226, v226, v9
buffer_load_dwordx4 a[68:71], v116, s[4:7], s88 offen offset:1024 sc1
v_mul_f32 v227, v227, v9
v_mul_f32 v228, v228, v9
s_add_u32 m0, s90, 101408
s_nop 0
buffer_load_dwordx4 v118, s[8:11], s89 offen offset:1024  lds
v_mul_f32 v229, v229, v9
v_mul_f32 v230, v230, v9
buffer_load_dwordx4 a[72:75], v116, s[4:7], s88 offen offset:2048 sc1
ds_read_b64_tr_b16 v[36:37], v120 offset:0
v_mul_f32 v231, v231, v9
v_cvt_pk_bf16_f32 v176, v224, v225
s_add_u32 m0, s90, 101440
s_nop 0
buffer_load_dwordx4 v118, s[8:11], s89 offen offset:2048  lds
ds_read_b64_tr_b16 v[38:39], v120 offset:256
v_cvt_pk_bf16_f32 v177, v226, v227
v_mul_f32 v232, v232, v9
buffer_load_dwordx4 a[76:79], v116, s[4:7], s88 offen offset:3072 sc1
ds_read_b64_tr_b16 v[40:41], v120 offset:512
v_mul_f32 v233, v233, v9
v_mul_f32 v234, v234, v9
s_add_u32 m0, s90, 101472
s_nop 0
buffer_load_dwordx4 v118, s[8:11], s89 offen offset:3072  lds
ds_read_b64_tr_b16 v[42:43], v120 offset:768
v_mul_f32 v235, v235, v9
v_cvt_pk_bf16_f32 v178, v228, v229
buffer_load_dwordx4 a[80:83], v117, s[4:7], s88 offen offset:0 sc1
ds_read_b64_tr_b16 v[44:45], v120 offset:16896
v_cvt_pk_bf16_f32 v179, v230, v231
v_mul_f32 v236, v236, v9
s_add_u32 m0, s90, 105600
s_nop 0
buffer_load_dwordx4 v119, s[8:11], s89 offen offset:0  lds
ds_read_b64_tr_b16 v[46:47], v120 offset:17152
v_mul_f32 v237, v237, v9
v_mul_f32 v238, v238, v9
buffer_load_dwordx4 a[84:87], v117, s[4:7], s88 offen offset:1024 sc1
ds_read_b64_tr_b16 v[48:49], v120 offset:17408
v_mul_f32 v239, v239, v9
v_cvt_pk_bf16_f32 v180, v232, v233
s_add_u32 m0, s90, 105632
s_nop 0
buffer_load_dwordx4 v119, s[8:11], s89 offen offset:1024  lds
ds_read_b64_tr_b16 v[50:51], v120 offset:17664
v_cvt_pk_bf16_f32 v181, v234, v235
v_mul_f32 v240, v240, v9
buffer_load_dwordx4 a[88:91], v117, s[4:7], s88 offen offset:2048 sc1
ds_read_b64_tr_b16 v[52:53], v120 offset:32
v_mul_f32 v241, v241, v9
v_mul_f32 v242, v242, v9
s_add_u32 m0, s90, 105664
s_nop 0
buffer_load_dwordx4 v119, s[8:11], s89 offen offset:2048  lds
ds_read_b64_tr_b16 v[54:55], v120 offset:288
v_mul_f32 v243, v243, v9
v_cvt_pk_bf16_f32 v182, v236, v237
buffer_load_dwordx4 a[92:95], v117, s[4:7], s88 offen offset:3072 sc1
ds_read_b64_tr_b16 v[56:57], v120 offset:544
v_cvt_pk_bf16_f32 v183, v238, v239
v_mul_f32 v244, v244, v9
s_add_u32 m0, s90, 105696
s_nop 0
buffer_load_dwordx4 v119, s[8:11], s89 offen offset:3072  lds
ds_read_b64_tr_b16 v[58:59], v120 offset:800
v_mul_f32 v245, v245, v9
v_mul_f32 v246, v246, v9
s_add_u32 s88, s88, 0x20000
s_cmp_eq_u32 s88, 0x100000
s_cselect_b32 s88, 0x10000, s88
ds_read_b64_tr_b16 v[60:61], v120 offset:16928
v_mul_f32 v247, v247, v9
v_cvt_pk_bf16_f32 v184, v240, v241
buffer_load_dwordx4 a[96:99], v116, s[4:7], s88 offen offset:0 sc1
ds_read_b64_tr_b16 v[62:63], v120 offset:17184
v_cvt_pk_bf16_f32 v185, v242, v243
v_mul_f32 v248, v248, v9
buffer_load_dwordx4 a[100:103], v116, s[4:7], s88 offen offset:1024 sc1
ds_read_b64_tr_b16 v[64:65], v120 offset:17440
v_mul_f32 v249, v249, v9
v_mul_f32 v250, v250, v9
buffer_load_dwordx4 a[104:107], v116, s[4:7], s88 offen offset:2048 sc1
ds_read_b64_tr_b16 v[66:67], v120 offset:17696
v_mul_f32 v251, v251, v9
v_cvt_pk_bf16_f32 v186, v244, v245
buffer_load_dwordx4 a[108:111], v116, s[4:7], s88 offen offset:3072 sc1
ds_read_b64_tr_b16 v[68:69], v120 offset:64
v_cvt_pk_bf16_f32 v187, v246, v247
v_mul_f32 v252, v252, v9
buffer_load_dwordx4 a[112:115], v117, s[4:7], s88 offen offset:0 sc1
ds_read_b64_tr_b16 v[70:71], v120 offset:320
v_mul_f32 v253, v253, v9
v_mul_f32 v254, v254, v9
buffer_load_dwordx4 a[116:119], v117, s[4:7], s88 offen offset:1024 sc1
ds_read_b64_tr_b16 v[72:73], v120 offset:576
v_mul_f32 v255, v255, v9
v_cvt_pk_bf16_f32 v188, v248, v249
buffer_load_dwordx4 a[120:123], v117, s[4:7], s88 offen offset:2048 sc1
ds_read_b64_tr_b16 v[74:75], v120 offset:832
v_cvt_pk_bf16_f32 v189, v250, v251
v_cvt_pk_bf16_f32 v190, v252, v253
buffer_load_dwordx4 a[124:127], v117, s[4:7], s88 offen offset:3072 sc1
ds_read_b64_tr_b16 v[76:77], v120 offset:16960
v_cvt_pk_bf16_f32 v191, v254, v255
ds_read_b64_tr_b16 v[78:79], v120 offset:17216
ds_read_b64_tr_b16 v[80:81], v120 offset:17472
ds_read_b64_tr_b16 v[82:83], v120 offset:17728
s_add_u32 s88, s88, 0x20000
s_cmp_eq_u32 s88, 0x100000
s_cselect_b32 s88, 0x10000, s88
s_and_b32 s61, s56, 240
s_cselect_b32 s61, 2, 0
v_mov_b32 v8, s61
v_mov_b32 v7, 163836
ds_or_b32 v7, v8
O_STEP0:
s_waitcnt vmcnt(32)
s_waitcnt lgkmcnt(15)
v_mfma_f32_16x16x32_bf16 v[192:195], v[36:39], a[0:3], 0
ds_read_b64_tr_b16 v[84:85], v120 offset:96
v_mfma_f32_16x16x32_bf16 v[192:195], v[40:43], a[4:7], v[192:195]
ds_read_b64_tr_b16 v[86:87], v120 offset:352
v_mfma_f32_16x16x32_bf16 v[192:195], v[44:47], a[8:11], v[192:195]
s_mov_b32 s52, 65536
ds_read_b64_tr_b16 v[88:89], v120 offset:608
ds_read_b64_tr_b16 v[90:91], v120 offset:864
v_mfma_f32_16x16x32_bf16 v[192:195], v[48:51], a[12:15], v[192:195]
buffer_store_dwordx4 v[128:131], v6, s[20:23], s52 offen offset:0 sc1
v_mfma_f32_16x16x32_bf16 v[196:199], v[48:51], a[28:31], 0
ds_read_b64_tr_b16 v[92:93], v120 offset:16992
v_mfma_f32_16x16x32_bf16 v[196:199], v[44:47], a[24:27], v[196:199]
ds_read_b64_tr_b16 v[94:95], v120 offset:17248
v_mfma_f32_16x16x32_bf16 v[196:199], v[40:43], a[20:23], v[196:199]
ds_read_b64_tr_b16 v[96:97], v120 offset:17504
v_mfma_f32_16x16x32_bf16 v[196:199], v[36:39], a[16:19], v[196:199]
ds_read_b64_tr_b16 v[98:99], v120 offset:17760
v_mfma_f32_16x16x32_bf16 v[204:207], v[52:55], a[16:19], 0
s_waitcnt lgkmcnt(15)
ds_read_b64_tr_b16 v[36:37], v120 offset:128
v_mfma_f32_16x16x32_bf16 v[204:207], v[56:59], a[20:23], v[204:207]
ds_read_b64_tr_b16 v[38:39], v120 offset:384
v_mfma_f32_16x16x32_bf16 v[204:207], v[60:63], a[24:27], v[204:207]
ds_read_b64_tr_b16 v[40:41], v120 offset:640
ds_read_b64_tr_b16 v[42:43], v120 offset:896
v_mfma_f32_16x16x32_bf16 v[204:207], v[64:67], a[28:31], v[204:207]
buffer_store_dwordx4 v[132:135], v6, s[20:23], s52 offen offset:1024 sc1
v_mfma_f32_16x16x32_bf16 v[200:203], v[64:67], a[12:15], 0
ds_read_b64_tr_b16 v[44:45], v120 offset:17024
v_mfma_f32_16x16x32_bf16 v[200:203], v[60:63], a[8:11], v[200:203]
ds_read_b64_tr_b16 v[46:47], v120 offset:17280
v_mfma_f32_16x16x32_bf16 v[200:203], v[56:59], a[4:7], v[200:203]
ds_read_b64_tr_b16 v[48:49], v120 offset:17536
v_mfma_f32_16x16x32_bf16 v[200:203], v[52:55], a[0:3], v[200:203]
ds_read_b64_tr_b16 v[50:51], v120 offset:17792
v_mfma_f32_16x16x32_bf16 v[208:211], v[68:71], a[0:3], 0
s_waitcnt lgkmcnt(15)
ds_read_b64_tr_b16 v[52:53], v120 offset:160
v_mfma_f32_16x16x32_bf16 v[208:211], v[72:75], a[4:7], v[208:211]
ds_read_b64_tr_b16 v[54:55], v120 offset:416
v_mfma_f32_16x16x32_bf16 v[208:211], v[76:79], a[8:11], v[208:211]
ds_read_b64_tr_b16 v[56:57], v120 offset:672
ds_read_b64_tr_b16 v[58:59], v120 offset:928
v_mfma_f32_16x16x32_bf16 v[208:211], v[80:83], a[12:15], v[208:211]
buffer_store_dwordx4 v[136:139], v6, s[20:23], s52 offen offset:2048 sc1
v_mfma_f32_16x16x32_bf16 v[212:215], v[80:83], a[28:31], 0
ds_read_b64_tr_b16 v[60:61], v120 offset:17056
v_mfma_f32_16x16x32_bf16 v[212:215], v[76:79], a[24:27], v[212:215]
ds_read_b64_tr_b16 v[62:63], v120 offset:17312
v_mfma_f32_16x16x32_bf16 v[212:215], v[72:75], a[20:23], v[212:215]
ds_read_b64_tr_b16 v[64:65], v120 offset:17568
v_mfma_f32_16x16x32_bf16 v[212:215], v[68:71], a[16:19], v[212:215]
s_waitcnt lgkmcnt(15)
ds_read_b64_tr_b16 v[66:67], v120 offset:17824
v_mfma_f32_16x16x32_bf16 v[220:223], v[84:87], a[16:19], 0
ds_read_b64_tr_b16 v[68:69], v120 offset:192
v_mfma_f32_16x16x32_bf16 v[220:223], v[88:91], a[20:23], v[220:223]
ds_read_b64_tr_b16 v[70:71], v120 offset:448
v_mfma_f32_16x16x32_bf16 v[220:223], v[92:95], a[24:27], v[220:223]
ds_read_b64_tr_b16 v[72:73], v120 offset:704
ds_read_b64_tr_b16 v[74:75], v120 offset:960
v_mfma_f32_16x16x32_bf16 v[220:223], v[96:99], a[28:31], v[220:223]
buffer_store_dwordx4 v[140:143], v6, s[20:23], s52 offen offset:3072 sc1
v_mfma_f32_16x16x32_bf16 v[216:219], v[96:99], a[12:15], 0
ds_read_b64_tr_b16 v[76:77], v120 offset:17088
v_mfma_f32_16x16x32_bf16 v[216:219], v[92:95], a[8:11], v[216:219]
ds_read_b64_tr_b16 v[78:79], v120 offset:17344
v_mfma_f32_16x16x32_bf16 v[216:219], v[88:91], a[4:7], v[216:219]
ds_read_b64_tr_b16 v[80:81], v120 offset:17600
v_mfma_f32_16x16x32_bf16 v[216:219], v[84:87], a[0:3], v[216:219]
s_waitcnt lgkmcnt(15)
ds_read_b64_tr_b16 v[82:83], v120 offset:17856
v_mfma_f32_16x16x32_bf16 v[224:227], v[36:39], a[0:3], 0
ds_read_b64_tr_b16 v[84:85], v120 offset:224
v_mfma_f32_16x16x32_bf16 v[224:227], v[40:43], a[4:7], v[224:227]
ds_read_b64_tr_b16 v[86:87], v120 offset:480
v_mfma_f32_16x16x32_bf16 v[224:227], v[44:47], a[8:11], v[224:227]
s_mov_b32 s52, 69632
ds_read_b64_tr_b16 v[88:89], v120 offset:736
ds_read_b64_tr_b16 v[90:91], v120 offset:992
v_mfma_f32_16x16x32_bf16 v[224:227], v[48:51], a[12:15], v[224:227]
buffer_store_dwordx4 v[160:163], v6, s[20:23], s52 offen offset:0 sc1
v_mfma_f32_16x16x32_bf16 v[228:231], v[48:51], a[28:31], 0
ds_read_b64_tr_b16 v[92:93], v120 offset:17120
v_mfma_f32_16x16x32_bf16 v[228:231], v[44:47], a[24:27], v[228:231]
s_waitcnt lgkmcnt(15)
ds_read_b64_tr_b16 v[94:95], v120 offset:17376
v_mfma_f32_16x16x32_bf16 v[228:231], v[40:43], a[20:23], v[228:231]
s_waitcnt vmcnt(53)
ds_read_b64_tr_b16 v[96:97], v120 offset:17632
v_mfma_f32_16x16x32_bf16 v[228:231], v[36:39], a[16:19], v[228:231]
s_barrier
ds_read_b64_tr_b16 v[98:99], v120 offset:17888
v_add_u32 v120, 0, v3
v_mfma_f32_16x16x32_bf16 v[236:239], v[52:55], a[16:19], 0
ds_read_b64_tr_b16 v[36:37], v120 offset:0
ds_read_b32 v8, v7
v_mfma_f32_16x16x32_bf16 v[236:239], v[56:59], a[20:23], v[236:239]
ds_read_b64_tr_b16 v[38:39], v120 offset:256
v_mfma_f32_16x16x32_bf16 v[236:239], v[60:63], a[24:27], v[236:239]
s_waitcnt lgkmcnt(15)
ds_read_b64_tr_b16 v[40:41], v120 offset:512
ds_read_b64_tr_b16 v[42:43], v120 offset:768
v_mfma_f32_16x16x32_bf16 v[236:239], v[64:67], a[28:31], v[236:239]
buffer_store_dwordx4 v[164:167], v6, s[20:23], s52 offen offset:1024 sc1
v_mfma_f32_16x16x32_bf16 v[232:235], v[64:67], a[12:15], 0
ds_read_b64_tr_b16 v[44:45], v120 offset:16896
v_mfma_f32_16x16x32_bf16 v[232:235], v[60:63], a[8:11], v[232:235]
ds_read_b64_tr_b16 v[46:47], v120 offset:17152
v_mfma_f32_16x16x32_bf16 v[232:235], v[56:59], a[4:7], v[232:235]
ds_read_b64_tr_b16 v[48:49], v120 offset:17408
v_mfma_f32_16x16x32_bf16 v[232:235], v[52:55], a[0:3], v[232:235]
ds_read_b64_tr_b16 v[50:51], v120 offset:17664
v_mfma_f32_16x16x32_bf16 v[240:243], v[68:71], a[0:3], 0
ds_read_b64_tr_b16 v[52:53], v120 offset:32
v_mfma_f32_16x16x32_bf16 v[240:243], v[72:75], a[4:7], v[240:243]
s_waitcnt lgkmcnt(15)
ds_read_b64_tr_b16 v[54:55], v120 offset:288
v_mfma_f32_16x16x32_bf16 v[240:243], v[76:79], a[8:11], v[240:243]
ds_read_b64_tr_b16 v[56:57], v120 offset:544
ds_read_b64_tr_b16 v[58:59], v120 offset:800
s_waitcnt lgkmcnt(11)
v_readfirstlane_b32 s62, v8
v_mfma_f32_16x16x32_bf16 v[240:243], v[80:83], a[12:15], v[240:243]
buffer_store_dwordx4 v[168:171], v6, s[20:23], s52 offen offset:2048 sc1
v_mfma_f32_16x16x32_bf16 v[244:247], v[80:83], a[28:31], 0
s_cmp_lg_u32 s62, 0
s_cbranch_scc1 SLOW
ds_read_b64_tr_b16 v[60:61], v120 offset:16928
v_mfma_f32_16x16x32_bf16 v[244:247], v[76:79], a[24:27], v[244:247]
ds_read_b64_tr_b16 v[62:63], v120 offset:17184
v_mfma_f32_16x16x32_bf16 v[244:247], v[72:75], a[20:23], v[244:247]
ds_read_b64_tr_b16 v[64:65], v120 offset:17440
v_mfma_f32_16x16x32_bf16 v[244:247], v[68:71], a[16:19], v[244:247]
ds_read_b64_tr_b16 v[66:67], v120 offset:17696
v_mfma_f32_16x16x32_bf16 v[252:255], v[84:87], a[16:19], 0
ds_read_b64_tr_b16 v[68:69], v120 offset:64
v_mfma_f32_16x16x32_bf16 v[252:255], v[88:91], a[20:23], v[252:255]
ds_read_b64_tr_b16 v[70:71], v120 offset:320
v_mfma_f32_16x16x32_bf16 v[252:255], v[92:95], a[24:27], v[252:255]
ds_read_b64_tr_b16 v[72:73], v120 offset:576
ds_read_b64_tr_b16 v[74:75], v120 offset:832
v_mfma_f32_16x16x32_bf16 v[252:255], v[96:99], a[28:31], v[252:255]
buffer_store_dwordx4 v[172:175], v6, s[20:23], s52 offen offset:3072 sc1
v_mfma_f32_16x16x32_bf16 v[248:251], v[96:99], a[12:15], 0
ds_read_b64_tr_b16 v[76:77], v120 offset:16960
v_mfma_f32_16x16x32_bf16 v[248:251], v[92:95], a[8:11], v[248:251]
ds_read_b64_tr_b16 v[78:79], v120 offset:17216
v_mfma_f32_16x16x32_bf16 v[248:251], v[88:91], a[4:7], v[248:251]
s_waitcnt vmcnt(32)
ds_read_b64_tr_b16 v[80:81], v120 offset:17472
v_mfma_f32_16x16x32_bf16 v[248:251], v[84:87], a[0:3], v[248:251]
s_waitcnt lgkmcnt(15)
ds_read_b64_tr_b16 v[82:83], v120 offset:17728
v_mfma_f32_16x16x32_bf16 v[192:195], v[36:39], a[32:35], v[192:195]
ds_read_b64_tr_b16 v[84:85], v120 offset:96
v_mfma_f32_16x16x32_bf16 v[192:195], v[40:43], a[36:39], v[192:195]
ds_read_b64_tr_b16 v[86:87], v120 offset:352
v_mfma_f32_16x16x32_bf16 v[192:195], v[44:47], a[40:43], v[192:195]
s_mov_b32 s52, 73728
ds_read_b64_tr_b16 v[88:89], v120 offset:608
ds_read_b64_tr_b16 v[90:91], v120 offset:864
v_mfma_f32_16x16x32_bf16 v[192:195], v[48:51], a[44:47], v[192:195]
buffer_store_dwordx4 v[144:147], v6, s[20:23], s52 offen offset:0 sc1
v_mfma_f32_16x16x32_bf16 v[196:199], v[48:51], a[60:63], v[196:199]
ds_read_b64_tr_b16 v[92:93], v120 offset:16992
v_mfma_f32_16x16x32_bf16 v[196:199], v[44:47], a[56:59], v[196:199]
ds_read_b64_tr_b16 v[94:95], v120 offset:17248
v_mfma_f32_16x16x32_bf16 v[196:199], v[40:43], a[52:55], v[196:199]
ds_read_b64_tr_b16 v[96:97], v120 offset:17504
v_mfma_f32_16x16x32_bf16 v[196:199], v[36:39], a[48:51], v[196:199]
s_waitcnt lgkmcnt(15)
ds_read_b64_tr_b16 v[98:99], v120 offset:17760
v_mfma_f32_16x16x32_bf16 v[204:207], v[52:55], a[48:51], v[204:207]
ds_read_b64_tr_b16 v[36:37], v120 offset:128
v_mfma_f32_16x16x32_bf16 v[204:207], v[56:59], a[52:55], v[204:207]
ds_read_b64_tr_b16 v[38:39], v120 offset:384
v_mfma_f32_16x16x32_bf16 v[204:207], v[60:63], a[56:59], v[204:207]
ds_read_b64_tr_b16 v[40:41], v120 offset:640
ds_read_b64_tr_b16 v[42:43], v120 offset:896
v_mfma_f32_16x16x32_bf16 v[204:207], v[64:67], a[60:63], v[204:207]
buffer_store_dwordx4 v[148:151], v6, s[20:23], s52 offen offset:1024 sc1
v_mfma_f32_16x16x32_bf16 v[200:203], v[64:67], a[44:47], v[200:203]
ds_read_b64_tr_b16 v[44:45], v120 offset:17024
v_mfma_f32_16x16x32_bf16 v[200:203], v[60:63], a[40:43], v[200:203]
ds_read_b64_tr_b16 v[46:47], v120 offset:17280
v_mfma_f32_16x16x32_bf16 v[200:203], v[56:59], a[36:39], v[200:203]
ds_read_b64_tr_b16 v[48:49], v120 offset:17536
v_mfma_f32_16x16x32_bf16 v[200:203], v[52:55], a[32:35], v[200:203]
s_waitcnt lgkmcnt(15)
ds_read_b64_tr_b16 v[50:51], v120 offset:17792
v_mfma_f32_16x16x32_bf16 v[208:211], v[68:71], a[32:35], v[208:211]
ds_read_b64_tr_b16 v[52:53], v120 offset:160
v_mfma_f32_16x16x32_bf16 v[208:211], v[72:75], a[36:39], v[208:211]
ds_read_b64_tr_b16 v[54:55], v120 offset:416
v_mfma_f32_16x16x32_bf16 v[208:211], v[76:79], a[40:43], v[208:211]
ds_read_b64_tr_b16 v[56:57], v120 offset:672
ds_read_b64_tr_b16 v[58:59], v120 offset:928
v_mfma_f32_16x16x32_bf16 v[208:211], v[80:83], a[44:47], v[208:211]
buffer_store_dwordx4 v[152:155], v6, s[20:23], s52 offen offset:2048 sc1
v_mfma_f32_16x16x32_bf16 v[212:215], v[80:83], a[60:63], v[212:215]
ds_read_b64_tr_b16 v[60:61], v120 offset:17056
v_mfma_f32_16x16x32_bf16 v[212:215], v[76:79], a[56:59], v[212:215]
ds_read_b64_tr_b16 v[62:63], v120 offset:17312
v_mfma_f32_16x16x32_bf16 v[212:215], v[72:75], a[52:55], v[212:215]
ds_read_b64_tr_b16 v[64:65], v120 offset:17568
v_mfma_f32_16x16x32_bf16 v[212:215], v[68:71], a[48:51], v[212:215]
s_waitcnt lgkmcnt(15)
ds_read_b64_tr_b16 v[66:67], v120 offset:17824
v_mfma_f32_16x16x32_bf16 v[220:223], v[84:87], a[48:51], v[220:223]
ds_read_b64_tr_b16 v[68:69], v120 offset:192
v_mfma_f32_16x16x32_bf16 v[220:223], v[88:91], a[52:55], v[220:223]
ds_read_b64_tr_b16 v[70:71], v120 offset:448
v_mfma_f32_16x16x32_bf16 v[220:223], v[92:95], a[56:59], v[220:223]
ds_read_b64_tr_b16 v[72:73], v120 offset:704
ds_read_b64_tr_b16 v[74:75], v120 offset:960
v_mfma_f32_16x16x32_bf16 v[220:223], v[96:99], a[60:63], v[220:223]
buffer_store_dwordx4 v[156:159], v6, s[20:23], s52 offen offset:3072 sc1
v_mfma_f32_16x16x32_bf16 v[216:219], v[96:99], a[44:47], v[216:219]
ds_read_b64_tr_b16 v[76:77], v120 offset:17088
v_mfma_f32_16x16x32_bf16 v[216:219], v[92:95], a[40:43], v[216:219]
ds_read_b64_tr_b16 v[78:79], v120 offset:17344
v_mfma_f32_16x16x32_bf16 v[216:219], v[88:91], a[36:39], v[216:219]
ds_read_b64_tr_b16 v[80:81], v120 offset:17600
v_mfma_f32_16x16x32_bf16 v[216:219], v[84:87], a[32:35], v[216:219]
s_waitcnt lgkmcnt(15)
ds_read_b64_tr_b16 v[82:83], v120 offset:17856
v_mfma_f32_16x16x32_bf16 v[224:227], v[36:39], a[32:35], v[224:227]
ds_read_b64_tr_b16 v[84:85], v120 offset:224
v_mfma_f32_16x16x32_bf16 v[224:227], v[40:43], a[36:39], v[224:227]
ds_read_b64_tr_b16 v[86:87], v120 offset:480
v_mfma_f32_16x16x32_bf16 v[224:227], v[44:47], a[40:43], v[224:227]
s_mov_b32 s52, 77824
ds_read_b64_tr_b16 v[88:89], v120 offset:736
ds_read_b64_tr_b16 v[90:91], v120 offset:992
v_mfma_f32_16x16x32_bf16 v[224:227], v[48:51], a[44:47], v[224:227]
buffer_store_dwordx4 v[176:179], v6, s[20:23], s52 offen offset:0 sc1
v_mfma_f32_16x16x32_bf16 v[228:231], v[48:51], a[60:63], v[228:231]
ds_read_b64_tr_b16 v[92:93], v120 offset:17120
v_mfma_f32_16x16x32_bf16 v[228:231], v[44:47], a[56:59], v[228:231]
s_waitcnt lgkmcnt(15)
ds_read_b64_tr_b16 v[94:95], v120 offset:17376
v_mfma_f32_16x16x32_bf16 v[228:231], v[40:43], a[52:55], v[228:231]
s_waitcnt vmcnt(53)
ds_read_b64_tr_b16 v[96:97], v120 offset:17632
v_mfma_f32_16x16x32_bf16 v[228:231], v[36:39], a[48:51], v[228:231]
s_barrier
ds_read_b64_tr_b16 v[98:99], v120 offset:17888
v_add_u32 v120, 4294933504, v3
v_mfma_f32_16x16x32_bf16 v[236:239], v[52:55], a[48:51], v[236:239]
ds_read_b64_tr_b16 v[36:37], v120 offset:0
v_mfma_f32_16x16x32_bf16 v[236:239], v[56:59], a[52:55], v[236:239]
ds_read_b64_tr_b16 v[38:39], v120 offset:256
v_mfma_f32_16x16x32_bf16 v[236:239], v[60:63], a[56:59], v[236:239]
s_waitcnt lgkmcnt(15)
ds_read_b64_tr_b16 v[40:41], v120 offset:512
ds_read_b64_tr_b16 v[42:43], v120 offset:768
v_mfma_f32_16x16x32_bf16 v[236:239], v[64:67], a[60:63], v[236:239]
s_mov_b32 s89, 1048576
buffer_store_dwordx4 v[180:183], v6, s[20:23], s52 offen offset:1024 sc1
v_mfma_f32_16x16x32_bf16 v[232:235], v[64:67], a[44:47], v[232:235]
s_add_u32 m0, s90, 0
ds_read_b64_tr_b16 v[44:45], v120 offset:16896
ds_read_b64_tr_b16 v[46:47], v120 offset:17152
v_mfma_f32_16x16x32_bf16 v[232:235], v[60:63], a[40:43], v[232:235]
buffer_load_dwordx4 v118, s[8:11], s89 offen offset:0  lds
v_mfma_f32_16x16x32_bf16 v[232:235], v[56:59], a[36:39], v[232:235]
s_add_u32 m0, s90, 32
ds_read_b64_tr_b16 v[48:49], v120 offset:17408
ds_read_b64_tr_b16 v[50:51], v120 offset:17664
v_mfma_f32_16x16x32_bf16 v[232:235], v[52:55], a[32:35], v[232:235]
buffer_load_dwordx4 v118, s[8:11], s89 offen offset:1024  lds
v_mfma_f32_16x16x32_bf16 v[240:243], v[68:71], a[32:35], v[240:243]
s_waitcnt lgkmcnt(15)
ds_read_b64_tr_b16 v[52:53], v120 offset:32
ds_read_b64_tr_b16 v[54:55], v120 offset:288
v_mfma_f32_16x16x32_bf16 v[240:243], v[72:75], a[36:39], v[240:243]
ds_read_b64_tr_b16 v[56:57], v120 offset:544
v_mfma_f32_16x16x32_bf16 v[240:243], v[76:79], a[40:43], v[240:243]
ds_read_b64_tr_b16 v[58:59], v120 offset:800
ds_read_b64_tr_b16 v[60:61], v120 offset:16928
v_mfma_f32_16x16x32_bf16 v[240:243], v[80:83], a[44:47], v[240:243]
buffer_store_dwordx4 v[184:187], v6, s[20:23], s52 offen offset:2048 sc1
v_mfma_f32_16x16x32_bf16 v[244:247], v[80:83], a[60:63], v[244:247]
s_add_u32 m0, s90, 64
ds_read_b64_tr_b16 v[62:63], v120 offset:17184
ds_read_b64_tr_b16 v[64:65], v120 offset:17440
v_mfma_f32_16x16x32_bf16 v[244:247], v[76:79], a[56:59], v[244:247]
buffer_load_dwordx4 v118, s[8:11], s89 offen offset:2048  lds
v_mfma_f32_16x16x32_bf16 v[244:247], v[72:75], a[52:55], v[244:247]
s_add_u32 m0, s90, 96
ds_read_b64_tr_b16 v[66:67], v120 offset:17696
v_mfma_f32_16x16x32_bf16 v[244:247], v[68:71], a[48:51], v[244:247]
s_waitcnt lgkmcnt(15)
buffer_load_dwordx4 v118, s[8:11], s89 offen offset:3072  lds
v_mfma_f32_16x16x32_bf16 v[252:255], v[84:87], a[48:51], v[252:255]
ds_read_b64_tr_b16 v[68:69], v120 offset:64
ds_read_b64_tr_b16 v[70:71], v120 offset:320
v_mfma_f32_16x16x32_bf16 v[252:255], v[88:91], a[52:55], v[252:255]
ds_read_b64_tr_b16 v[72:73], v120 offset:576
v_mfma_f32_16x16x32_bf16 v[252:255], v[92:95], a[56:59], v[252:255]
ds_read_b64_tr_b16 v[74:75], v120 offset:832
ds_read_b64_tr_b16 v[76:77], v120 offset:16960
v_mfma_f32_16x16x32_bf16 v[252:255], v[96:99], a[60:63], v[252:255]
buffer_store_dwordx4 v[188:191], v6, s[20:23], s52 offen offset:3072 sc1
v_mfma_f32_16x16x32_bf16 v[248:251], v[96:99], a[44:47], v[248:251]
s_add_u32 m0, s90, 4224
ds_read_b64_tr_b16 v[78:79], v120 offset:17216
ds_read_b64_tr_b16 v[80:81], v120 offset:17472
v_mfma_f32_16x16x32_bf16 v[248:251], v[92:95], a[40:43], v[248:251]
buffer_load_dwordx4 v119, s[8:11], s89 offen offset:0  lds
v_mfma_f32_16x16x32_bf16 v[248:251], v[88:91], a[36:39], v[248:251]
s_add_u32 m0, s90, 4256
s_waitcnt vmcnt(30)
ds_read_b64_tr_b16 v[82:83], v120 offset:17728
v_mfma_f32_16x16x32_bf16 v[248:251], v[84:87], a[32:35], v[248:251]
s_waitcnt lgkmcnt(15)
buffer_load_dwordx4 v119, s[8:11], s89 offen offset:1024  lds
v_mfma_f32_16x16x32_bf16 v[192:195], v[36:39], a[64:67], v[192:195]
ds_read_b64_tr_b16 v[84:85], v120 offset:96
ds_read_b64_tr_b16 v[86:87], v120 offset:352
v_mfma_f32_16x16x32_bf16 v[192:195], v[40:43], a[68:71], v[192:195]
ds_read_b64_tr_b16 v[88:89], v120 offset:608
v_mfma_f32_16x16x32_bf16 v[192:195], v[44:47], a[72:75], v[192:195]
s_add_u32 m0, s90, 4288
ds_read_b64_tr_b16 v[90:91], v120 offset:864
ds_read_b64_tr_b16 v[92:93], v120 offset:16992
v_mfma_f32_16x16x32_bf16 v[192:195], v[48:51], a[76:79], v[192:195]
buffer_load_dwordx4 v119, s[8:11], s89 offen offset:2048  lds
v_mfma_f32_16x16x32_bf16 v[196:199], v[48:51], a[92:95], v[196:199]
ds_read_b64_tr_b16 v[94:95], v120 offset:17248
v_mfma_f32_16x16x32_bf16 v[196:199], v[44:47], a[88:91], v[196:199]
ds_read_b64_tr_b16 v[96:97], v120 offset:17504
v_mfma_f32_16x16x32_bf16 v[196:199], v[40:43], a[84:87], v[196:199]
s_add_u32 m0, s90, 4320
ds_read_b64_tr_b16 v[98:99], v120 offset:17760
v_mfma_f32_16x16x32_bf16 v[196:199], v[36:39], a[80:83], v[196:199]
s_waitcnt lgkmcnt(15)
buffer_load_dwordx4 v119, s[8:11], s89 offen offset:3072  lds
v_mfma_f32_16x16x32_bf16 v[204:207], v[52:55], a[80:83], v[204:207]
ds_read_b64_tr_b16 v[36:37], v120 offset:128
ds_read_b64_tr_b16 v[38:39], v120 offset:384
v_mfma_f32_16x16x32_bf16 v[204:207], v[56:59], a[84:87], v[204:207]
s_mov_b32 s88, 524288
ds_read_b64_tr_b16 v[40:41], v120 offset:640
ds_read_b64_tr_b16 v[42:43], v120 offset:896
v_mfma_f32_16x16x32_bf16 v[204:207], v[60:63], a[88:91], v[204:207]
buffer_load_dwordx4 a[0:3], v116, s[4:7], s88 offen offset:0 sc1
v_mfma_f32_16x16x32_bf16 v[204:207], v[64:67], a[92:95], v[204:207]
ds_read_b64_tr_b16 v[44:45], v120 offset:17024
v_mfma_f32_16x16x32_bf16 v[200:203], v[64:67], a[76:79], v[200:203]
ds_read_b64_tr_b16 v[46:47], v120 offset:17280
v_mfma_f32_16x16x32_bf16 v[200:203], v[60:63], a[72:75], v[200:203]
ds_read_b64_tr_b16 v[48:49], v120 offset:17536
v_mfma_f32_16x16x32_bf16 v[200:203], v[56:59], a[68:71], v[200:203]
buffer_load_dwordx4 a[4:7], v116, s[4:7], s88 offen offset:1024 sc1
v_mfma_f32_16x16x32_bf16 v[200:203], v[52:55], a[64:67], v[200:203]
s_waitcnt lgkmcnt(15)
ds_read_b64_tr_b16 v[50:51], v120 offset:17792
v_mfma_f32_16x16x32_bf16 v[208:211], v[68:71], a[64:67], v[208:211]
ds_read_b64_tr_b16 v[52:53], v120 offset:160
v_mfma_f32_16x16x32_bf16 v[208:211], v[72:75], a[68:71], v[208:211]
ds_read_b64_tr_b16 v[54:55], v120 offset:416
ds_read_b64_tr_b16 v[56:57], v120 offset:672
v_mfma_f32_16x16x32_bf16 v[208:211], v[76:79], a[72:75], v[208:211]
buffer_load_dwordx4 a[8:11], v116, s[4:7], s88 offen offset:2048 sc1
v_mfma_f32_16x16x32_bf16 v[208:211], v[80:83], a[76:79], v[208:211]
ds_read_b64_tr_b16 v[58:59], v120 offset:928
ds_read_b64_tr_b16 v[60:61], v120 offset:17056
v_mfma_f32_16x16x32_bf16 v[212:215], v[80:83], a[92:95], v[212:215]
ds_read_b64_tr_b16 v[62:63], v120 offset:17312
v_mfma_f32_16x16x32_bf16 v[212:215], v[76:79], a[88:91], v[212:215]
ds_read_b64_tr_b16 v[64:65], v120 offset:17568
v_mfma_f32_16x16x32_bf16 v[212:215], v[72:75], a[84:87], v[212:215]
buffer_load_dwordx4 a[12:15], v116, s[4:7], s88 offen offset:3072 sc1
v_mfma_f32_16x16x32_bf16 v[212:215], v[68:71], a[80:83], v[212:215]
s_waitcnt lgkmcnt(15)
ds_read_b64_tr_b16 v[66:67], v120 offset:17824
v_mfma_f32_16x16x32_bf16 v[220:223], v[84:87], a[80:83], v[220:223]
ds_read_b64_tr_b16 v[68:69], v120 offset:192
v_mfma_f32_16x16x32_bf16 v[220:223], v[88:91], a[84:87], v[220:223]
ds_read_b64_tr_b16 v[70:71], v120 offset:448
ds_read_b64_tr_b16 v[72:73], v120 offset:704
v_mfma_f32_16x16x32_bf16 v[220:223], v[92:95], a[88:91], v[220:223]
buffer_load_dwordx4 a[16:19], v117, s[4:7], s88 offen offset:0 sc1
v_mfma_f32_16x16x32_bf16 v[220:223], v[96:99], a[92:95], v[220:223]
ds_read_b64_tr_b16 v[74:75], v120 offset:960
ds_read_b64_tr_b16 v[76:77], v120 offset:17088
v_mfma_f32_16x16x32_bf16 v[216:219], v[96:99], a[76:79], v[216:219]
ds_read_b64_tr_b16 v[78:79], v120 offset:17344
v_mfma_f32_16x16x32_bf16 v[216:219], v[92:95], a[72:75], v[216:219]
buffer_load_dwordx4 a[20:23], v117, s[4:7], s88 offen offset:1024 sc1
v_mfma_f32_16x16x32_bf16 v[216:219], v[88:91], a[68:71], v[216:219]
ds_read_b64_tr_b16 v[80:81], v120 offset:17600
v_mfma_f32_16x16x32_bf16 v[216:219], v[84:87], a[64:67], v[216:219]
s_waitcnt lgkmcnt(15)
ds_read_b64_tr_b16 v[82:83], v120 offset:17856
v_mfma_f32_16x16x32_bf16 v[224:227], v[36:39], a[64:67], v[224:227]
ds_read_b64_tr_b16 v[84:85], v120 offset:224
ds_read_b64_tr_b16 v[86:87], v120 offset:480
v_mfma_f32_16x16x32_bf16 v[224:227], v[40:43], a[68:71], v[224:227]
buffer_load_dwordx4 a[24:27], v117, s[4:7], s88 offen offset:2048 sc1
v_mfma_f32_16x16x32_bf16 v[224:227], v[44:47], a[72:75], v[224:227]
ds_read_b64_tr_b16 v[88:89], v120 offset:736
ds_read_b64_tr_b16 v[90:91], v120 offset:992
v_mfma_f32_16x16x32_bf16 v[224:227], v[48:51], a[76:79], v[224:227]
ds_read_b64_tr_b16 v[92:93], v120 offset:17120
v_mfma_f32_16x16x32_bf16 v[228:231], v[48:51], a[92:95], v[228:231]
ds_read_b64_tr_b16 v[94:95], v120 offset:17376
v_mfma_f32_16x16x32_bf16 v[228:231], v[44:47], a[88:91], v[228:231]
s_waitcnt lgkmcnt(15)
buffer_load_dwordx4 a[28:31], v117, s[4:7], s88 offen offset:3072 sc1
v_mfma_f32_16x16x32_bf16 v[228:231], v[40:43], a[84:87], v[228:231]
s_waitcnt vmcnt(12)
ds_read_b64_tr_b16 v[96:97], v120 offset:17632
v_mfma_f32_16x16x32_bf16 v[228:231], v[36:39], a[80:83], v[228:231]
s_barrier
ds_read_b64_tr_b16 v[98:99], v120 offset:17888
v_add_u32 v120, 33792, v3
v_mfma_f32_16x16x32_bf16 v[236:239], v[52:55], a[80:83], v[236:239]
s_cmp_eq_u32 s60, 0
s_cbranch_scc1 PUB2
PUB2_RET:
s_mov_b32 s89, 1310720
ds_read_b64_tr_b16 v[36:37], v120 offset:0
v_mfma_f32_16x16x32_bf16 v[236:239], v[56:59], a[84:87], v[236:239]
s_add_u32 m0, s90, 67584
ds_read_b64_tr_b16 v[38:39], v120 offset:256
ds_read_b64_tr_b16 v[40:41], v120 offset:512
v_mfma_f32_16x16x32_bf16 v[236:239], v[60:63], a[88:91], v[236:239]
s_waitcnt lgkmcnt(15)
buffer_load_dwordx4 v118, s[8:11], s89 offen offset:0  lds
v_mfma_f32_16x16x32_bf16 v[236:239], v[64:67], a[92:95], v[236:239]
ds_read_b64_tr_b16 v[42:43], v120 offset:768
ds_read_b64_tr_b16 v[44:45], v120 offset:16896
v_mfma_f32_16x16x32_bf16 v[232:235], v[64:67], a[76:79], v[232:235]
s_add_u32 m0, s90, 67616
ds_read_b64_tr_b16 v[46:47], v120 offset:17152
v_mfma_f32_16x16x32_bf16 v[232:235], v[60:63], a[72:75], v[232:235]
buffer_load_dwordx4 v118, s[8:11], s89 offen offset:1024  lds
v_mfma_f32_16x16x32_bf16 v[232:235], v[56:59], a[68:71], v[232:235]
ds_read_b64_tr_b16 v[48:49], v120 offset:17408
v_mfma_f32_16x16x32_bf16 v[232:235], v[52:55], a[64:67], v[232:235]
s_add_u32 m0, s90, 67648
ds_read_b64_tr_b16 v[50:51], v120 offset:17664
v_mfma_f32_16x16x32_bf16 v[240:243], v[68:71], a[64:67], v[240:243]
buffer_load_dwordx4 v118, s[8:11], s89 offen offset:2048  lds
v_mfma_f32_16x16x32_bf16 v[240:243], v[72:75], a[68:71], v[240:243]
s_waitcnt lgkmcnt(15)
ds_read_b64_tr_b16 v[52:53], v120 offset:32
ds_read_b64_tr_b16 v[54:55], v120 offset:288
v_mfma_f32_16x16x32_bf16 v[240:243], v[76:79], a[72:75], v[240:243]
ds_read_b64_tr_b16 v[56:57], v120 offset:544
v_mfma_f32_16x16x32_bf16 v[240:243], v[80:83], a[76:79], v[240:243]
s_add_u32 m0, s90, 67680
ds_read_b64_tr_b16 v[58:59], v120 offset:800
ds_read_b64_tr_b16 v[60:61], v120 offset:16928
v_mfma_f32_16x16x32_bf16 v[244:247], v[80:83], a[92:95], v[244:247]
buffer_load_dwordx4 v118, s[8:11], s89 offen offset:3072  lds
v_mfma_f32_16x16x32_bf16 v[244:247], v[76:79], a[88:91], v[244:247]
ds_read_b64_tr_b16 v[62:63], v120 offset:17184
v_mfma_f32_16x16x32_bf16 v[244:247], v[72:75], a[84:87], v[244:247]
s_waitcnt lgkmcnt(15)
ds_read_b64_tr_b16 v[64:65], v120 offset:17440
v_mfma_f32_16x16x32_bf16 v[244:247], v[68:71], a[80:83], v[244:247]
s_add_u32 m0, s90, 71808
ds_read_b64_tr_b16 v[66:67], v120 offset:17696
v_mfma_f32_16x16x32_bf16 v[252:255], v[84:87], a[80:83], v[252:255]
buffer_load_dwordx4 v119, s[8:11], s89 offen offset:0  lds
v_mfma_f32_16x16x32_bf16 v[252:255], v[88:91], a[84:87], v[252:255]
ds_read_b64_tr_b16 v[68:69], v120 offset:64
ds_read_b64_tr_b16 v[70:71], v120 offset:320
v_mfma_f32_16x16x32_bf16 v[252:255], v[92:95], a[88:91], v[252:255]
s_waitcnt lgkmcnt(15)
ds_read_b64_tr_b16 v[72:73], v120 offset:576
v_mfma_f32_16x16x32_bf16 v[252:255], v[96:99], a[92:95], v[252:255]
s_add_u32 m0, s90, 71840
ds_read_b64_tr_b16 v[74:75], v120 offset:832
ds_read_b64_tr_b16 v[76:77], v120 offset:16960
v_mfma_f32_16x16x32_bf16 v[248:251], v[96:99], a[76:79], v[248:251]
buffer_load_dwordx4 v119, s[8:11], s89 offen offset:1024  lds
v_mfma_f32_16x16x32_bf16 v[248:251], v[92:95], a[72:75], v[248:251]
ds_read_b64_tr_b16 v[78:79], v120 offset:17216
v_mfma_f32_16x16x32_bf16 v[248:251], v[88:91], a[68:71], v[248:251]
s_waitcnt vmcnt(38)
ds_read_b64_tr_b16 v[80:81], v120 offset:17472
v_mfma_f32_16x16x32_bf16 v[248:251], v[84:87], a[64:67], v[248:251]
s_add_u32 m0, s90, 71872
ds_read_b64_tr_b16 v[82:83], v120 offset:17728
v_mfma_f32_16x16x32_bf16 v[192:195], v[36:39], a[96:99], v[192:195]
s_waitcnt lgkmcnt(15)
buffer_load_dwordx4 v119, s[8:11], s89 offen offset:2048  lds
v_mfma_f32_16x16x32_bf16 v[192:195], v[40:43], a[100:103], v[192:195]
ds_read_b64_tr_b16 v[84:85], v120 offset:96
ds_read_b64_tr_b16 v[86:87], v120 offset:352
v_mfma_f32_16x16x32_bf16 v[192:195], v[44:47], a[104:107], v[192:195]
s_add_u32 m0, s90, 71904
ds_read_b64_tr_b16 v[88:89], v120 offset:608
ds_read_b64_tr_b16 v[90:91], v120 offset:864
v_mfma_f32_16x16x32_bf16 v[192:195], v[48:51], a[108:111], v[192:195]
buffer_load_dwordx4 v119, s[8:11], s89 offen offset:3072  lds
v_mfma_f32_16x16x32_bf16 v[196:199], v[48:51], a[124:127], v[196:199]
ds_read_b64_tr_b16 v[92:93], v120 offset:16992
ds_read_b64_tr_b16 v[94:95], v120 offset:17248
v_mfma_f32_16x16x32_bf16 v[196:199], v[44:47], a[120:123], v[196:199]
s_mov_b64 s[72:73], s[68:69]
ds_read_b64_tr_b16 v[96:97], v120 offset:17504
v_mfma_f32_16x16x32_bf16 v[196:199], v[40:43], a[116:119], v[196:199]
s_mov_b32 s88, 655360
ds_read_b64_tr_b16 v[98:99], v120 offset:17760
v_mfma_f32_16x16x32_bf16 v[196:199], v[36:39], a[112:115], v[196:199]
s_waitcnt lgkmcnt(15)
buffer_load_dwordx4 a[32:35], v116, s[4:7], s88 offen offset:0 sc1
v_mfma_f32_16x16x32_bf16 v[204:207], v[52:55], a[112:115], v[204:207]
ds_read_b64_tr_b16 v[36:37], v120 offset:128
ds_read_b64_tr_b16 v[38:39], v120 offset:384
v_mfma_f32_16x16x32_bf16 v[204:207], v[56:59], a[116:119], v[204:207]
ds_read_b64_tr_b16 v[40:41], v120 offset:640
v_mfma_f32_16x16x32_bf16 v[204:207], v[60:63], a[120:123], v[204:207]
ds_read_b64_tr_b16 v[42:43], v120 offset:896
ds_read_b64_tr_b16 v[44:45], v120 offset:17024
v_mfma_f32_16x16x32_bf16 v[204:207], v[64:67], a[124:127], v[204:207]
buffer_load_dwordx4 a[36:39], v116, s[4:7], s88 offen offset:1024 sc1
v_mfma_f32_16x16x32_bf16 v[200:203], v[64:67], a[108:111], v[200:203]
ds_read_b64_tr_b16 v[46:47], v120 offset:17280
v_mfma_f32_16x16x32_bf16 v[200:203], v[60:63], a[104:107], v[200:203]
ds_read_b64_tr_b16 v[48:49], v120 offset:17536
v_mfma_f32_16x16x32_bf16 v[200:203], v[56:59], a[100:103], v[200:203]
ds_read_b64_tr_b16 v[50:51], v120 offset:17792
v_mfma_f32_16x16x32_bf16 v[200:203], v[52:55], a[96:99], v[200:203]
s_waitcnt lgkmcnt(15)
buffer_load_dwordx4 a[40:43], v116, s[4:7], s88 offen offset:2048 sc1
v_mfma_f32_16x16x32_bf16 v[208:211], v[68:71], a[96:99], v[208:211]
ds_read_b64_tr_b16 v[52:53], v120 offset:160
ds_read_b64_tr_b16 v[54:55], v120 offset:416
v_mfma_f32_16x16x32_bf16 v[208:211], v[72:75], a[100:103], v[208:211]
ds_read_b64_tr_b16 v[56:57], v120 offset:672
v_mfma_f32_16x16x32_bf16 v[208:211], v[76:79], a[104:107], v[208:211]
ds_read_b64_tr_b16 v[58:59], v120 offset:928
ds_read_b64_tr_b16 v[60:61], v120 offset:17056
v_mfma_f32_16x16x32_bf16 v[208:211], v[80:83], a[108:111], v[208:211]
buffer_load_dwordx4 a[44:47], v116, s[4:7], s88 offen offset:3072 sc1
v_mfma_f32_16x16x32_bf16 v[212:215], v[80:83], a[124:127], v[212:215]
ds_read_b64_tr_b16 v[62:63], v120 offset:17312
v_mfma_f32_16x16x32_bf16 v[212:215], v[76:79], a[120:123], v[212:215]
ds_read_b64_tr_b16 v[64:65], v120 offset:17568
v_mfma_f32_16x16x32_bf16 v[212:215], v[72:75], a[116:119], v[212:215]
buffer_load_dwordx4 a[48:51], v117, s[4:7], s88 offen offset:0 sc1
v_mfma_f32_16x16x32_bf16 v[212:215], v[68:71], a[112:115], v[212:215]
s_waitcnt lgkmcnt(15)
ds_read_b64_tr_b16 v[66:67], v120 offset:17824
v_mfma_f32_16x16x32_bf16 v[220:223], v[84:87], a[112:115], v[220:223]
ds_read_b64_tr_b16 v[68:69], v120 offset:192
v_mfma_f32_16x16x32_bf16 v[220:223], v[88:91], a[116:119], v[220:223]
ds_read_b64_tr_b16 v[70:71], v120 offset:448
ds_read_b64_tr_b16 v[72:73], v120 offset:704
v_mfma_f32_16x16x32_bf16 v[220:223], v[92:95], a[120:123], v[220:223]
buffer_load_dwordx4 a[52:55], v117, s[4:7], s88 offen offset:1024 sc1
v_mfma_f32_16x16x32_bf16 v[220:223], v[96:99], a[124:127], v[220:223]
ds_read_b64_tr_b16 v[74:75], v120 offset:960
ds_read_b64_tr_b16 v[76:77], v120 offset:17088
v_mfma_f32_16x16x32_bf16 v[216:219], v[96:99], a[108:111], v[216:219]
ds_read_b64_tr_b16 v[78:79], v120 offset:17344
v_mfma_f32_16x16x32_bf16 v[216:219], v[92:95], a[104:107], v[216:219]
ds_read_b64_tr_b16 v[80:81], v120 offset:17600
v_mfma_f32_16x16x32_bf16 v[216:219], v[88:91], a[100:103], v[216:219]
buffer_load_dwordx4 a[56:59], v117, s[4:7], s88 offen offset:2048 sc1
v_mfma_f32_16x16x32_bf16 v[216:219], v[84:87], a[96:99], v[216:219]
s_waitcnt lgkmcnt(15)
ds_read_b64_tr_b16 v[82:83], v120 offset:17856
v_mfma_f32_16x16x32_bf16 v[224:227], v[36:39], a[96:99], v[224:227]
ds_read_b64_tr_b16 v[84:85], v120 offset:224
v_mfma_f32_16x16x32_bf16 v[224:227], v[40:43], a[100:103], v[224:227]
ds_read_b64_tr_b16 v[86:87], v120 offset:480
ds_read_b64_tr_b16 v[88:89], v120 offset:736
v_mfma_f32_16x16x32_bf16 v[224:227], v[44:47], a[104:107], v[224:227]
buffer_load_dwordx4 a[60:63], v117, s[4:7], s88 offen offset:3072 sc1
v_mfma_f32_16x16x32_bf16 v[224:227], v[48:51], a[108:111], v[224:227]
ds_read_b64_tr_b16 v[90:91], v120 offset:992
v_mfma_f32_16x16x32_bf16 v[228:231], v[48:51], a[124:127], v[228:231]
ds_read_b64_tr_b16 v[92:93], v120 offset:17120
v_mfma_f32_16x16x32_bf16 v[228:231], v[44:47], a[120:123], v[228:231]
s_waitcnt lgkmcnt(15)
ds_read_b64_tr_b16 v[94:95], v120 offset:17376
v_mfma_f32_16x16x32_bf16 v[228:231], v[40:43], a[116:119], v[228:231]
s_waitcnt vmcnt(24)
ds_read_b64_tr_b16 v[96:97], v120 offset:17632
v_mfma_f32_16x16x32_bf16 v[228:231], v[36:39], a[112:115], v[228:231]
s_barrier
ds_read_b64_tr_b16 v[98:99], v120 offset:17888
v_add_u32 v120, 4294899712, v3
v_mfma_f32_16x16x32_bf16 v[236:239], v[52:55], a[112:115], v[236:239]
s_mov_b32 s89, 1572864
ds_read_b64_tr_b16 v[36:37], v120 offset:0
v_mfma_f32_16x16x32_bf16 v[236:239], v[56:59], a[116:119], v[236:239]
s_add_u32 m0, s90, 33792
ds_read_b64_tr_b16 v[38:39], v120 offset:256
ds_read_b64_tr_b16 v[40:41], v120 offset:512
v_mfma_f32_16x16x32_bf16 v[236:239], v[60:63], a[120:123], v[236:239]
s_waitcnt lgkmcnt(15)
buffer_load_dwordx4 v118, s[8:11], s89 offen offset:0  lds
v_mfma_f32_16x16x32_bf16 v[236:239], v[64:67], a[124:127], v[236:239]
s_add_u32 m0, s90, 33824
ds_read_b64_tr_b16 v[42:43], v120 offset:768
ds_read_b64_tr_b16 v[44:45], v120 offset:16896
v_mfma_f32_16x16x32_bf16 v[232:235], v[64:67], a[108:111], v[232:235]
buffer_load_dwordx4 v118, s[8:11], s89 offen offset:1024  lds
v_mfma_f32_16x16x32_bf16 v[232:235], v[60:63], a[104:107], v[232:235]
ds_read_b64_tr_b16 v[46:47], v120 offset:17152
v_mfma_f32_16x16x32_bf16 v[232:235], v[56:59], a[100:103], v[232:235]
ds_read_b64_tr_b16 v[48:49], v120 offset:17408
v_mfma_f32_16x16x32_bf16 v[232:235], v[52:55], a[96:99], v[232:235]
s_add_u32 m0, s90, 33856
ds_read_b64_tr_b16 v[50:51], v120 offset:17664
v_mfma_f32_16x16x32_bf16 v[240:243], v[68:71], a[96:99], v[240:243]
buffer_load_dwordx4 v118, s[8:11], s89 offen offset:2048  lds
v_mfma_f32_16x16x32_bf16 v[240:243], v[72:75], a[100:103], v[240:243]
s_waitcnt lgkmcnt(15)
ds_read_b64_tr_b16 v[52:53], v120 offset:32
ds_read_b64_tr_b16 v[54:55], v120 offset:288
v_mfma_f32_16x16x32_bf16 v[240:243], v[76:79], a[104:107], v[240:243]
ds_read_b64_tr_b16 v[56:57], v120 offset:544
v_mfma_f32_16x16x32_bf16 v[240:243], v[80:83], a[108:111], v[240:243]
s_add_u32 m0, s90, 33888
ds_read_b64_tr_b16 v[58:59], v120 offset:800
ds_read_b64_tr_b16 v[60:61], v120 offset:16928
v_mfma_f32_16x16x32_bf16 v[244:247], v[80:83], a[124:127], v[244:247]
buffer_load_dwordx4 v118, s[8:11], s89 offen offset:3072  lds
v_mfma_f32_16x16x32_bf16 v[244:247], v[76:79], a[120:123], v[244:247]
ds_read_b64_tr_b16 v[62:63], v120 offset:17184
ds_read_b64_tr_b16 v[64:65], v120 offset:17440
v_mfma_f32_16x16x32_bf16 v[244:247], v[72:75], a[116:119], v[244:247]
s_add_u32 m0, s90, 38016
ds_read_b64_tr_b16 v[66:67], v120 offset:17696
v_mfma_f32_16x16x32_bf16 v[244:247], v[68:71], a[112:115], v[244:247]
s_waitcnt lgkmcnt(15)
buffer_load_dwordx4 v119, s[8:11], s89 offen offset:0  lds
v_mfma_f32_16x16x32_bf16 v[252:255], v[84:87], a[112:115], v[252:255]
ds_read_b64_tr_b16 v[68:69], v120 offset:64
ds_read_b64_tr_b16 v[70:71], v120 offset:320
v_mfma_f32_16x16x32_bf16 v[252:255], v[88:91], a[116:119], v[252:255]
ds_read_b64_tr_b16 v[72:73], v120 offset:576
v_mfma_f32_16x16x32_bf16 v[252:255], v[92:95], a[120:123], v[252:255]
s_add_u32 m0, s90, 38048
ds_read_b64_tr_b16 v[74:75], v120 offset:832
ds_read_b64_tr_b16 v[76:77], v120 offset:16960
v_mfma_f32_16x16x32_bf16 v[252:255], v[96:99], a[124:127], v[252:255]
buffer_load_dwordx4 v119, s[8:11], s89 offen offset:1024  lds
v_mfma_f32_16x16x32_bf16 v[248:251], v[96:99], a[108:111], v[248:251]
ds_read_b64_tr_b16 v[78:79], v120 offset:17216
v_mfma_f32_16x16x32_bf16 v[248:251], v[92:95], a[104:107], v[248:251]
ds_read_b64_tr_b16 v[80:81], v120 offset:17472
v_mfma_f32_16x16x32_bf16 v[248:251], v[88:91], a[100:103], v[248:251]
s_add_u32 m0, s90, 38080
s_waitcnt vmcnt(22)
ds_read_b64_tr_b16 v[82:83], v120 offset:17728
v_mfma_f32_16x16x32_bf16 v[248:251], v[84:87], a[96:99], v[248:251]
s_waitcnt lgkmcnt(15)
buffer_load_dwordx4 v119, s[8:11], s89 offen offset:2048  lds
v_mfma_f32_16x16x32_bf16 v[192:195], v[36:39], a[0:3], v[192:195]
ds_read_b64_tr_b16 v[84:85], v120 offset:96
ds_read_b64_tr_b16 v[86:87], v120 offset:352
v_mfma_f32_16x16x32_bf16 v[192:195], v[40:43], a[4:7], v[192:195]
ds_read_b64_tr_b16 v[88:89], v120 offset:608
v_mfma_f32_16x16x32_bf16 v[192:195], v[44:47], a[8:11], v[192:195]
s_add_u32 m0, s90, 38112
ds_read_b64_tr_b16 v[90:91], v120 offset:864
ds_read_b64_tr_b16 v[92:93], v120 offset:16992
v_mfma_f32_16x16x32_bf16 v[192:195], v[48:51], a[12:15], v[192:195]
buffer_load_dwordx4 v119, s[8:11], s89 offen offset:3072  lds
v_mfma_f32_16x16x32_bf16 v[196:199], v[48:51], a[28:31], v[196:199]
ds_read_b64_tr_b16 v[94:95], v120 offset:17248
v_mfma_f32_16x16x32_bf16 v[196:199], v[44:47], a[24:27], v[196:199]
ds_read_b64_tr_b16 v[96:97], v120 offset:17504
v_mfma_f32_16x16x32_bf16 v[196:199], v[40:43], a[20:23], v[196:199]
s_mov_b32 s88, 786432
ds_read_b64_tr_b16 v[98:99], v120 offset:17760
v_mfma_f32_16x16x32_bf16 v[196:199], v[36:39], a[16:19], v[196:199]
s_waitcnt lgkmcnt(15)
buffer_load_dwordx4 a[64:67], v116, s[4:7], s88 offen offset:0 sc1
v_mfma_f32_16x16x32_bf16 v[204:207], v[52:55], a[16:19], v[204:207]
ds_read_b64_tr_b16 v[36:37], v120 offset:128
ds_read_b64_tr_b16 v[38:39], v120 offset:384
v_mfma_f32_16x16x32_bf16 v[204:207], v[56:59], a[20:23], v[204:207]
ds_read_b64_tr_b16 v[40:41], v120 offset:640
ds_read_b64_tr_b16 v[42:43], v120 offset:896
v_mfma_f32_16x16x32_bf16 v[204:207], v[60:63], a[24:27], v[204:207]
buffer_load_dwordx4 a[68:71], v116, s[4:7], s88 offen offset:1024 sc1
v_mfma_f32_16x16x32_bf16 v[204:207], v[64:67], a[28:31], v[204:207]
ds_read_b64_tr_b16 v[44:45], v120 offset:17024
v_mfma_f32_16x16x32_bf16 v[200:203], v[64:67], a[12:15], v[200:203]
ds_read_b64_tr_b16 v[46:47], v120 offset:17280
v_mfma_f32_16x16x32_bf16 v[200:203], v[60:63], a[8:11], v[200:203]
ds_read_b64_tr_b16 v[48:49], v120 offset:17536
v_mfma_f32_16x16x32_bf16 v[200:203], v[56:59], a[4:7], v[200:203]
buffer_load_dwordx4 a[72:75], v116, s[4:7], s88 offen offset:2048 sc1
v_mfma_f32_16x16x32_bf16 v[200:203], v[52:55], a[0:3], v[200:203]
s_waitcnt lgkmcnt(15)
ds_read_b64_tr_b16 v[50:51], v120 offset:17792
v_mfma_f32_16x16x32_bf16 v[208:211], v[68:71], a[0:3], v[208:211]
ds_read_b64_tr_b16 v[52:53], v120 offset:160
v_mfma_f32_16x16x32_bf16 v[208:211], v[72:75], a[4:7], v[208:211]
ds_read_b64_tr_b16 v[54:55], v120 offset:416
ds_read_b64_tr_b16 v[56:57], v120 offset:672
v_mfma_f32_16x16x32_bf16 v[208:211], v[76:79], a[8:11], v[208:211]
buffer_load_dwordx4 a[76:79], v116, s[4:7], s88 offen offset:3072 sc1
v_mfma_f32_16x16x32_bf16 v[208:211], v[80:83], a[12:15], v[208:211]
ds_read_b64_tr_b16 v[58:59], v120 offset:928
ds_read_b64_tr_b16 v[60:61], v120 offset:17056
v_mfma_f32_16x16x32_bf16 v[212:215], v[80:83], a[28:31], v[212:215]
ds_read_b64_tr_b16 v[62:63], v120 offset:17312
v_mfma_f32_16x16x32_bf16 v[212:215], v[76:79], a[24:27], v[212:215]
ds_read_b64_tr_b16 v[64:65], v120 offset:17568
v_mfma_f32_16x16x32_bf16 v[212:215], v[72:75], a[20:23], v[212:215]
buffer_load_dwordx4 a[80:83], v117, s[4:7], s88 offen offset:0 sc1
v_mfma_f32_16x16x32_bf16 v[212:215], v[68:71], a[16:19], v[212:215]
s_waitcnt lgkmcnt(15)
ds_read_b64_tr_b16 v[66:67], v120 offset:17824
v_mfma_f32_16x16x32_bf16 v[220:223], v[84:87], a[16:19], v[220:223]
ds_read_b64_tr_b16 v[68:69], v120 offset:192
v_mfma_f32_16x16x32_bf16 v[220:223], v[88:91], a[20:23], v[220:223]
ds_read_b64_tr_b16 v[70:71], v120 offset:448
ds_read_b64_tr_b16 v[72:73], v120 offset:704
v_mfma_f32_16x16x32_bf16 v[220:223], v[92:95], a[24:27], v[220:223]
buffer_load_dwordx4 a[84:87], v117, s[4:7], s88 offen offset:1024 sc1
v_mfma_f32_16x16x32_bf16 v[220:223], v[96:99], a[28:31], v[220:223]
ds_read_b64_tr_b16 v[74:75], v120 offset:960
ds_read_b64_tr_b16 v[76:77], v120 offset:17088
v_mfma_f32_16x16x32_bf16 v[216:219], v[96:99], a[12:15], v[216:219]
ds_read_b64_tr_b16 v[78:79], v120 offset:17344
v_mfma_f32_16x16x32_bf16 v[216:219], v[92:95], a[8:11], v[216:219]
buffer_load_dwordx4 a[88:91], v117, s[4:7], s88 offen offset:2048 sc1
v_mfma_f32_16x16x32_bf16 v[216:219], v[88:91], a[4:7], v[216:219]
ds_read_b64_tr_b16 v[80:81], v120 offset:17600
v_mfma_f32_16x16x32_bf16 v[216:219], v[84:87], a[0:3], v[216:219]
s_waitcnt lgkmcnt(15)
ds_read_b64_tr_b16 v[82:83], v120 offset:17856
v_mfma_f32_16x16x32_bf16 v[224:227], v[36:39], a[0:3], v[224:227]
ds_read_b64_tr_b16 v[84:85], v120 offset:224
ds_read_b64_tr_b16 v[86:87], v120 offset:480
v_mfma_f32_16x16x32_bf16 v[224:227], v[40:43], a[4:7], v[224:227]
buffer_load_dwordx4 a[92:95], v117, s[4:7], s88 offen offset:3072 sc1
v_mfma_f32_16x16x32_bf16 v[224:227], v[44:47], a[8:11], v[224:227]
ds_read_b64_tr_b16 v[88:89], v120 offset:736
v_mfma_f32_16x16x32_bf16 v[224:227], v[48:51], a[12:15], v[224:227]
ds_read_b64_tr_b16 v[90:91], v120 offset:992
v_mfma_f32_16x16x32_bf16 v[228:231], v[48:51], a[28:31], v[228:231]
ds_read_b64_tr_b16 v[92:93], v120 offset:17120
v_mfma_f32_16x16x32_bf16 v[228:231], v[44:47], a[24:27], v[228:231]
s_waitcnt lgkmcnt(15)
ds_read_b64_tr_b16 v[94:95], v120 offset:17376
v_mfma_f32_16x16x32_bf16 v[228:231], v[40:43], a[20:23], v[228:231]
s_waitcnt vmcnt(24)
ds_read_b64_tr_b16 v[96:97], v120 offset:17632
v_mfma_f32_16x16x32_bf16 v[228:231], v[36:39], a[16:19], v[228:231]
s_barrier
ds_read_b64_tr_b16 v[98:99], v120 offset:17888
v_add_u32 v120, 0, v3
v_mfma_f32_16x16x32_bf16 v[236:239], v[52:55], a[16:19], v[236:239]
s_mov_b32 s89, 1835008
ds_read_b64_tr_b16 v[36:37], v120 offset:0
v_mfma_f32_16x16x32_bf16 v[236:239], v[56:59], a[20:23], v[236:239]
s_add_u32 m0, s90, 101376
ds_read_b64_tr_b16 v[38:39], v120 offset:256
ds_read_b64_tr_b16 v[40:41], v120 offset:512
v_mfma_f32_16x16x32_bf16 v[236:239], v[60:63], a[24:27], v[236:239]
s_waitcnt lgkmcnt(15)
buffer_load_dwordx4 v118, s[8:11], s89 offen offset:0  lds
v_mfma_f32_16x16x32_bf16 v[236:239], v[64:67], a[28:31], v[236:239]
s_add_u32 m0, s90, 101408
ds_read_b64_tr_b16 v[42:43], v120 offset:768
ds_read_b64_tr_b16 v[44:45], v120 offset:16896
v_mfma_f32_16x16x32_bf16 v[232:235], v[64:67], a[12:15], v[232:235]
buffer_load_dwordx4 v118, s[8:11], s89 offen offset:1024  lds
v_mfma_f32_16x16x32_bf16 v[232:235], v[60:63], a[8:11], v[232:235]
ds_read_b64_tr_b16 v[46:47], v120 offset:17152
v_mfma_f32_16x16x32_bf16 v[232:235], v[56:59], a[4:7], v[232:235]
ds_read_b64_tr_b16 v[48:49], v120 offset:17408
v_mfma_f32_16x16x32_bf16 v[232:235], v[52:55], a[0:3], v[232:235]
s_add_u32 m0, s90, 101440
ds_read_b64_tr_b16 v[50:51], v120 offset:17664
v_mfma_f32_16x16x32_bf16 v[240:243], v[68:71], a[0:3], v[240:243]
buffer_load_dwordx4 v118, s[8:11], s89 offen offset:2048  lds
v_mfma_f32_16x16x32_bf16 v[240:243], v[72:75], a[4:7], v[240:243]
s_waitcnt lgkmcnt(15)
ds_read_b64_tr_b16 v[52:53], v120 offset:32
ds_read_b64_tr_b16 v[54:55], v120 offset:288
v_mfma_f32_16x16x32_bf16 v[240:243], v[76:79], a[8:11], v[240:243]
ds_read_b64_tr_b16 v[56:57], v120 offset:544
v_mfma_f32_16x16x32_bf16 v[240:243], v[80:83], a[12:15], v[240:243]
s_add_u32 m0, s90, 101472
ds_read_b64_tr_b16 v[58:59], v120 offset:800
ds_read_b64_tr_b16 v[60:61], v120 offset:16928
v_mfma_f32_16x16x32_bf16 v[244:247], v[80:83], a[28:31], v[244:247]
buffer_load_dwordx4 v118, s[8:11], s89 offen offset:3072  lds
v_mfma_f32_16x16x32_bf16 v[244:247], v[76:79], a[24:27], v[244:247]
ds_read_b64_tr_b16 v[62:63], v120 offset:17184
ds_read_b64_tr_b16 v[64:65], v120 offset:17440
v_mfma_f32_16x16x32_bf16 v[244:247], v[72:75], a[20:23], v[244:247]
s_add_u32 m0, s90, 105600
ds_read_b64_tr_b16 v[66:67], v120 offset:17696
v_mfma_f32_16x16x32_bf16 v[244:247], v[68:71], a[16:19], v[244:247]
s_waitcnt lgkmcnt(15)
buffer_load_dwordx4 v119, s[8:11], s89 offen offset:0  lds
v_mfma_f32_16x16x32_bf16 v[252:255], v[84:87], a[16:19], v[252:255]
ds_read_b64_tr_b16 v[68:69], v120 offset:64
ds_read_b64_tr_b16 v[70:71], v120 offset:320
v_mfma_f32_16x16x32_bf16 v[252:255], v[88:91], a[20:23], v[252:255]
ds_read_b64_tr_b16 v[72:73], v120 offset:576
v_mfma_f32_16x16x32_bf16 v[252:255], v[92:95], a[24:27], v[252:255]
s_add_u32 m0, s90, 105632
ds_read_b64_tr_b16 v[74:75], v120 offset:832
v_mfma_f32_16x16x32_bf16 v[252:255], v[96:99], a[28:31], v[252:255]
buffer_load_dwordx4 v119, s[8:11], s89 offen offset:1024  lds
v_mfma_f32_16x16x32_bf16 v[248:251], v[96:99], a[12:15], v[248:251]
ds_read_b64_tr_b16 v[76:77], v120 offset:16960
v_mfma_f32_16x16x32_bf16 v[248:251], v[92:95], a[8:11], v[248:251]
ds_read_b64_tr_b16 v[78:79], v120 offset:17216
v_mfma_f32_16x16x32_bf16 v[248:251], v[88:91], a[4:7], v[248:251]
s_waitcnt vmcnt(22)
ds_read_b64_tr_b16 v[80:81], v120 offset:17472
v_mfma_f32_16x16x32_bf16 v[248:251], v[84:87], a[0:3], v[248:251]
s_waitcnt lgkmcnt(15)
ds_read_b64_tr_b16 v[82:83], v120 offset:17728
v_mfma_f32_16x16x32_bf16 v[192:195], v[36:39], a[32:35], v[192:195]
global_load_dwordx2 v[122:123], v121, s[80:81] sc1
v_mfma_f32_16x16x32_bf16 v[192:195], v[40:43], a[36:39], v[192:195]
s_add_u32 m0, s90, 105664
ds_read_b64_tr_b16 v[84:85], v120 offset:96
ds_read_b64_tr_b16 v[86:87], v120 offset:352
v_mfma_f32_16x16x32_bf16 v[192:195], v[44:47], a[40:43], v[192:195]
buffer_load_dwordx4 v119, s[8:11], s89 offen offset:2048  lds
v_mfma_f32_16x16x32_bf16 v[192:195], v[48:51], a[44:47], v[192:195]
s_add_u32 m0, s90, 105696
ds_read_b64_tr_b16 v[88:89], v120 offset:608
ds_read_b64_tr_b16 v[90:91], v120 offset:864
v_mfma_f32_16x16x32_bf16 v[196:199], v[48:51], a[60:63], v[196:199]
buffer_load_dwordx4 v119, s[8:11], s89 offen offset:3072  lds
v_mfma_f32_16x16x32_bf16 v[196:199], v[44:47], a[56:59], v[196:199]
ds_read_b64_tr_b16 v[92:93], v120 offset:16992
ds_read_b64_tr_b16 v[94:95], v120 offset:17248
v_mfma_f32_16x16x32_bf16 v[196:199], v[40:43], a[52:55], v[196:199]
s_waitcnt lgkmcnt(15)
ds_read_b64_tr_b16 v[96:97], v120 offset:17504
v_mfma_f32_16x16x32_bf16 v[196:199], v[36:39], a[48:51], v[196:199]
s_mov_b32 s88, 917504
ds_read_b64_tr_b16 v[98:99], v120 offset:17760
v_mfma_f32_16x16x32_bf16 v[204:207], v[52:55], a[48:51], v[204:207]
buffer_load_dwordx4 a[96:99], v116, s[4:7], s88 offen offset:0 sc1
v_mfma_f32_16x16x32_bf16 v[204:207], v[56:59], a[52:55], v[204:207]
ds_read_b64_tr_b16 v[36:37], v120 offset:128
ds_read_b64_tr_b16 v[38:39], v120 offset:384
v_mfma_f32_16x16x32_bf16 v[204:207], v[60:63], a[56:59], v[204:207]
s_waitcnt lgkmcnt(15)
ds_read_b64_tr_b16 v[40:41], v120 offset:640
v_mfma_f32_16x16x32_bf16 v[204:207], v[64:67], a[60:63], v[204:207]
ds_read_b64_tr_b16 v[42:43], v120 offset:896
ds_read_b64_tr_b16 v[44:45], v120 offset:17024
v_mfma_f32_16x16x32_bf16 v[200:203], v[64:67], a[44:47], v[200:203]
buffer_load_dwordx4 a[100:103], v116, s[4:7], s88 offen offset:1024 sc1
v_mfma_f32_16x16x32_bf16 v[200:203], v[60:63], a[40:43], v[200:203]
ds_read_b64_tr_b16 v[46:47], v120 offset:17280
ds_read_b64_tr_b16 v[48:49], v120 offset:17536
v_mfma_f32_16x16x32_bf16 v[200:203], v[56:59], a[36:39], v[200:203]
ds_read_b64_tr_b16 v[50:51], v120 offset:17792
v_mfma_f32_16x16x32_bf16 v[200:203], v[52:55], a[32:35], v[200:203]
buffer_load_dwordx4 a[104:107], v116, s[4:7], s88 offen offset:2048 sc1
v_mfma_f32_16x16x32_bf16 v[208:211], v[68:71], a[32:35], v[208:211]
s_waitcnt lgkmcnt(15)
ds_read_b64_tr_b16 v[52:53], v120 offset:160
ds_read_b64_tr_b16 v[54:55], v120 offset:416
v_mfma_f32_16x16x32_bf16 v[208:211], v[72:75], a[36:39], v[208:211]
ds_read_b64_tr_b16 v[56:57], v120 offset:672
v_mfma_f32_16x16x32_bf16 v[208:211], v[76:79], a[40:43], v[208:211]
ds_read_b64_tr_b16 v[58:59], v120 offset:928
ds_read_b64_tr_b16 v[60:61], v120 offset:17056
v_mfma_f32_16x16x32_bf16 v[208:211], v[80:83], a[44:47], v[208:211]
buffer_load_dwordx4 a[108:111], v116, s[4:7], s88 offen offset:3072 sc1
v_mfma_f32_16x16x32_bf16 v[212:215], v[80:83], a[60:63], v[212:215]
ds_read_b64_tr_b16 v[62:63], v120 offset:17312
v_mfma_f32_16x16x32_bf16 v[212:215], v[76:79], a[56:59], v[212:215]
ds_read_b64_tr_b16 v[64:65], v120 offset:17568
v_mfma_f32_16x16x32_bf16 v[212:215], v[72:75], a[52:55], v[212:215]
ds_read_b64_tr_b16 v[66:67], v120 offset:17824
v_mfma_f32_16x16x32_bf16 v[212:215], v[68:71], a[48:51], v[212:215]
s_waitcnt lgkmcnt(15)
buffer_load_dwordx4 a[112:115], v117, s[4:7], s88 offen offset:0 sc1
v_mfma_f32_16x16x32_bf16 v[220:223], v[84:87], a[48:51], v[220:223]
ds_read_b64_tr_b16 v[68:69], v120 offset:192
ds_read_b64_tr_b16 v[70:71], v120 offset:448
v_mfma_f32_16x16x32_bf16 v[220:223], v[88:91], a[52:55], v[220:223]
ds_read_b64_tr_b16 v[72:73], v120 offset:704
v_mfma_f32_16x16x32_bf16 v[220:223], v[92:95], a[56:59], v[220:223]
ds_read_b64_tr_b16 v[74:75], v120 offset:960
ds_read_b64_tr_b16 v[76:77], v120 offset:17088
v_mfma_f32_16x16x32_bf16 v[220:223], v[96:99], a[60:63], v[220:223]
buffer_load_dwordx4 a[116:119], v117, s[4:7], s88 offen offset:1024 sc1
v_mfma_f32_16x16x32_bf16 v[216:219], v[96:99], a[44:47], v[216:219]
ds_read_b64_tr_b16 v[78:79], v120 offset:17344
v_mfma_f32_16x16x32_bf16 v[216:219], v[92:95], a[40:43], v[216:219]
ds_read_b64_tr_b16 v[80:81], v120 offset:17600
v_mfma_f32_16x16x32_bf16 v[216:219], v[88:91], a[36:39], v[216:219]
ds_read_b64_tr_b16 v[82:83], v120 offset:17856
v_mfma_f32_16x16x32_bf16 v[216:219], v[84:87], a[32:35], v[216:219]
s_waitcnt lgkmcnt(15)
buffer_load_dwordx4 a[120:123], v117, s[4:7], s88 offen offset:2048 sc1
v_mfma_f32_16x16x32_bf16 v[224:227], v[36:39], a[32:35], v[224:227]
ds_read_b64_tr_b16 v[84:85], v120 offset:224
ds_read_b64_tr_b16 v[86:87], v120 offset:480
v_mfma_f32_16x16x32_bf16 v[224:227], v[40:43], a[36:39], v[224:227]
ds_read_b64_tr_b16 v[88:89], v120 offset:736
v_mfma_f32_16x16x32_bf16 v[224:227], v[44:47], a[40:43], v[224:227]
buffer_load_dwordx4 a[124:127], v117, s[4:7], s88 offen offset:3072 sc1
v_mfma_f32_16x16x32_bf16 v[224:227], v[48:51], a[44:47], v[224:227]
ds_read_b64_tr_b16 v[90:91], v120 offset:992
v_mfma_f32_16x16x32_bf16 v[228:231], v[48:51], a[60:63], v[228:231]
ds_read_b64_tr_b16 v[92:93], v120 offset:17120
v_mfma_f32_16x16x32_bf16 v[228:231], v[44:47], a[56:59], v[228:231]
s_waitcnt lgkmcnt(15)
ds_read_b64_tr_b16 v[94:95], v120 offset:17376
v_mfma_f32_16x16x32_bf16 v[228:231], v[40:43], a[52:55], v[228:231]
s_waitcnt vmcnt(25)
ds_read_b64_tr_b16 v[96:97], v120 offset:17632
v_mfma_f32_16x16x32_bf16 v[228:231], v[36:39], a[48:51], v[228:231]
s_barrier
ds_read_b64_tr_b16 v[98:99], v120 offset:17888
v_add_u32 v120, 4294933504, v3
v_mfma_f32_16x16x32_bf16 v[236:239], v[52:55], a[48:51], v[236:239]
s_mov_b32 s89, 131072
ds_read_b64_tr_b16 v[36:37], v120 offset:0
v_mfma_f32_16x16x32_bf16 v[236:239], v[56:59], a[52:55], v[236:239]
s_add_u32 m0, s90, 0
ds_read_b64_tr_b16 v[38:39], v120 offset:256
ds_read_b64_tr_b16 v[40:41], v120 offset:512
v_mfma_f32_16x16x32_bf16 v[236:239], v[60:63], a[56:59], v[236:239]
s_waitcnt lgkmcnt(15)
buffer_load_dwordx4 v118, s[8:11], s89 offen offset:0  lds
v_mfma_f32_16x16x32_bf16 v[236:239], v[64:67], a[60:63], v[236:239]
s_add_u32 m0, s90, 32
ds_read_b64_tr_b16 v[42:43], v120 offset:768
ds_read_b64_tr_b16 v[44:45], v120 offset:16896
v_mfma_f32_16x16x32_bf16 v[232:235], v[64:67], a[44:47], v[232:235]
buffer_load_dwordx4 v118, s[8:11], s89 offen offset:1024  lds
v_mfma_f32_16x16x32_bf16 v[232:235], v[60:63], a[40:43], v[232:235]
ds_read_b64_tr_b16 v[46:47], v120 offset:17152
v_mfma_f32_16x16x32_bf16 v[232:235], v[56:59], a[36:39], v[232:235]
ds_read_b64_tr_b16 v[48:49], v120 offset:17408
v_mfma_f32_16x16x32_bf16 v[232:235], v[52:55], a[32:35], v[232:235]
s_add_u32 m0, s90, 64
ds_read_b64_tr_b16 v[50:51], v120 offset:17664
v_mfma_f32_16x16x32_bf16 v[240:243], v[68:71], a[32:35], v[240:243]
buffer_load_dwordx4 v118, s[8:11], s89 offen offset:2048  lds
v_mfma_f32_16x16x32_bf16 v[240:243], v[72:75], a[36:39], v[240:243]
s_waitcnt lgkmcnt(15)
ds_read_b64_tr_b16 v[52:53], v120 offset:32
ds_read_b64_tr_b16 v[54:55], v120 offset:288
v_mfma_f32_16x16x32_bf16 v[240:243], v[76:79], a[40:43], v[240:243]
ds_read_b64_tr_b16 v[56:57], v120 offset:544
v_mfma_f32_16x16x32_bf16 v[240:243], v[80:83], a[44:47], v[240:243]
s_add_u32 m0, s90, 96
s_waitcnt vmcnt(13)
ds_read_b64_tr_b16 v[58:59], v120 offset:800
ds_read_b64_tr_b16 v[60:61], v120 offset:16928
v_readfirstlane_b32 s61, v122
v_mfma_f32_16x16x32_bf16 v[244:247], v[80:83], a[60:63], v[244:247]
buffer_load_dwordx4 v118, s[8:11], s89 offen offset:3072  lds
v_readfirstlane_b32 s62, v123
v_mfma_f32_16x16x32_bf16 v[244:247], v[76:79], a[56:59], v[244:247]
ds_read_b64_tr_b16 v[62:63], v120 offset:17184
ds_read_b64_tr_b16 v[64:65], v120 offset:17440
v_mfma_f32_16x16x32_bf16 v[244:247], v[72:75], a[52:55], v[244:247]
s_add_u32 m0, s90, 4224
s_and_b32 s63, s61, 0xffff
s_and_b32 s31, s62, 0xffff
ds_read_b64_tr_b16 v[66:67], v120 offset:17696
v_mfma_f32_16x16x32_bf16 v[244:247], v[68:71], a[48:51], v[244:247]
s_waitcnt lgkmcnt(15)
buffer_load_dwordx4 v119, s[8:11], s89 offen offset:0  lds
v_mfma_f32_16x16x32_bf16 v[252:255], v[84:87], a[48:51], v[252:255]
s_cmp_eq_u32 s93, 0
s_cselect_b32 s61, s61, s62
ds_read_b64_tr_b16 v[68:69], v120 offset:64
ds_read_b64_tr_b16 v[70:71], v120 offset:320
v_mfma_f32_16x16x32_bf16 v[252:255], v[88:91], a[52:55], v[252:255]
ds_read_b64_tr_b16 v[72:73], v120 offset:576
v_mfma_f32_16x16x32_bf16 v[252:255], v[92:95], a[56:59], v[252:255]
s_add_u32 m0, s90, 4256
s_lshr_b32 s61, s61, 16
s_min_u32 s63, s63, s31
ds_read_b64_tr_b16 v[74:75], v120 offset:832
ds_read_b64_tr_b16 v[76:77], v120 offset:16960
v_mfma_f32_16x16x32_bf16 v[252:255], v[96:99], a[60:63], v[252:255]
buffer_load_dwordx4 v119, s[8:11], s89 offen offset:1024  lds
v_mfma_f32_16x16x32_bf16 v[248:251], v[96:99], a[44:47], v[248:251]
s_min_u32 s61, s61, s63
ds_read_b64_tr_b16 v[78:79], v120 offset:17216
v_mfma_f32_16x16x32_bf16 v[248:251], v[92:95], a[40:43], v[248:251]
s_cmp_lt_u32 s61, 8
s_cbranch_scc1 SPIN2
SPIN2_RET:
ds_read_b64_tr_b16 v[80:81], v120 offset:17472
v_mfma_f32_16x16x32_bf16 v[248:251], v[88:91], a[36:39], v[248:251]
s_add_u32 m0, s90, 4288
s_waitcnt vmcnt(23)
ds_read_b64_tr_b16 v[82:83], v120 offset:17728
v_mfma_f32_16x16x32_bf16 v[248:251], v[84:87], a[32:35], v[248:251]
s_waitcnt lgkmcnt(15)
buffer_load_dwordx4 v119, s[8:11], s89 offen offset:2048  lds
v_mfma_f32_16x16x32_bf16 v[192:195], v[36:39], a[64:67], v[192:195]
ds_read_b64_tr_b16 v[84:85], v120 offset:96
ds_read_b64_tr_b16 v[86:87], v120 offset:352
v_mfma_f32_16x16x32_bf16 v[192:195], v[40:43], a[68:71], v[192:195]
ds_read_b64_tr_b16 v[88:89], v120 offset:608
v_mfma_f32_16x16x32_bf16 v[192:195], v[44:47], a[72:75], v[192:195]
s_add_u32 m0, s90, 4320
ds_read_b64_tr_b16 v[90:91], v120 offset:864
ds_read_b64_tr_b16 v[92:93], v120 offset:16992
v_mfma_f32_16x16x32_bf16 v[192:195], v[48:51], a[76:79], v[192:195]
buffer_load_dwordx4 v119, s[8:11], s89 offen offset:3072  lds
v_mfma_f32_16x16x32_bf16 v[196:199], v[48:51], a[92:95], v[196:199]
ds_read_b64_tr_b16 v[94:95], v120 offset:17248
v_mfma_f32_16x16x32_bf16 v[196:199], v[44:47], a[88:91], v[196:199]
ds_read_b64_tr_b16 v[96:97], v120 offset:17504
v_mfma_f32_16x16x32_bf16 v[196:199], v[40:43], a[84:87], v[196:199]
s_mov_b32 s88, 65536
ds_read_b64_tr_b16 v[98:99], v120 offset:17760
v_mfma_f32_16x16x32_bf16 v[196:199], v[36:39], a[80:83], v[196:199]
s_waitcnt lgkmcnt(15)
buffer_load_dwordx4 a[0:3], v116, s[4:7], s88 offen offset:0 sc1
v_mfma_f32_16x16x32_bf16 v[204:207], v[52:55], a[80:83], v[204:207]
ds_read_b64_tr_b16 v[36:37], v120 offset:128
ds_read_b64_tr_b16 v[38:39], v120 offset:384
v_mfma_f32_16x16x32_bf16 v[204:207], v[56:59], a[84:87], v[204:207]
ds_read_b64_tr_b16 v[40:41], v120 offset:640
ds_read_b64_tr_b16 v[42:43], v120 offset:896
v_mfma_f32_16x16x32_bf16 v[204:207], v[60:63], a[88:91], v[204:207]
buffer_load_dwordx4 a[4:7], v116, s[4:7], s88 offen offset:1024 sc1
v_mfma_f32_16x16x32_bf16 v[204:207], v[64:67], a[92:95], v[204:207]
ds_read_b64_tr_b16 v[44:45], v120 offset:17024
v_mfma_f32_16x16x32_bf16 v[200:203], v[64:67], a[76:79], v[200:203]
ds_read_b64_tr_b16 v[46:47], v120 offset:17280
v_mfma_f32_16x16x32_bf16 v[200:203], v[60:63], a[72:75], v[200:203]
ds_read_b64_tr_b16 v[48:49], v120 offset:17536
v_mfma_f32_16x16x32_bf16 v[200:203], v[56:59], a[68:71], v[200:203]
buffer_load_dwordx4 a[8:11], v116, s[4:7], s88 offen offset:2048 sc1
v_mfma_f32_16x16x32_bf16 v[200:203], v[52:55], a[64:67], v[200:203]
s_waitcnt lgkmcnt(15)
ds_read_b64_tr_b16 v[50:51], v120 offset:17792
v_mfma_f32_16x16x32_bf16 v[208:211], v[68:71], a[64:67], v[208:211]
ds_read_b64_tr_b16 v[52:53], v120 offset:160
v_mfma_f32_16x16x32_bf16 v[208:211], v[72:75], a[68:71], v[208:211]
ds_read_b64_tr_b16 v[54:55], v120 offset:416
ds_read_b64_tr_b16 v[56:57], v120 offset:672
v_mfma_f32_16x16x32_bf16 v[208:211], v[76:79], a[72:75], v[208:211]
buffer_load_dwordx4 a[12:15], v116, s[4:7], s88 offen offset:3072 sc1
v_mfma_f32_16x16x32_bf16 v[208:211], v[80:83], a[76:79], v[208:211]
ds_read_b64_tr_b16 v[58:59], v120 offset:928
ds_read_b64_tr_b16 v[60:61], v120 offset:17056
v_mfma_f32_16x16x32_bf16 v[212:215], v[80:83], a[92:95], v[212:215]
ds_read_b64_tr_b16 v[62:63], v120 offset:17312
v_mfma_f32_16x16x32_bf16 v[212:215], v[76:79], a[88:91], v[212:215]
ds_read_b64_tr_b16 v[64:65], v120 offset:17568
v_mfma_f32_16x16x32_bf16 v[212:215], v[72:75], a[84:87], v[212:215]
buffer_load_dwordx4 a[16:19], v117, s[4:7], s88 offen offset:0 sc1
v_mfma_f32_16x16x32_bf16 v[212:215], v[68:71], a[80:83], v[212:215]
s_waitcnt lgkmcnt(15)
ds_read_b64_tr_b16 v[66:67], v120 offset:17824
v_mfma_f32_16x16x32_bf16 v[220:223], v[84:87], a[80:83], v[220:223]
ds_read_b64_tr_b16 v[68:69], v120 offset:192
v_mfma_f32_16x16x32_bf16 v[220:223], v[88:91], a[84:87], v[220:223]
ds_read_b64_tr_b16 v[70:71], v120 offset:448
ds_read_b64_tr_b16 v[72:73], v120 offset:704
v_mfma_f32_16x16x32_bf16 v[220:223], v[92:95], a[88:91], v[220:223]
buffer_load_dwordx4 a[20:23], v117, s[4:7], s88 offen offset:1024 sc1
v_mfma_f32_16x16x32_bf16 v[220:223], v[96:99], a[92:95], v[220:223]
ds_read_b64_tr_b16 v[74:75], v120 offset:960
ds_read_b64_tr_b16 v[76:77], v120 offset:17088
v_mfma_f32_16x16x32_bf16 v[216:219], v[96:99], a[76:79], v[216:219]
ds_read_b64_tr_b16 v[78:79], v120 offset:17344
v_mfma_f32_16x16x32_bf16 v[216:219], v[92:95], a[72:75], v[216:219]
buffer_load_dwordx4 a[24:27], v117, s[4:7], s88 offen offset:2048 sc1
v_mfma_f32_16x16x32_bf16 v[216:219], v[88:91], a[68:71], v[216:219]
ds_read_b64_tr_b16 v[80:81], v120 offset:17600
v_mfma_f32_16x16x32_bf16 v[216:219], v[84:87], a[64:67], v[216:219]
s_waitcnt lgkmcnt(15)
ds_read_b64_tr_b16 v[82:83], v120 offset:17856
v_mfma_f32_16x16x32_bf16 v[224:227], v[36:39], a[64:67], v[224:227]
ds_read_b64_tr_b16 v[84:85], v120 offset:224
ds_read_b64_tr_b16 v[86:87], v120 offset:480
v_mfma_f32_16x16x32_bf16 v[224:227], v[40:43], a[68:71], v[224:227]
buffer_load_dwordx4 a[28:31], v117, s[4:7], s88 offen offset:3072 sc1
v_mfma_f32_16x16x32_bf16 v[224:227], v[44:47], a[72:75], v[224:227]
ds_read_b64_tr_b16 v[88:89], v120 offset:736
v_mfma_f32_16x16x32_bf16 v[224:227], v[48:51], a[76:79], v[224:227]
ds_read_b64_tr_b16 v[90:91], v120 offset:992
v_mfma_f32_16x16x32_bf16 v[228:231], v[48:51], a[92:95], v[228:231]
ds_read_b64_tr_b16 v[92:93], v120 offset:17120
v_mfma_f32_16x16x32_bf16 v[228:231], v[44:47], a[88:91], v[228:231]
s_waitcnt lgkmcnt(15)
ds_read_b64_tr_b16 v[94:95], v120 offset:17376
v_mfma_f32_16x16x32_bf16 v[228:231], v[40:43], a[84:87], v[228:231]
s_waitcnt vmcnt(24)
ds_read_b64_tr_b16 v[96:97], v120 offset:17632
v_mfma_f32_16x16x32_bf16 v[228:231], v[36:39], a[80:83], v[228:231]
s_barrier
ds_read_b64_tr_b16 v[98:99], v120 offset:17888
v_add_u32 v120, 33792, v3
v_mfma_f32_16x16x32_bf16 v[236:239], v[52:55], a[80:83], v[236:239]
s_mov_b32 s89, 393216
ds_read_b64_tr_b16 v[36:37], v120 offset:0
v_mfma_f32_16x16x32_bf16 v[236:239], v[56:59], a[84:87], v[236:239]
s_add_u32 m0, s90, 67584
ds_read_b64_tr_b16 v[38:39], v120 offset:256
ds_read_b64_tr_b16 v[40:41], v120 offset:512
v_mfma_f32_16x16x32_bf16 v[236:239], v[60:63], a[88:91], v[236:239]
s_waitcnt lgkmcnt(15)
buffer_load_dwordx4 v118, s[8:11], s89 offen offset:0  lds
v_mfma_f32_16x16x32_bf16 v[236:239], v[64:67], a[92:95], v[236:239]
s_add_u32 m0, s90, 67616
ds_read_b64_tr_b16 v[42:43], v120 offset:768
ds_read_b64_tr_b16 v[44:45], v120 offset:16896
v_mfma_f32_16x16x32_bf16 v[232:235], v[64:67], a[76:79], v[232:235]
buffer_load_dwordx4 v118, s[8:11], s89 offen offset:1024  lds
v_mfma_f32_16x16x32_bf16 v[232:235], v[60:63], a[72:75], v[232:235]
ds_read_b64_tr_b16 v[46:47], v120 offset:17152
v_mfma_f32_16x16x32_bf16 v[232:235], v[56:59], a[68:71], v[232:235]
ds_read_b64_tr_b16 v[48:49], v120 offset:17408
v_mfma_f32_16x16x32_bf16 v[232:235], v[52:55], a[64:67], v[232:235]
s_add_u32 m0, s90, 67648
ds_read_b64_tr_b16 v[50:51], v120 offset:17664
v_mfma_f32_16x16x32_bf16 v[240:243], v[68:71], a[64:67], v[240:243]
buffer_load_dwordx4 v118, s[8:11], s89 offen offset:2048  lds
v_mfma_f32_16x16x32_bf16 v[240:243], v[72:75], a[68:71], v[240:243]
s_waitcnt lgkmcnt(15)
ds_read_b64_tr_b16 v[52:53], v120 offset:32
ds_read_b64_tr_b16 v[54:55], v120 offset:288
v_mfma_f32_16x16x32_bf16 v[240:243], v[76:79], a[72:75], v[240:243]
ds_read_b64_tr_b16 v[56:57], v120 offset:544
v_mfma_f32_16x16x32_bf16 v[240:243], v[80:83], a[76:79], v[240:243]
s_add_u32 m0, s90, 67680
ds_read_b64_tr_b16 v[58:59], v120 offset:800
ds_read_b64_tr_b16 v[60:61], v120 offset:16928
v_mfma_f32_16x16x32_bf16 v[244:247], v[80:83], a[92:95], v[244:247]
buffer_load_dwordx4 v118, s[8:11], s89 offen offset:3072  lds
v_mfma_f32_16x16x32_bf16 v[244:247], v[76:79], a[88:91], v[244:247]
ds_read_b64_tr_b16 v[62:63], v120 offset:17184
ds_read_b64_tr_b16 v[64:65], v120 offset:17440
v_mfma_f32_16x16x32_bf16 v[244:247], v[72:75], a[84:87], v[244:247]
s_add_u32 m0, s90, 71808
ds_read_b64_tr_b16 v[66:67], v120 offset:17696
v_mfma_f32_16x16x32_bf16 v[244:247], v[68:71], a[80:83], v[244:247]
s_waitcnt lgkmcnt(15)
buffer_load_dwordx4 v119, s[8:11], s89 offen offset:0  lds
v_mfma_f32_16x16x32_bf16 v[252:255], v[84:87], a[80:83], v[252:255]
ds_read_b64_tr_b16 v[68:69], v120 offset:64
ds_read_b64_tr_b16 v[70:71], v120 offset:320
v_mfma_f32_16x16x32_bf16 v[252:255], v[88:91], a[84:87], v[252:255]
ds_read_b64_tr_b16 v[72:73], v120 offset:576
v_mfma_f32_16x16x32_bf16 v[252:255], v[92:95], a[88:91], v[252:255]
s_add_u32 m0, s90, 71840
ds_read_b64_tr_b16 v[74:75], v120 offset:832
ds_read_b64_tr_b16 v[76:77], v120 offset:16960
v_mfma_f32_16x16x32_bf16 v[252:255], v[96:99], a[92:95], v[252:255]
buffer_load_dwordx4 v119, s[8:11], s89 offen offset:1024  lds
v_mfma_f32_16x16x32_bf16 v[248:251], v[96:99], a[76:79], v[248:251]
ds_read_b64_tr_b16 v[78:79], v120 offset:17216
v_mfma_f32_16x16x32_bf16 v[248:251], v[92:95], a[72:75], v[248:251]
ds_read_b64_tr_b16 v[80:81], v120 offset:17472
v_mfma_f32_16x16x32_bf16 v[248:251], v[88:91], a[68:71], v[248:251]
s_add_u32 m0, s90, 71872
s_waitcnt vmcnt(22)
ds_read_b64_tr_b16 v[82:83], v120 offset:17728
v_mfma_f32_16x16x32_bf16 v[248:251], v[84:87], a[64:67], v[248:251]
s_waitcnt lgkmcnt(15)
buffer_load_dwordx4 v119, s[8:11], s89 offen offset:2048  lds
v_mfma_f32_16x16x32_bf16 v[192:195], v[36:39], a[96:99], v[192:195]
ds_read_b64_tr_b16 v[84:85], v120 offset:96
ds_read_b64_tr_b16 v[86:87], v120 offset:352
v_mfma_f32_16x16x32_bf16 v[192:195], v[40:43], a[100:103], v[192:195]
ds_read_b64_tr_b16 v[88:89], v120 offset:608
v_mfma_f32_16x16x32_bf16 v[192:195], v[44:47], a[104:107], v[192:195]
s_add_u32 m0, s90, 71904
ds_read_b64_tr_b16 v[90:91], v120 offset:864
ds_read_b64_tr_b16 v[92:93], v120 offset:16992
v_mfma_f32_16x16x32_bf16 v[192:195], v[48:51], a[108:111], v[192:195]
buffer_load_dwordx4 v119, s[8:11], s89 offen offset:3072  lds
v_mfma_f32_16x16x32_bf16 v[196:199], v[48:51], a[124:127], v[196:199]
ds_read_b64_tr_b16 v[94:95], v120 offset:17248
v_mfma_f32_16x16x32_bf16 v[196:199], v[44:47], a[120:123], v[196:199]
ds_read_b64_tr_b16 v[96:97], v120 offset:17504
v_mfma_f32_16x16x32_bf16 v[196:199], v[40:43], a[116:119], v[196:199]
s_mov_b32 s88, 196608
ds_read_b64_tr_b16 v[98:99], v120 offset:17760
v_mfma_f32_16x16x32_bf16 v[196:199], v[36:39], a[112:115], v[196:199]
s_waitcnt lgkmcnt(15)
buffer_load_dwordx4 a[32:35], v116, s[4:7], s88 offen offset:0 sc1
v_mfma_f32_16x16x32_bf16 v[204:207], v[52:55], a[112:115], v[204:207]
ds_read_b64_tr_b16 v[36:37], v120 offset:128
ds_read_b64_tr_b16 v[38:39], v120 offset:384
v_mfma_f32_16x16x32_bf16 v[204:207], v[56:59], a[116:119], v[204:207]
ds_read_b64_tr_b16 v[40:41], v120 offset:640
ds_read_b64_tr_b16 v[42:43], v120 offset:896
v_mfma_f32_16x16x32_bf16 v[204:207], v[60:63], a[120:123], v[204:207]
buffer_load_dwordx4 a[36:39], v116, s[4:7], s88 offen offset:1024 sc1
v_mfma_f32_16x16x32_bf16 v[204:207], v[64:67], a[124:127], v[204:207]
ds_read_b64_tr_b16 v[44:45], v120 offset:17024
v_mfma_f32_16x16x32_bf16 v[200:203], v[64:67], a[108:111], v[200:203]
ds_read_b64_tr_b16 v[46:47], v120 offset:17280
v_mfma_f32_16x16x32_bf16 v[200:203], v[60:63], a[104:107], v[200:203]
ds_read_b64_tr_b16 v[48:49], v120 offset:17536
v_mfma_f32_16x16x32_bf16 v[200:203], v[56:59], a[100:103], v[200:203]
buffer_load_dwordx4 a[40:43], v116, s[4:7], s88 offen offset:2048 sc1
v_mfma_f32_16x16x32_bf16 v[200:203], v[52:55], a[96:99], v[200:203]
s_waitcnt lgkmcnt(15)
ds_read_b64_tr_b16 v[50:51], v120 offset:17792
v_mfma_f32_16x16x32_bf16 v[208:211], v[68:71], a[96:99], v[208:211]
ds_read_b64_tr_b16 v[52:53], v120 offset:160
v_mfma_f32_16x16x32_bf16 v[208:211], v[72:75], a[100:103], v[208:211]
ds_read_b64_tr_b16 v[54:55], v120 offset:416
ds_read_b64_tr_b16 v[56:57], v120 offset:672
v_mfma_f32_16x16x32_bf16 v[208:211], v[76:79], a[104:107], v[208:211]
buffer_load_dwordx4 a[44:47], v116, s[4:7], s88 offen offset:3072 sc1
v_mfma_f32_16x16x32_bf16 v[208:211], v[80:83], a[108:111], v[208:211]
ds_read_b64_tr_b16 v[58:59], v120 offset:928
ds_read_b64_tr_b16 v[60:61], v120 offset:17056
v_mfma_f32_16x16x32_bf16 v[212:215], v[80:83], a[124:127], v[212:215]
ds_read_b64_tr_b16 v[62:63], v120 offset:17312
v_mfma_f32_16x16x32_bf16 v[212:215], v[76:79], a[120:123], v[212:215]
ds_read_b64_tr_b16 v[64:65], v120 offset:17568
v_mfma_f32_16x16x32_bf16 v[212:215], v[72:75], a[116:119], v[212:215]
buffer_load_dwordx4 a[48:51], v117, s[4:7], s88 offen offset:0 sc1
v_mfma_f32_16x16x32_bf16 v[212:215], v[68:71], a[112:115], v[212:215]
s_waitcnt lgkmcnt(15)
ds_read_b64_tr_b16 v[66:67], v120 offset:17824
v_mfma_f32_16x16x32_bf16 v[220:223], v[84:87], a[112:115], v[220:223]
ds_read_b64_tr_b16 v[68:69], v120 offset:192
v_mfma_f32_16x16x32_bf16 v[220:223], v[88:91], a[116:119], v[220:223]
ds_read_b64_tr_b16 v[70:71], v120 offset:448
ds_read_b64_tr_b16 v[72:73], v120 offset:704
v_mfma_f32_16x16x32_bf16 v[220:223], v[92:95], a[120:123], v[220:223]
buffer_load_dwordx4 a[52:55], v117, s[4:7], s88 offen offset:1024 sc1
v_mfma_f32_16x16x32_bf16 v[220:223], v[96:99], a[124:127], v[220:223]
ds_read_b64_tr_b16 v[74:75], v120 offset:960
ds_read_b64_tr_b16 v[76:77], v120 offset:17088
v_mfma_f32_16x16x32_bf16 v[216:219], v[96:99], a[108:111], v[216:219]
ds_read_b64_tr_b16 v[78:79], v120 offset:17344
v_mfma_f32_16x16x32_bf16 v[216:219], v[92:95], a[104:107], v[216:219]
buffer_load_dwordx4 a[56:59], v117, s[4:7], s88 offen offset:2048 sc1
v_mfma_f32_16x16x32_bf16 v[216:219], v[88:91], a[100:103], v[216:219]
ds_read_b64_tr_b16 v[80:81], v120 offset:17600
v_mfma_f32_16x16x32_bf16 v[216:219], v[84:87], a[96:99], v[216:219]
s_waitcnt lgkmcnt(15)
ds_read_b64_tr_b16 v[82:83], v120 offset:17856
v_mfma_f32_16x16x32_bf16 v[224:227], v[36:39], a[96:99], v[224:227]
ds_read_b64_tr_b16 v[84:85], v120 offset:224
ds_read_b64_tr_b16 v[86:87], v120 offset:480
v_mfma_f32_16x16x32_bf16 v[224:227], v[40:43], a[100:103], v[224:227]
buffer_load_dwordx4 a[60:63], v117, s[4:7], s88 offen offset:3072 sc1
v_mfma_f32_16x16x32_bf16 v[224:227], v[44:47], a[104:107], v[224:227]
ds_read_b64_tr_b16 v[88:89], v120 offset:736
v_mfma_f32_16x16x32_bf16 v[224:227], v[48:51], a[108:111], v[224:227]
ds_read_b64_tr_b16 v[90:91], v120 offset:992
v_mfma_f32_16x16x32_bf16 v[228:231], v[48:51], a[124:127], v[228:231]
ds_read_b64_tr_b16 v[92:93], v120 offset:17120
v_mfma_f32_16x16x32_bf16 v[228:231], v[44:47], a[120:123], v[228:231]
s_waitcnt lgkmcnt(15)
ds_read_b64_tr_b16 v[94:95], v120 offset:17376
v_mfma_f32_16x16x32_bf16 v[228:231], v[40:43], a[116:119], v[228:231]
s_waitcnt vmcnt(24)
ds_read_b64_tr_b16 v[96:97], v120 offset:17632
v_mfma_f32_16x16x32_bf16 v[228:231], v[36:39], a[112:115], v[228:231]
s_barrier
ds_read_b64_tr_b16 v[98:99], v120 offset:17888
v_add_u32 v120, 4294899712, v3
v_mfma_f32_16x16x32_bf16 v[236:239], v[52:55], a[112:115], v[236:239]
s_mov_b32 s89, 655360
ds_read_b64_tr_b16 v[36:37], v120 offset:0
v_mfma_f32_16x16x32_bf16 v[236:239], v[56:59], a[116:119], v[236:239]
s_add_u32 m0, s90, 33792
ds_read_b64_tr_b16 v[38:39], v120 offset:256
ds_read_b64_tr_b16 v[40:41], v120 offset:512
v_mfma_f32_16x16x32_bf16 v[236:239], v[60:63], a[120:123], v[236:239]
s_waitcnt lgkmcnt(15)
buffer_load_dwordx4 v118, s[8:11], s89 offen offset:0  lds
v_mfma_f32_16x16x32_bf16 v[236:239], v[64:67], a[124:127], v[236:239]
s_add_u32 m0, s90, 33824
ds_read_b64_tr_b16 v[42:43], v120 offset:768
ds_read_b64_tr_b16 v[44:45], v120 offset:16896
v_mfma_f32_16x16x32_bf16 v[232:235], v[64:67], a[108:111], v[232:235]
buffer_load_dwordx4 v118, s[8:11], s89 offen offset:1024  lds
v_mfma_f32_16x16x32_bf16 v[232:235], v[60:63], a[104:107], v[232:235]
ds_read_b64_tr_b16 v[46:47], v120 offset:17152
v_mfma_f32_16x16x32_bf16 v[232:235], v[56:59], a[100:103], v[232:235]
ds_read_b64_tr_b16 v[48:49], v120 offset:17408
v_mfma_f32_16x16x32_bf16 v[232:235], v[52:55], a[96:99], v[232:235]
s_add_u32 m0, s90, 33856
ds_read_b64_tr_b16 v[50:51], v120 offset:17664
v_mfma_f32_16x16x32_bf16 v[240:243], v[68:71], a[96:99], v[240:243]
buffer_load_dwordx4 v118, s[8:11], s89 offen offset:2048  lds
v_mfma_f32_16x16x32_bf16 v[240:243], v[72:75], a[100:103], v[240:243]
s_waitcnt lgkmcnt(15)
ds_read_b64_tr_b16 v[52:53], v120 offset:32
ds_read_b64_tr_b16 v[54:55], v120 offset:288
v_mfma_f32_16x16x32_bf16 v[240:243], v[76:79], a[104:107], v[240:243]
ds_read_b64_tr_b16 v[56:57], v120 offset:544
v_mfma_f32_16x16x32_bf16 v[240:243], v[80:83], a[108:111], v[240:243]
s_add_u32 m0, s90, 33888
ds_read_b64_tr_b16 v[58:59], v120 offset:800
ds_read_b64_tr_b16 v[60:61], v120 offset:16928
v_mfma_f32_16x16x32_bf16 v[244:247], v[80:83], a[124:127], v[244:247]
buffer_load_dwordx4 v118, s[8:11], s89 offen offset:3072  lds
v_mfma_f32_16x16x32_bf16 v[244:247], v[76:79], a[120:123], v[244:247]
ds_read_b64_tr_b16 v[62:63], v120 offset:17184
ds_read_b64_tr_b16 v[64:65], v120 offset:17440
v_mfma_f32_16x16x32_bf16 v[244:247], v[72:75], a[116:119], v[244:247]
s_add_u32 m0, s90, 38016
ds_read_b64_tr_b16 v[66:67], v120 offset:17696
v_mfma_f32_16x16x32_bf16 v[244:247], v[68:71], a[112:115], v[244:247]
s_waitcnt lgkmcnt(15)
buffer_load_dwordx4 v119, s[8:11], s89 offen offset:0  lds
v_mfma_f32_16x16x32_bf16 v[252:255], v[84:87], a[112:115], v[252:255]
ds_read_b64_tr_b16 v[68:69], v120 offset:64
ds_read_b64_tr_b16 v[70:71], v120 offset:320
v_mfma_f32_16x16x32_bf16 v[252:255], v[88:91], a[116:119], v[252:255]
ds_read_b64_tr_b16 v[72:73], v120 offset:576
v_mfma_f32_16x16x32_bf16 v[252:255], v[92:95], a[120:123], v[252:255]
s_add_u32 m0, s90, 38048
ds_read_b64_tr_b16 v[74:75], v120 offset:832
ds_read_b64_tr_b16 v[76:77], v120 offset:16960
v_mfma_f32_16x16x32_bf16 v[252:255], v[96:99], a[124:127], v[252:255]
buffer_load_dwordx4 v119, s[8:11], s89 offen offset:1024  lds
v_mfma_f32_16x16x32_bf16 v[248:251], v[96:99], a[108:111], v[248:251]
ds_read_b64_tr_b16 v[78:79], v120 offset:17216
v_mfma_f32_16x16x32_bf16 v[248:251], v[92:95], a[104:107], v[248:251]
ds_read_b64_tr_b16 v[80:81], v120 offset:17472
v_mfma_f32_16x16x32_bf16 v[248:251], v[88:91], a[100:103], v[248:251]
s_add_u32 m0, s90, 38080
s_waitcnt vmcnt(22)
ds_read_b64_tr_b16 v[82:83], v120 offset:17728
v_mfma_f32_16x16x32_bf16 v[248:251], v[84:87], a[96:99], v[248:251]
s_waitcnt lgkmcnt(15)
buffer_load_dwordx4 v119, s[8:11], s89 offen offset:2048  lds
v_mfma_f32_16x16x32_bf16 v[192:195], v[36:39], a[0:3], v[192:195]
ds_read_b64_tr_b16 v[84:85], v120 offset:96
ds_read_b64_tr_b16 v[86:87], v120 offset:352
v_mfma_f32_16x16x32_bf16 v[192:195], v[40:43], a[4:7], v[192:195]
ds_read_b64_tr_b16 v[88:89], v120 offset:608
v_mfma_f32_16x16x32_bf16 v[192:195], v[44:47], a[8:11], v[192:195]
s_add_u32 m0, s90, 38112
ds_read_b64_tr_b16 v[90:91], v120 offset:864
ds_read_b64_tr_b16 v[92:93], v120 offset:16992
v_mfma_f32_16x16x32_bf16 v[192:195], v[48:51], a[12:15], v[192:195]
buffer_load_dwordx4 v119, s[8:11], s89 offen offset:3072  lds
v_mfma_f32_16x16x32_bf16 v[196:199], v[48:51], a[28:31], v[196:199]
ds_read_b64_tr_b16 v[94:95], v120 offset:17248
v_mfma_f32_16x16x32_bf16 v[196:199], v[44:47], a[24:27], v[196:199]
ds_read_b64_tr_b16 v[96:97], v120 offset:17504
v_mfma_f32_16x16x32_bf16 v[196:199], v[40:43], a[20:23], v[196:199]
s_mov_b32 s88, 327680
ds_read_b64_tr_b16 v[98:99], v120 offset:17760
v_mfma_f32_16x16x32_bf16 v[196:199], v[36:39], a[16:19], v[196:199]
s_waitcnt lgkmcnt(15)
buffer_load_dwordx4 a[64:67], v116, s[4:7], s88 offen offset:0 sc1
v_mfma_f32_16x16x32_bf16 v[204:207], v[52:55], a[16:19], v[204:207]
ds_read_b64_tr_b16 v[36:37], v120 offset:128
ds_read_b64_tr_b16 v[38:39], v120 offset:384
v_mfma_f32_16x16x32_bf16 v[204:207], v[56:59], a[20:23], v[204:207]
ds_read_b64_tr_b16 v[40:41], v120 offset:640
ds_read_b64_tr_b16 v[42:43], v120 offset:896
v_mfma_f32_16x16x32_bf16 v[204:207], v[60:63], a[24:27], v[204:207]
buffer_load_dwordx4 a[68:71], v116, s[4:7], s88 offen offset:1024 sc1
v_mfma_f32_16x16x32_bf16 v[204:207], v[64:67], a[28:31], v[204:207]
ds_read_b64_tr_b16 v[44:45], v120 offset:17024
v_mfma_f32_16x16x32_bf16 v[200:203], v[64:67], a[12:15], v[200:203]
ds_read_b64_tr_b16 v[46:47], v120 offset:17280
v_mfma_f32_16x16x32_bf16 v[200:203], v[60:63], a[8:11], v[200:203]
ds_read_b64_tr_b16 v[48:49], v120 offset:17536
v_mfma_f32_16x16x32_bf16 v[200:203], v[56:59], a[4:7], v[200:203]
buffer_load_dwordx4 a[72:75], v116, s[4:7], s88 offen offset:2048 sc1
v_mfma_f32_16x16x32_bf16 v[200:203], v[52:55], a[0:3], v[200:203]
s_waitcnt lgkmcnt(15)
ds_read_b64_tr_b16 v[50:51], v120 offset:17792
v_mfma_f32_16x16x32_bf16 v[208:211], v[68:71], a[0:3], v[208:211]
ds_read_b64_tr_b16 v[52:53], v120 offset:160
v_mfma_f32_16x16x32_bf16 v[208:211], v[72:75], a[4:7], v[208:211]
ds_read_b64_tr_b16 v[54:55], v120 offset:416
ds_read_b64_tr_b16 v[56:57], v120 offset:672
v_mfma_f32_16x16x32_bf16 v[208:211], v[76:79], a[8:11], v[208:211]
buffer_load_dwordx4 a[76:79], v116, s[4:7], s88 offen offset:3072 sc1
v_mfma_f32_16x16x32_bf16 v[208:211], v[80:83], a[12:15], v[208:211]
ds_read_b64_tr_b16 v[58:59], v120 offset:928
ds_read_b64_tr_b16 v[60:61], v120 offset:17056
v_mfma_f32_16x16x32_bf16 v[212:215], v[80:83], a[28:31], v[212:215]
ds_read_b64_tr_b16 v[62:63], v120 offset:17312
v_mfma_f32_16x16x32_bf16 v[212:215], v[76:79], a[24:27], v[212:215]
ds_read_b64_tr_b16 v[64:65], v120 offset:17568
v_mfma_f32_16x16x32_bf16 v[212:215], v[72:75], a[20:23], v[212:215]
buffer_load_dwordx4 a[80:83], v117, s[4:7], s88 offen offset:0 sc1
v_mfma_f32_16x16x32_bf16 v[212:215], v[68:71], a[16:19], v[212:215]
s_waitcnt lgkmcnt(15)
ds_read_b64_tr_b16 v[66:67], v120 offset:17824
v_mfma_f32_16x16x32_bf16 v[220:223], v[84:87], a[16:19], v[220:223]
ds_read_b64_tr_b16 v[68:69], v120 offset:192
v_mfma_f32_16x16x32_bf16 v[220:223], v[88:91], a[20:23], v[220:223]
ds_read_b64_tr_b16 v[70:71], v120 offset:448
ds_read_b64_tr_b16 v[72:73], v120 offset:704
v_mfma_f32_16x16x32_bf16 v[220:223], v[92:95], a[24:27], v[220:223]
buffer_load_dwordx4 a[84:87], v117, s[4:7], s88 offen offset:1024 sc1
v_mfma_f32_16x16x32_bf16 v[220:223], v[96:99], a[28:31], v[220:223]
ds_read_b64_tr_b16 v[74:75], v120 offset:960
ds_read_b64_tr_b16 v[76:77], v120 offset:17088
v_mfma_f32_16x16x32_bf16 v[216:219], v[96:99], a[12:15], v[216:219]
ds_read_b64_tr_b16 v[78:79], v120 offset:17344
v_mfma_f32_16x16x32_bf16 v[216:219], v[92:95], a[8:11], v[216:219]
buffer_load_dwordx4 a[88:91], v117, s[4:7], s88 offen offset:2048 sc1
v_mfma_f32_16x16x32_bf16 v[216:219], v[88:91], a[4:7], v[216:219]
ds_read_b64_tr_b16 v[80:81], v120 offset:17600
v_mfma_f32_16x16x32_bf16 v[216:219], v[84:87], a[0:3], v[216:219]
s_waitcnt lgkmcnt(15)
ds_read_b64_tr_b16 v[82:83], v120 offset:17856
v_mfma_f32_16x16x32_bf16 v[224:227], v[36:39], a[0:3], v[224:227]
ds_read_b64_tr_b16 v[84:85], v120 offset:224
ds_read_b64_tr_b16 v[86:87], v120 offset:480
v_mfma_f32_16x16x32_bf16 v[224:227], v[40:43], a[4:7], v[224:227]
buffer_load_dwordx4 a[92:95], v117, s[4:7], s88 offen offset:3072 sc1
v_mfma_f32_16x16x32_bf16 v[224:227], v[44:47], a[8:11], v[224:227]
ds_read_b64_tr_b16 v[88:89], v120 offset:736
v_mfma_f32_16x16x32_bf16 v[224:227], v[48:51], a[12:15], v[224:227]
ds_read_b64_tr_b16 v[90:91], v120 offset:992
v_mfma_f32_16x16x32_bf16 v[228:231], v[48:51], a[28:31], v[228:231]
ds_read_b64_tr_b16 v[92:93], v120 offset:17120
v_mfma_f32_16x16x32_bf16 v[228:231], v[44:47], a[24:27], v[228:231]
s_waitcnt lgkmcnt(15)
ds_read_b64_tr_b16 v[94:95], v120 offset:17376
v_mfma_f32_16x16x32_bf16 v[228:231], v[40:43], a[20:23], v[228:231]
s_waitcnt vmcnt(24)
ds_read_b64_tr_b16 v[96:97], v120 offset:17632
v_mfma_f32_16x16x32_bf16 v[228:231], v[36:39], a[16:19], v[228:231]
s_barrier
ds_read_b64_tr_b16 v[98:99], v120 offset:17888
v_add_u32 v120, 0, v3
v_mfma_f32_16x16x32_bf16 v[236:239], v[52:55], a[16:19], v[236:239]
s_mov_b32 s89, 917504
ds_read_b64_tr_b16 v[36:37], v120 offset:0
v_mfma_f32_16x16x32_bf16 v[236:239], v[56:59], a[20:23], v[236:239]
s_add_u32 m0, s90, 101376
ds_read_b64_tr_b16 v[38:39], v120 offset:256
ds_read_b64_tr_b16 v[40:41], v120 offset:512
v_mfma_f32_16x16x32_bf16 v[236:239], v[60:63], a[24:27], v[236:239]
s_waitcnt lgkmcnt(15)
buffer_load_dwordx4 v118, s[8:11], s89 offen offset:0  lds
v_mfma_f32_16x16x32_bf16 v[236:239], v[64:67], a[28:31], v[236:239]
s_add_u32 m0, s90, 101408
ds_read_b64_tr_b16 v[42:43], v120 offset:768
ds_read_b64_tr_b16 v[44:45], v120 offset:16896
v_mfma_f32_16x16x32_bf16 v[232:235], v[64:67], a[12:15], v[232:235]
buffer_load_dwordx4 v118, s[8:11], s89 offen offset:1024  lds
v_mfma_f32_16x16x32_bf16 v[232:235], v[60:63], a[8:11], v[232:235]
ds_read_b64_tr_b16 v[46:47], v120 offset:17152
v_mfma_f32_16x16x32_bf16 v[232:235], v[56:59], a[4:7], v[232:235]
ds_read_b64_tr_b16 v[48:49], v120 offset:17408
v_mfma_f32_16x16x32_bf16 v[232:235], v[52:55], a[0:3], v[232:235]
s_add_u32 m0, s90, 101440
ds_read_b64_tr_b16 v[50:51], v120 offset:17664
v_mfma_f32_16x16x32_bf16 v[240:243], v[68:71], a[0:3], v[240:243]
buffer_load_dwordx4 v118, s[8:11], s89 offen offset:2048  lds
v_mfma_f32_16x16x32_bf16 v[240:243], v[72:75], a[4:7], v[240:243]
s_waitcnt lgkmcnt(15)
ds_read_b64_tr_b16 v[52:53], v120 offset:32
ds_read_b64_tr_b16 v[54:55], v120 offset:288
v_mfma_f32_16x16x32_bf16 v[240:243], v[76:79], a[8:11], v[240:243]
ds_read_b64_tr_b16 v[56:57], v120 offset:544
v_mfma_f32_16x16x32_bf16 v[240:243], v[80:83], a[12:15], v[240:243]
s_add_u32 m0, s90, 101472
ds_read_b64_tr_b16 v[58:59], v120 offset:800
ds_read_b64_tr_b16 v[60:61], v120 offset:16928
v_mfma_f32_16x16x32_bf16 v[244:247], v[80:83], a[28:31], v[244:247]
buffer_load_dwordx4 v118, s[8:11], s89 offen offset:3072  lds
v_mfma_f32_16x16x32_bf16 v[244:247], v[76:79], a[24:27], v[244:247]
ds_read_b64_tr_b16 v[62:63], v120 offset:17184
ds_read_b64_tr_b16 v[64:65], v120 offset:17440
v_mfma_f32_16x16x32_bf16 v[244:247], v[72:75], a[20:23], v[244:247]
s_add_u32 m0, s90, 105600
ds_read_b64_tr_b16 v[66:67], v120 offset:17696
v_mfma_f32_16x16x32_bf16 v[244:247], v[68:71], a[16:19], v[244:247]
s_waitcnt lgkmcnt(15)
buffer_load_dwordx4 v119, s[8:11], s89 offen offset:0  lds
v_mfma_f32_16x16x32_bf16 v[252:255], v[84:87], a[16:19], v[252:255]
ds_read_b64_tr_b16 v[68:69], v120 offset:64
ds_read_b64_tr_b16 v[70:71], v120 offset:320
v_mfma_f32_16x16x32_bf16 v[252:255], v[88:91], a[20:23], v[252:255]
ds_read_b64_tr_b16 v[72:73], v120 offset:576
v_mfma_f32_16x16x32_bf16 v[252:255], v[92:95], a[24:27], v[252:255]
s_add_u32 m0, s90, 105632
ds_read_b64_tr_b16 v[74:75], v120 offset:832
ds_read_b64_tr_b16 v[76:77], v120 offset:16960
v_mfma_f32_16x16x32_bf16 v[252:255], v[96:99], a[28:31], v[252:255]
buffer_load_dwordx4 v119, s[8:11], s89 offen offset:1024  lds
v_mfma_f32_16x16x32_bf16 v[248:251], v[96:99], a[12:15], v[248:251]
ds_read_b64_tr_b16 v[78:79], v120 offset:17216
v_mfma_f32_16x16x32_bf16 v[248:251], v[92:95], a[8:11], v[248:251]
ds_read_b64_tr_b16 v[80:81], v120 offset:17472
v_mfma_f32_16x16x32_bf16 v[248:251], v[88:91], a[4:7], v[248:251]
s_add_u32 m0, s90, 105664
s_waitcnt vmcnt(22)
ds_read_b64_tr_b16 v[82:83], v120 offset:17728
v_mfma_f32_16x16x32_bf16 v[248:251], v[84:87], a[0:3], v[248:251]
s_waitcnt lgkmcnt(15)
buffer_load_dwordx4 v119, s[8:11], s89 offen offset:2048  lds
v_mfma_f32_16x16x32_bf16 v[192:195], v[36:39], a[32:35], v[192:195]
ds_read_b64_tr_b16 v[84:85], v120 offset:96
ds_read_b64_tr_b16 v[86:87], v120 offset:352
v_mfma_f32_16x16x32_bf16 v[192:195], v[40:43], a[36:39], v[192:195]
ds_read_b64_tr_b16 v[88:89], v120 offset:608
v_mfma_f32_16x16x32_bf16 v[192:195], v[44:47], a[40:43], v[192:195]
s_add_u32 m0, s90, 105696
ds_read_b64_tr_b16 v[90:91], v120 offset:864
ds_read_b64_tr_b16 v[92:93], v120 offset:16992
v_mfma_f32_16x16x32_bf16 v[192:195], v[48:51], a[44:47], v[192:195]
buffer_load_dwordx4 v119, s[8:11], s89 offen offset:3072  lds
v_mfma_f32_16x16x32_bf16 v[196:199], v[48:51], a[60:63], v[196:199]
ds_read_b64_tr_b16 v[94:95], v120 offset:17248
v_mfma_f32_16x16x32_bf16 v[196:199], v[44:47], a[56:59], v[196:199]
ds_read_b64_tr_b16 v[96:97], v120 offset:17504
v_mfma_f32_16x16x32_bf16 v[196:199], v[40:43], a[52:55], v[196:199]
s_mov_b32 s88, 458752
ds_read_b64_tr_b16 v[98:99], v120 offset:17760
v_mfma_f32_16x16x32_bf16 v[196:199], v[36:39], a[48:51], v[196:199]
s_waitcnt lgkmcnt(15)
buffer_load_dwordx4 a[96:99], v116, s[4:7], s88 offen offset:0 sc1
v_mfma_f32_16x16x32_bf16 v[204:207], v[52:55], a[48:51], v[204:207]
ds_read_b64_tr_b16 v[36:37], v120 offset:128
ds_read_b64_tr_b16 v[38:39], v120 offset:384
v_mfma_f32_16x16x32_bf16 v[204:207], v[56:59], a[52:55], v[204:207]
ds_read_b64_tr_b16 v[40:41], v120 offset:640
ds_read_b64_tr_b16 v[42:43], v120 offset:896
v_mfma_f32_16x16x32_bf16 v[204:207], v[60:63], a[56:59], v[204:207]
buffer_load_dwordx4 a[100:103], v116, s[4:7], s88 offen offset:1024 sc1
v_mfma_f32_16x16x32_bf16 v[204:207], v[64:67], a[60:63], v[204:207]
ds_read_b64_tr_b16 v[44:45], v120 offset:17024
v_mfma_f32_16x16x32_bf16 v[200:203], v[64:67], a[44:47], v[200:203]
ds_read_b64_tr_b16 v[46:47], v120 offset:17280
v_mfma_f32_16x16x32_bf16 v[200:203], v[60:63], a[40:43], v[200:203]
ds_read_b64_tr_b16 v[48:49], v120 offset:17536
v_mfma_f32_16x16x32_bf16 v[200:203], v[56:59], a[36:39], v[200:203]
buffer_load_dwordx4 a[104:107], v116, s[4:7], s88 offen offset:2048 sc1
v_mfma_f32_16x16x32_bf16 v[200:203], v[52:55], a[32:35], v[200:203]
s_waitcnt lgkmcnt(15)
ds_read_b64_tr_b16 v[50:51], v120 offset:17792
v_mfma_f32_16x16x32_bf16 v[208:211], v[68:71], a[32:35], v[208:211]
ds_read_b64_tr_b16 v[52:53], v120 offset:160
v_mfma_f32_16x16x32_bf16 v[208:211], v[72:75], a[36:39], v[208:211]
ds_read_b64_tr_b16 v[54:55], v120 offset:416
ds_read_b64_tr_b16 v[56:57], v120 offset:672
v_mfma_f32_16x16x32_bf16 v[208:211], v[76:79], a[40:43], v[208:211]
buffer_load_dwordx4 a[108:111], v116, s[4:7], s88 offen offset:3072 sc1
v_mfma_f32_16x16x32_bf16 v[208:211], v[80:83], a[44:47], v[208:211]
ds_read_b64_tr_b16 v[58:59], v120 offset:928
ds_read_b64_tr_b16 v[60:61], v120 offset:17056
v_mfma_f32_16x16x32_bf16 v[212:215], v[80:83], a[60:63], v[212:215]
ds_read_b64_tr_b16 v[62:63], v120 offset:17312
v_mfma_f32_16x16x32_bf16 v[212:215], v[76:79], a[56:59], v[212:215]
ds_read_b64_tr_b16 v[64:65], v120 offset:17568
v_mfma_f32_16x16x32_bf16 v[212:215], v[72:75], a[52:55], v[212:215]
buffer_load_dwordx4 a[112:115], v117, s[4:7], s88 offen offset:0 sc1
v_mfma_f32_16x16x32_bf16 v[212:215], v[68:71], a[48:51], v[212:215]
s_waitcnt lgkmcnt(15)
ds_read_b64_tr_b16 v[66:67], v120 offset:17824
v_mfma_f32_16x16x32_bf16 v[220:223], v[84:87], a[48:51], v[220:223]
ds_read_b64_tr_b16 v[68:69], v120 offset:192
v_mfma_f32_16x16x32_bf16 v[220:223], v[88:91], a[52:55], v[220:223]
ds_read_b64_tr_b16 v[70:71], v120 offset:448
ds_read_b64_tr_b16 v[72:73], v120 offset:704
v_mfma_f32_16x16x32_bf16 v[220:223], v[92:95], a[56:59], v[220:223]
buffer_load_dwordx4 a[116:119], v117, s[4:7], s88 offen offset:1024 sc1
v_mfma_f32_16x16x32_bf16 v[220:223], v[96:99], a[60:63], v[220:223]
ds_read_b64_tr_b16 v[74:75], v120 offset:960
ds_read_b64_tr_b16 v[76:77], v120 offset:17088
v_mfma_f32_16x16x32_bf16 v[216:219], v[96:99], a[44:47], v[216:219]
ds_read_b64_tr_b16 v[78:79], v120 offset:17344
v_mfma_f32_16x16x32_bf16 v[216:219], v[92:95], a[40:43], v[216:219]
buffer_load_dwordx4 a[120:123], v117, s[4:7], s88 offen offset:2048 sc1
v_mfma_f32_16x16x32_bf16 v[216:219], v[88:91], a[36:39], v[216:219]
ds_read_b64_tr_b16 v[80:81], v120 offset:17600
v_mfma_f32_16x16x32_bf16 v[216:219], v[84:87], a[32:35], v[216:219]
s_waitcnt lgkmcnt(15)
ds_read_b64_tr_b16 v[82:83], v120 offset:17856
v_mfma_f32_16x16x32_bf16 v[224:227], v[36:39], a[32:35], v[224:227]
ds_read_b64_tr_b16 v[84:85], v120 offset:224
ds_read_b64_tr_b16 v[86:87], v120 offset:480
v_mfma_f32_16x16x32_bf16 v[224:227], v[40:43], a[36:39], v[224:227]
buffer_load_dwordx4 a[124:127], v117, s[4:7], s88 offen offset:3072 sc1
v_mfma_f32_16x16x32_bf16 v[224:227], v[44:47], a[40:43], v[224:227]
ds_read_b64_tr_b16 v[88:89], v120 offset:736
v_mfma_f32_16x16x32_bf16 v[224:227], v[48:51], a[44:47], v[224:227]
ds_read_b64_tr_b16 v[90:91], v120 offset:992
v_mfma_f32_16x16x32_bf16 v[228:231], v[48:51], a[60:63], v[228:231]
ds_read_b64_tr_b16 v[92:93], v120 offset:17120
v_mfma_f32_16x16x32_bf16 v[228:231], v[44:47], a[56:59], v[228:231]
s_waitcnt lgkmcnt(15)
ds_read_b64_tr_b16 v[94:95], v120 offset:17376
v_mfma_f32_16x16x32_bf16 v[228:231], v[40:43], a[52:55], v[228:231]
s_waitcnt vmcnt(24)
ds_read_b64_tr_b16 v[96:97], v120 offset:17632
v_mfma_f32_16x16x32_bf16 v[228:231], v[36:39], a[48:51], v[228:231]
s_barrier
ds_read_b64_tr_b16 v[98:99], v120 offset:17888
v_add_u32 v120, 4294933504, v3
v_mfma_f32_16x16x32_bf16 v[236:239], v[52:55], a[48:51], v[236:239]
s_mov_b32 s89, 1179648
ds_read_b64_tr_b16 v[36:37], v120 offset:0
v_mfma_f32_16x16x32_bf16 v[236:239], v[56:59], a[52:55], v[236:239]
s_add_u32 m0, s90, 0
ds_read_b64_tr_b16 v[38:39], v120 offset:256
ds_read_b64_tr_b16 v[40:41], v120 offset:512
v_mfma_f32_16x16x32_bf16 v[236:239], v[60:63], a[56:59], v[236:239]
s_waitcnt lgkmcnt(15)
buffer_load_dwordx4 v118, s[8:11], s89 offen offset:0  lds
v_mfma_f32_16x16x32_bf16 v[236:239], v[64:67], a[60:63], v[236:239]
s_add_u32 m0, s90, 32
ds_read_b64_tr_b16 v[42:43], v120 offset:768
ds_read_b64_tr_b16 v[44:45], v120 offset:16896
v_mfma_f32_16x16x32_bf16 v[232:235], v[64:67], a[44:47], v[232:235]
buffer_load_dwordx4 v118, s[8:11], s89 offen offset:1024  lds
v_mfma_f32_16x16x32_bf16 v[232:235], v[60:63], a[40:43], v[232:235]
ds_read_b64_tr_b16 v[46:47], v120 offset:17152
v_mfma_f32_16x16x32_bf16 v[232:235], v[56:59], a[36:39], v[232:235]
ds_read_b64_tr_b16 v[48:49], v120 offset:17408
v_mfma_f32_16x16x32_bf16 v[232:235], v[52:55], a[32:35], v[232:235]
s_add_u32 m0, s90, 64
ds_read_b64_tr_b16 v[50:51], v120 offset:17664
v_mfma_f32_16x16x32_bf16 v[240:243], v[68:71], a[32:35], v[240:243]
buffer_load_dwordx4 v118, s[8:11], s89 offen offset:2048  lds
v_mfma_f32_16x16x32_bf16 v[240:243], v[72:75], a[36:39], v[240:243]
s_waitcnt lgkmcnt(15)
ds_read_b64_tr_b16 v[52:53], v120 offset:32
ds_read_b64_tr_b16 v[54:55], v120 offset:288
v_mfma_f32_16x16x32_bf16 v[240:243], v[76:79], a[40:43], v[240:243]
ds_read_b64_tr_b16 v[56:57], v120 offset:544
v_mfma_f32_16x16x32_bf16 v[240:243], v[80:83], a[44:47], v[240:243]
s_add_u32 m0, s90, 96
ds_read_b64_tr_b16 v[58:59], v120 offset:800
ds_read_b64_tr_b16 v[60:61], v120 offset:16928
v_mfma_f32_16x16x32_bf16 v[244:247], v[80:83], a[60:63], v[244:247]
buffer_load_dwordx4 v118, s[8:11], s89 offen offset:3072  lds
v_mfma_f32_16x16x32_bf16 v[244:247], v[76:79], a[56:59], v[244:247]
ds_read_b64_tr_b16 v[62:63], v120 offset:17184
ds_read_b64_tr_b16 v[64:65], v120 offset:17440
v_mfma_f32_16x16x32_bf16 v[244:247], v[72:75], a[52:55], v[244:247]
s_add_u32 m0, s90, 4224
ds_read_b64_tr_b16 v[66:67], v120 offset:17696
v_mfma_f32_16x16x32_bf16 v[244:247], v[68:71], a[48:51], v[244:247]
s_waitcnt lgkmcnt(15)
buffer_load_dwordx4 v119, s[8:11], s89 offen offset:0  lds
v_mfma_f32_16x16x32_bf16 v[252:255], v[84:87], a[48:51], v[252:255]
ds_read_b64_tr_b16 v[68:69], v120 offset:64
ds_read_b64_tr_b16 v[70:71], v120 offset:320
v_mfma_f32_16x16x32_bf16 v[252:255], v[88:91], a[52:55], v[252:255]
ds_read_b64_tr_b16 v[72:73], v120 offset:576
v_mfma_f32_16x16x32_bf16 v[252:255], v[92:95], a[56:59], v[252:255]
s_add_u32 m0, s90, 4256
ds_read_b64_tr_b16 v[74:75], v120 offset:832
ds_read_b64_tr_b16 v[76:77], v120 offset:16960
v_mfma_f32_16x16x32_bf16 v[252:255], v[96:99], a[60:63], v[252:255]
buffer_load_dwordx4 v119, s[8:11], s89 offen offset:1024  lds
v_mfma_f32_16x16x32_bf16 v[248:251], v[96:99], a[44:47], v[248:251]
ds_read_b64_tr_b16 v[78:79], v120 offset:17216
v_mfma_f32_16x16x32_bf16 v[248:251], v[92:95], a[40:43], v[248:251]
ds_read_b64_tr_b16 v[80:81], v120 offset:17472
v_mfma_f32_16x16x32_bf16 v[248:251], v[88:91], a[36:39], v[248:251]
s_add_u32 m0, s90, 4288
s_waitcnt vmcnt(22)
ds_read_b64_tr_b16 v[82:83], v120 offset:17728
v_mfma_f32_16x16x32_bf16 v[248:251], v[84:87], a[32:35], v[248:251]
s_waitcnt lgkmcnt(15)
buffer_load_dwordx4 v119, s[8:11], s89 offen offset:2048  lds
v_mfma_f32_16x16x32_bf16 v[192:195], v[36:39], a[64:67], v[192:195]
ds_read_b64_tr_b16 v[84:85], v120 offset:96
ds_read_b64_tr_b16 v[86:87], v120 offset:352
v_mfma_f32_16x16x32_bf16 v[192:195], v[40:43], a[68:71], v[192:195]
ds_read_b64_tr_b16 v[88:89], v120 offset:608
v_mfma_f32_16x16x32_bf16 v[192:195], v[44:47], a[72:75], v[192:195]
s_add_u32 m0, s90, 4320
ds_read_b64_tr_b16 v[90:91], v120 offset:864
ds_read_b64_tr_b16 v[92:93], v120 offset:16992
v_mfma_f32_16x16x32_bf16 v[192:195], v[48:51], a[76:79], v[192:195]
buffer_load_dwordx4 v119, s[8:11], s89 offen offset:3072  lds
v_mfma_f32_16x16x32_bf16 v[196:199], v[48:51], a[92:95], v[196:199]
ds_read_b64_tr_b16 v[94:95], v120 offset:17248
v_mfma_f32_16x16x32_bf16 v[196:199], v[44:47], a[88:91], v[196:199]
ds_read_b64_tr_b16 v[96:97], v120 offset:17504
v_mfma_f32_16x16x32_bf16 v[196:199], v[40:43], a[84:87], v[196:199]
s_mov_b32 s88, 589824
ds_read_b64_tr_b16 v[98:99], v120 offset:17760
v_mfma_f32_16x16x32_bf16 v[196:199], v[36:39], a[80:83], v[196:199]
s_waitcnt lgkmcnt(15)
buffer_load_dwordx4 a[0:3], v116, s[4:7], s88 offen offset:0 sc1
v_mfma_f32_16x16x32_bf16 v[204:207], v[52:55], a[80:83], v[204:207]
ds_read_b64_tr_b16 v[36:37], v120 offset:128
ds_read_b64_tr_b16 v[38:39], v120 offset:384
v_mfma_f32_16x16x32_bf16 v[204:207], v[56:59], a[84:87], v[204:207]
ds_read_b64_tr_b16 v[40:41], v120 offset:640
ds_read_b64_tr_b16 v[42:43], v120 offset:896
v_mfma_f32_16x16x32_bf16 v[204:207], v[60:63], a[88:91], v[204:207]
buffer_load_dwordx4 a[4:7], v116, s[4:7], s88 offen offset:1024 sc1
v_mfma_f32_16x16x32_bf16 v[204:207], v[64:67], a[92:95], v[204:207]
ds_read_b64_tr_b16 v[44:45], v120 offset:17024
v_mfma_f32_16x16x32_bf16 v[200:203], v[64:67], a[76:79], v[200:203]
ds_read_b64_tr_b16 v[46:47], v120 offset:17280
v_mfma_f32_16x16x32_bf16 v[200:203], v[60:63], a[72:75], v[200:203]
ds_read_b64_tr_b16 v[48:49], v120 offset:17536
v_mfma_f32_16x16x32_bf16 v[200:203], v[56:59], a[68:71], v[200:203]
buffer_load_dwordx4 a[8:11], v116, s[4:7], s88 offen offset:2048 sc1
v_mfma_f32_16x16x32_bf16 v[200:203], v[52:55], a[64:67], v[200:203]
s_waitcnt lgkmcnt(15)
ds_read_b64_tr_b16 v[50:51], v120 offset:17792
v_mfma_f32_16x16x32_bf16 v[208:211], v[68:71], a[64:67], v[208:211]
ds_read_b64_tr_b16 v[52:53], v120 offset:160
v_mfma_f32_16x16x32_bf16 v[208:211], v[72:75], a[68:71], v[208:211]
ds_read_b64_tr_b16 v[54:55], v120 offset:416
ds_read_b64_tr_b16 v[56:57], v120 offset:672
v_mfma_f32_16x16x32_bf16 v[208:211], v[76:79], a[72:75], v[208:211]
buffer_load_dwordx4 a[12:15], v116, s[4:7], s88 offen offset:3072 sc1
v_mfma_f32_16x16x32_bf16 v[208:211], v[80:83], a[76:79], v[208:211]
ds_read_b64_tr_b16 v[58:59], v120 offset:928
ds_read_b64_tr_b16 v[60:61], v120 offset:17056
v_mfma_f32_16x16x32_bf16 v[212:215], v[80:83], a[92:95], v[212:215]
ds_read_b64_tr_b16 v[62:63], v120 offset:17312
v_mfma_f32_16x16x32_bf16 v[212:215], v[76:79], a[88:91], v[212:215]
ds_read_b64_tr_b16 v[64:65], v120 offset:17568
v_mfma_f32_16x16x32_bf16 v[212:215], v[72:75], a[84:87], v[212:215]
buffer_load_dwordx4 a[16:19], v117, s[4:7], s88 offen offset:0 sc1
v_mfma_f32_16x16x32_bf16 v[212:215], v[68:71], a[80:83], v[212:215]
s_waitcnt lgkmcnt(15)
ds_read_b64_tr_b16 v[66:67], v120 offset:17824
v_mfma_f32_16x16x32_bf16 v[220:223], v[84:87], a[80:83], v[220:223]
ds_read_b64_tr_b16 v[68:69], v120 offset:192
v_mfma_f32_16x16x32_bf16 v[220:223], v[88:91], a[84:87], v[220:223]
ds_read_b64_tr_b16 v[70:71], v120 offset:448
ds_read_b64_tr_b16 v[72:73], v120 offset:704
v_mfma_f32_16x16x32_bf16 v[220:223], v[92:95], a[88:91], v[220:223]
buffer_load_dwordx4 a[20:23], v117, s[4:7], s88 offen offset:1024 sc1
v_mfma_f32_16x16x32_bf16 v[220:223], v[96:99], a[92:95], v[220:223]
ds_read_b64_tr_b16 v[74:75], v120 offset:960
ds_read_b64_tr_b16 v[76:77], v120 offset:17088
v_mfma_f32_16x16x32_bf16 v[216:219], v[96:99], a[76:79], v[216:219]
ds_read_b64_tr_b16 v[78:79], v120 offset:17344
v_mfma_f32_16x16x32_bf16 v[216:219], v[92:95], a[72:75], v[216:219]
buffer_load_dwordx4 a[24:27], v117, s[4:7], s88 offen offset:2048 sc1
v_mfma_f32_16x16x32_bf16 v[216:219], v[88:91], a[68:71], v[216:219]
ds_read_b64_tr_b16 v[80:81], v120 offset:17600
v_mfma_f32_16x16x32_bf16 v[216:219], v[84:87], a[64:67], v[216:219]
s_waitcnt lgkmcnt(15)
ds_read_b64_tr_b16 v[82:83], v120 offset:17856
v_mfma_f32_16x16x32_bf16 v[224:227], v[36:39], a[64:67], v[224:227]
ds_read_b64_tr_b16 v[84:85], v120 offset:224
ds_read_b64_tr_b16 v[86:87], v120 offset:480
v_mfma_f32_16x16x32_bf16 v[224:227], v[40:43], a[68:71], v[224:227]
buffer_load_dwordx4 a[28:31], v117, s[4:7], s88 offen offset:3072 sc1
v_mfma_f32_16x16x32_bf16 v[224:227], v[44:47], a[72:75], v[224:227]
ds_read_b64_tr_b16 v[88:89], v120 offset:736
v_mfma_f32_16x16x32_bf16 v[224:227], v[48:51], a[76:79], v[224:227]
ds_read_b64_tr_b16 v[90:91], v120 offset:992
v_mfma_f32_16x16x32_bf16 v[228:231], v[48:51], a[92:95], v[228:231]
ds_read_b64_tr_b16 v[92:93], v120 offset:17120
v_mfma_f32_16x16x32_bf16 v[228:231], v[44:47], a[88:91], v[228:231]
s_waitcnt lgkmcnt(15)
ds_read_b64_tr_b16 v[94:95], v120 offset:17376
v_mfma_f32_16x16x32_bf16 v[228:231], v[40:43], a[84:87], v[228:231]
s_waitcnt vmcnt(24)
ds_read_b64_tr_b16 v[96:97], v120 offset:17632
v_mfma_f32_16x16x32_bf16 v[228:231], v[36:39], a[80:83], v[228:231]
s_barrier
ds_read_b64_tr_b16 v[98:99], v120 offset:17888
v_add_u32 v120, 33792, v3
v_mfma_f32_16x16x32_bf16 v[236:239], v[52:55], a[80:83], v[236:239]
s_mov_b32 s89, 1441792
ds_read_b64_tr_b16 v[36:37], v120 offset:0
v_mfma_f32_16x16x32_bf16 v[236:239], v[56:59], a[84:87], v[236:239]
s_add_u32 m0, s90, 67584
ds_read_b64_tr_b16 v[38:39], v120 offset:256
ds_read_b64_tr_b16 v[40:41], v120 offset:512
v_mfma_f32_16x16x32_bf16 v[236:239], v[60:63], a[88:91], v[236:239]
s_waitcnt lgkmcnt(15)
buffer_load_dwordx4 v118, s[8:11], s89 offen offset:0  lds
v_mfma_f32_16x16x32_bf16 v[236:239], v[64:67], a[92:95], v[236:239]
s_add_u32 m0, s90, 67616
ds_read_b64_tr_b16 v[42:43], v120 offset:768
ds_read_b64_tr_b16 v[44:45], v120 offset:16896
v_mfma_f32_16x16x32_bf16 v[232:235], v[64:67], a[76:79], v[232:235]
buffer_load_dwordx4 v118, s[8:11], s89 offen offset:1024  lds
v_mfma_f32_16x16x32_bf16 v[232:235], v[60:63], a[72:75], v[232:235]
ds_read_b64_tr_b16 v[46:47], v120 offset:17152
v_mfma_f32_16x16x32_bf16 v[232:235], v[56:59], a[68:71], v[232:235]
ds_read_b64_tr_b16 v[48:49], v120 offset:17408
v_mfma_f32_16x16x32_bf16 v[232:235], v[52:55], a[64:67], v[232:235]
s_add_u32 m0, s90, 67648
ds_read_b64_tr_b16 v[50:51], v120 offset:17664
v_mfma_f32_16x16x32_bf16 v[240:243], v[68:71], a[64:67], v[240:243]
buffer_load_dwordx4 v118, s[8:11], s89 offen offset:2048  lds
v_mfma_f32_16x16x32_bf16 v[240:243], v[72:75], a[68:71], v[240:243]
s_waitcnt lgkmcnt(15)
ds_read_b64_tr_b16 v[52:53], v120 offset:32
ds_read_b64_tr_b16 v[54:55], v120 offset:288
v_mfma_f32_16x16x32_bf16 v[240:243], v[76:79], a[72:75], v[240:243]
ds_read_b64_tr_b16 v[56:57], v120 offset:544
v_mfma_f32_16x16x32_bf16 v[240:243], v[80:83], a[76:79], v[240:243]
s_add_u32 m0, s90, 67680
ds_read_b64_tr_b16 v[58:59], v120 offset:800
ds_read_b64_tr_b16 v[60:61], v120 offset:16928
v_mfma_f32_16x16x32_bf16 v[244:247], v[80:83], a[92:95], v[244:247]
buffer_load_dwordx4 v118, s[8:11], s89 offen offset:3072  lds
v_mfma_f32_16x16x32_bf16 v[244:247], v[76:79], a[88:91], v[244:247]
ds_read_b64_tr_b16 v[62:63], v120 offset:17184
ds_read_b64_tr_b16 v[64:65], v120 offset:17440
v_mfma_f32_16x16x32_bf16 v[244:247], v[72:75], a[84:87], v[244:247]
s_add_u32 m0, s90, 71808
ds_read_b64_tr_b16 v[66:67], v120 offset:17696
v_mfma_f32_16x16x32_bf16 v[244:247], v[68:71], a[80:83], v[244:247]
s_waitcnt lgkmcnt(15)
buffer_load_dwordx4 v119, s[8:11], s89 offen offset:0  lds
v_mfma_f32_16x16x32_bf16 v[252:255], v[84:87], a[80:83], v[252:255]
ds_read_b64_tr_b16 v[68:69], v120 offset:64
ds_read_b64_tr_b16 v[70:71], v120 offset:320
v_mfma_f32_16x16x32_bf16 v[252:255], v[88:91], a[84:87], v[252:255]
ds_read_b64_tr_b16 v[72:73], v120 offset:576
v_mfma_f32_16x16x32_bf16 v[252:255], v[92:95], a[88:91], v[252:255]
s_add_u32 m0, s90, 71840
ds_read_b64_tr_b16 v[74:75], v120 offset:832
ds_read_b64_tr_b16 v[76:77], v120 offset:16960
v_mfma_f32_16x16x32_bf16 v[252:255], v[96:99], a[92:95], v[252:255]
buffer_load_dwordx4 v119, s[8:11], s89 offen offset:1024  lds
v_mfma_f32_16x16x32_bf16 v[248:251], v[96:99], a[76:79], v[248:251]
ds_read_b64_tr_b16 v[78:79], v120 offset:17216
v_mfma_f32_16x16x32_bf16 v[248:251], v[92:95], a[72:75], v[248:251]
ds_read_b64_tr_b16 v[80:81], v120 offset:17472
v_mfma_f32_16x16x32_bf16 v[248:251], v[88:91], a[68:71], v[248:251]
s_add_u32 m0, s90, 71872
s_waitcnt vmcnt(22)
ds_read_b64_tr_b16 v[82:83], v120 offset:17728
v_mfma_f32_16x16x32_bf16 v[248:251], v[84:87], a[64:67], v[248:251]
s_waitcnt lgkmcnt(15)
buffer_load_dwordx4 v119, s[8:11], s89 offen offset:2048  lds
v_mfma_f32_16x16x32_bf16 v[192:195], v[36:39], a[96:99], v[192:195]
ds_read_b64_tr_b16 v[84:85], v120 offset:96
ds_read_b64_tr_b16 v[86:87], v120 offset:352
v_mfma_f32_16x16x32_bf16 v[192:195], v[40:43], a[100:103], v[192:195]
ds_read_b64_tr_b16 v[88:89], v120 offset:608
v_mfma_f32_16x16x32_bf16 v[192:195], v[44:47], a[104:107], v[192:195]
s_add_u32 m0, s90, 71904
ds_read_b64_tr_b16 v[90:91], v120 offset:864
ds_read_b64_tr_b16 v[92:93], v120 offset:16992
v_mfma_f32_16x16x32_bf16 v[192:195], v[48:51], a[108:111], v[192:195]
buffer_load_dwordx4 v119, s[8:11], s89 offen offset:3072  lds
v_mfma_f32_16x16x32_bf16 v[196:199], v[48:51], a[124:127], v[196:199]
ds_read_b64_tr_b16 v[94:95], v120 offset:17248
v_mfma_f32_16x16x32_bf16 v[196:199], v[44:47], a[120:123], v[196:199]
ds_read_b64_tr_b16 v[96:97], v120 offset:17504
v_mfma_f32_16x16x32_bf16 v[196:199], v[40:43], a[116:119], v[196:199]
s_mov_b32 s88, 720896
ds_read_b64_tr_b16 v[98:99], v120 offset:17760
v_mfma_f32_16x16x32_bf16 v[196:199], v[36:39], a[112:115], v[196:199]
s_waitcnt lgkmcnt(15)
buffer_load_dwordx4 a[32:35], v116, s[4:7], s88 offen offset:0 sc1
v_mfma_f32_16x16x32_bf16 v[204:207], v[52:55], a[112:115], v[204:207]
ds_read_b64_tr_b16 v[36:37], v120 offset:128
ds_read_b64_tr_b16 v[38:39], v120 offset:384
v_mfma_f32_16x16x32_bf16 v[204:207], v[56:59], a[116:119], v[204:207]
ds_read_b64_tr_b16 v[40:41], v120 offset:640
ds_read_b64_tr_b16 v[42:43], v120 offset:896
v_mfma_f32_16x16x32_bf16 v[204:207], v[60:63], a[120:123], v[204:207]
buffer_load_dwordx4 a[36:39], v116, s[4:7], s88 offen offset:1024 sc1
v_mfma_f32_16x16x32_bf16 v[204:207], v[64:67], a[124:127], v[204:207]
ds_read_b64_tr_b16 v[44:45], v120 offset:17024
v_mfma_f32_16x16x32_bf16 v[200:203], v[64:67], a[108:111], v[200:203]
ds_read_b64_tr_b16 v[46:47], v120 offset:17280
v_mfma_f32_16x16x32_bf16 v[200:203], v[60:63], a[104:107], v[200:203]
ds_read_b64_tr_b16 v[48:49], v120 offset:17536
v_mfma_f32_16x16x32_bf16 v[200:203], v[56:59], a[100:103], v[200:203]
buffer_load_dwordx4 a[40:43], v116, s[4:7], s88 offen offset:2048 sc1
v_mfma_f32_16x16x32_bf16 v[200:203], v[52:55], a[96:99], v[200:203]
s_waitcnt lgkmcnt(15)
ds_read_b64_tr_b16 v[50:51], v120 offset:17792
v_mfma_f32_16x16x32_bf16 v[208:211], v[68:71], a[96:99], v[208:211]
ds_read_b64_tr_b16 v[52:53], v120 offset:160
v_mfma_f32_16x16x32_bf16 v[208:211], v[72:75], a[100:103], v[208:211]
ds_read_b64_tr_b16 v[54:55], v120 offset:416
ds_read_b64_tr_b16 v[56:57], v120 offset:672
v_mfma_f32_16x16x32_bf16 v[208:211], v[76:79], a[104:107], v[208:211]
buffer_load_dwordx4 a[44:47], v116, s[4:7], s88 offen offset:3072 sc1
v_mfma_f32_16x16x32_bf16 v[208:211], v[80:83], a[108:111], v[208:211]
ds_read_b64_tr_b16 v[58:59], v120 offset:928
ds_read_b64_tr_b16 v[60:61], v120 offset:17056
v_mfma_f32_16x16x32_bf16 v[212:215], v[80:83], a[124:127], v[212:215]
ds_read_b64_tr_b16 v[62:63], v120 offset:17312
v_mfma_f32_16x16x32_bf16 v[212:215], v[76:79], a[120:123], v[212:215]
ds_read_b64_tr_b16 v[64:65], v120 offset:17568
v_mfma_f32_16x16x32_bf16 v[212:215], v[72:75], a[116:119], v[212:215]
buffer_load_dwordx4 a[48:51], v117, s[4:7], s88 offen offset:0 sc1
v_mfma_f32_16x16x32_bf16 v[212:215], v[68:71], a[112:115], v[212:215]
s_waitcnt lgkmcnt(15)
ds_read_b64_tr_b16 v[66:67], v120 offset:17824
v_mfma_f32_16x16x32_bf16 v[220:223], v[84:87], a[112:115], v[220:223]
ds_read_b64_tr_b16 v[68:69], v120 offset:192
v_mfma_f32_16x16x32_bf16 v[220:223], v[88:91], a[116:119], v[220:223]
ds_read_b64_tr_b16 v[70:71], v120 offset:448
ds_read_b64_tr_b16 v[72:73], v120 offset:704
v_mfma_f32_16x16x32_bf16 v[220:223], v[92:95], a[120:123], v[220:223]
buffer_load_dwordx4 a[52:55], v117, s[4:7], s88 offen offset:1024 sc1
v_mfma_f32_16x16x32_bf16 v[220:223], v[96:99], a[124:127], v[220:223]
ds_read_b64_tr_b16 v[74:75], v120 offset:960
ds_read_b64_tr_b16 v[76:77], v120 offset:17088
v_mfma_f32_16x16x32_bf16 v[216:219], v[96:99], a[108:111], v[216:219]
ds_read_b64_tr_b16 v[78:79], v120 offset:17344
v_mfma_f32_16x16x32_bf16 v[216:219], v[92:95], a[104:107], v[216:219]
buffer_load_dwordx4 a[56:59], v117, s[4:7], s88 offen offset:2048 sc1
v_mfma_f32_16x16x32_bf16 v[216:219], v[88:91], a[100:103], v[216:219]
ds_read_b64_tr_b16 v[80:81], v120 offset:17600
v_mfma_f32_16x16x32_bf16 v[216:219], v[84:87], a[96:99], v[216:219]
s_waitcnt lgkmcnt(15)
ds_read_b64_tr_b16 v[82:83], v120 offset:17856
v_mfma_f32_16x16x32_bf16 v[224:227], v[36:39], a[96:99], v[224:227]
ds_read_b64_tr_b16 v[84:85], v120 offset:224
ds_read_b64_tr_b16 v[86:87], v120 offset:480
v_mfma_f32_16x16x32_bf16 v[224:227], v[40:43], a[100:103], v[224:227]
buffer_load_dwordx4 a[60:63], v117, s[4:7], s88 offen offset:3072 sc1
v_mfma_f32_16x16x32_bf16 v[224:227], v[44:47], a[104:107], v[224:227]
ds_read_b64_tr_b16 v[88:89], v120 offset:736
v_mfma_f32_16x16x32_bf16 v[224:227], v[48:51], a[108:111], v[224:227]
ds_read_b64_tr_b16 v[90:91], v120 offset:992
v_mfma_f32_16x16x32_bf16 v[228:231], v[48:51], a[124:127], v[228:231]
ds_read_b64_tr_b16 v[92:93], v120 offset:17120
v_mfma_f32_16x16x32_bf16 v[228:231], v[44:47], a[120:123], v[228:231]
s_waitcnt lgkmcnt(15)
ds_read_b64_tr_b16 v[94:95], v120 offset:17376
v_mfma_f32_16x16x32_bf16 v[228:231], v[40:43], a[116:119], v[228:231]
s_waitcnt vmcnt(24)
ds_read_b64_tr_b16 v[96:97], v120 offset:17632
v_mfma_f32_16x16x32_bf16 v[228:231], v[36:39], a[112:115], v[228:231]
s_barrier
ds_read_b64_tr_b16 v[98:99], v120 offset:17888
v_add_u32 v120, 4294899712, v3
v_mfma_f32_16x16x32_bf16 v[236:239], v[52:55], a[112:115], v[236:239]
s_mov_b32 s89, 1703936
ds_read_b64_tr_b16 v[36:37], v120 offset:0
v_mfma_f32_16x16x32_bf16 v[236:239], v[56:59], a[116:119], v[236:239]
s_add_u32 m0, s90, 33792
ds_read_b64_tr_b16 v[38:39], v120 offset:256
ds_read_b64_tr_b16 v[40:41], v120 offset:512
v_mfma_f32_16x16x32_bf16 v[236:239], v[60:63], a[120:123], v[236:239]
s_waitcnt lgkmcnt(15)
buffer_load_dwordx4 v118, s[8:11], s89 offen offset:0  lds
v_mfma_f32_16x16x32_bf16 v[236:239], v[64:67], a[124:127], v[236:239]
s_add_u32 m0, s90, 33824
ds_read_b64_tr_b16 v[42:43], v120 offset:768
ds_read_b64_tr_b16 v[44:45], v120 offset:16896
v_mfma_f32_16x16x32_bf16 v[232:235], v[64:67], a[108:111], v[232:235]
buffer_load_dwordx4 v118, s[8:11], s89 offen offset:1024  lds
v_mfma_f32_16x16x32_bf16 v[232:235], v[60:63], a[104:107], v[232:235]
ds_read_b64_tr_b16 v[46:47], v120 offset:17152
v_mfma_f32_16x16x32_bf16 v[232:235], v[56:59], a[100:103], v[232:235]
ds_read_b64_tr_b16 v[48:49], v120 offset:17408
v_mfma_f32_16x16x32_bf16 v[232:235], v[52:55], a[96:99], v[232:235]
s_add_u32 m0, s90, 33856
ds_read_b64_tr_b16 v[50:51], v120 offset:17664
v_mfma_f32_16x16x32_bf16 v[240:243], v[68:71], a[96:99], v[240:243]
buffer_load_dwordx4 v118, s[8:11], s89 offen offset:2048  lds
v_mfma_f32_16x16x32_bf16 v[240:243], v[72:75], a[100:103], v[240:243]
s_waitcnt lgkmcnt(15)
ds_read_b64_tr_b16 v[52:53], v120 offset:32
ds_read_b64_tr_b16 v[54:55], v120 offset:288
v_mfma_f32_16x16x32_bf16 v[240:243], v[76:79], a[104:107], v[240:243]
ds_read_b64_tr_b16 v[56:57], v120 offset:544
v_mfma_f32_16x16x32_bf16 v[240:243], v[80:83], a[108:111], v[240:243]
s_add_u32 m0, s90, 33888
ds_read_b64_tr_b16 v[58:59], v120 offset:800
ds_read_b64_tr_b16 v[60:61], v120 offset:16928
v_mfma_f32_16x16x32_bf16 v[244:247], v[80:83], a[124:127], v[244:247]
buffer_load_dwordx4 v118, s[8:11], s89 offen offset:3072  lds
v_mfma_f32_16x16x32_bf16 v[244:247], v[76:79], a[120:123], v[244:247]
ds_read_b64_tr_b16 v[62:63], v120 offset:17184
ds_read_b64_tr_b16 v[64:65], v120 offset:17440
v_mfma_f32_16x16x32_bf16 v[244:247], v[72:75], a[116:119], v[244:247]
s_add_u32 m0, s90, 38016
ds_read_b64_tr_b16 v[66:67], v120 offset:17696
v_mfma_f32_16x16x32_bf16 v[244:247], v[68:71], a[112:115], v[244:247]
s_waitcnt lgkmcnt(15)
buffer_load_dwordx4 v119, s[8:11], s89 offen offset:0  lds
v_mfma_f32_16x16x32_bf16 v[252:255], v[84:87], a[112:115], v[252:255]
ds_read_b64_tr_b16 v[68:69], v120 offset:64
ds_read_b64_tr_b16 v[70:71], v120 offset:320
v_mfma_f32_16x16x32_bf16 v[252:255], v[88:91], a[116:119], v[252:255]
ds_read_b64_tr_b16 v[72:73], v120 offset:576
v_mfma_f32_16x16x32_bf16 v[252:255], v[92:95], a[120:123], v[252:255]
s_add_u32 m0, s90, 38048
ds_read_b64_tr_b16 v[74:75], v120 offset:832
ds_read_b64_tr_b16 v[76:77], v120 offset:16960
v_mfma_f32_16x16x32_bf16 v[252:255], v[96:99], a[124:127], v[252:255]
buffer_load_dwordx4 v119, s[8:11], s89 offen offset:1024  lds
v_mfma_f32_16x16x32_bf16 v[248:251], v[96:99], a[108:111], v[248:251]
ds_read_b64_tr_b16 v[78:79], v120 offset:17216
v_mfma_f32_16x16x32_bf16 v[248:251], v[92:95], a[104:107], v[248:251]
ds_read_b64_tr_b16 v[80:81], v120 offset:17472
v_mfma_f32_16x16x32_bf16 v[248:251], v[88:91], a[100:103], v[248:251]
s_add_u32 m0, s90, 38080
s_waitcnt vmcnt(22)
ds_read_b64_tr_b16 v[82:83], v120 offset:17728
v_mfma_f32_16x16x32_bf16 v[248:251], v[84:87], a[96:99], v[248:251]
s_waitcnt lgkmcnt(15)
buffer_load_dwordx4 v119, s[8:11], s89 offen offset:2048  lds
v_mfma_f32_16x16x32_bf16 v[192:195], v[36:39], a[0:3], v[192:195]
ds_read_b64_tr_b16 v[84:85], v120 offset:96
ds_read_b64_tr_b16 v[86:87], v120 offset:352
v_mfma_f32_16x16x32_bf16 v[192:195], v[40:43], a[4:7], v[192:195]
ds_read_b64_tr_b16 v[88:89], v120 offset:608
v_mfma_f32_16x16x32_bf16 v[192:195], v[44:47], a[8:11], v[192:195]
s_cmp_eq_u32 s40, 0
s_cbranch_scc1 TICKET
TICKET_RET:
s_add_u32 m0, s90, 38112
ds_read_b64_tr_b16 v[90:91], v120 offset:864
ds_read_b64_tr_b16 v[92:93], v120 offset:16992
v_mfma_f32_16x16x32_bf16 v[192:195], v[48:51], a[12:15], v[192:195]
buffer_load_dwordx4 v119, s[8:11], s89 offen offset:3072  lds
v_mfma_f32_16x16x32_bf16 v[196:199], v[48:51], a[28:31], v[196:199]
ds_read_b64_tr_b16 v[94:95], v120 offset:17248
v_mfma_f32_16x16x32_bf16 v[196:199], v[44:47], a[24:27], v[196:199]
ds_read_b64_tr_b16 v[96:97], v120 offset:17504
v_mfma_f32_16x16x32_bf16 v[196:199], v[40:43], a[20:23], v[196:199]
s_mov_b32 s88, 851968
ds_read_b64_tr_b16 v[98:99], v120 offset:17760
v_mfma_f32_16x16x32_bf16 v[196:199], v[36:39], a[16:19], v[196:199]
s_waitcnt lgkmcnt(15)
buffer_load_dwordx4 a[64:67], v116, s[4:7], s88 offen offset:0 sc1
v_mfma_f32_16x16x32_bf16 v[204:207], v[52:55], a[16:19], v[204:207]
ds_read_b64_tr_b16 v[36:37], v120 offset:128
ds_read_b64_tr_b16 v[38:39], v120 offset:384
v_mfma_f32_16x16x32_bf16 v[204:207], v[56:59], a[20:23], v[204:207]
ds_read_b64_tr_b16 v[40:41], v120 offset:640
ds_read_b64_tr_b16 v[42:43], v120 offset:896
v_mfma_f32_16x16x32_bf16 v[204:207], v[60:63], a[24:27], v[204:207]
buffer_load_dwordx4 a[68:71], v116, s[4:7], s88 offen offset:1024 sc1
v_mfma_f32_16x16x32_bf16 v[204:207], v[64:67], a[28:31], v[204:207]
ds_read_b64_tr_b16 v[44:45], v120 offset:17024
v_mfma_f32_16x16x32_bf16 v[200:203], v[64:67], a[12:15], v[200:203]
ds_read_b64_tr_b16 v[46:47], v120 offset:17280
v_mfma_f32_16x16x32_bf16 v[200:203], v[60:63], a[8:11], v[200:203]
ds_read_b64_tr_b16 v[48:49], v120 offset:17536
v_mfma_f32_16x16x32_bf16 v[200:203], v[56:59], a[4:7], v[200:203]
buffer_load_dwordx4 a[72:75], v116, s[4:7], s88 offen offset:2048 sc1
v_mfma_f32_16x16x32_bf16 v[200:203], v[52:55], a[0:3], v[200:203]
s_waitcnt lgkmcnt(15)
ds_read_b64_tr_b16 v[50:51], v120 offset:17792
v_mfma_f32_16x16x32_bf16 v[208:211], v[68:71], a[0:3], v[208:211]
ds_read_b64_tr_b16 v[52:53], v120 offset:160
v_mfma_f32_16x16x32_bf16 v[208:211], v[72:75], a[4:7], v[208:211]
ds_read_b64_tr_b16 v[54:55], v120 offset:416
ds_read_b64_tr_b16 v[56:57], v120 offset:672
v_mfma_f32_16x16x32_bf16 v[208:211], v[76:79], a[8:11], v[208:211]
buffer_load_dwordx4 a[76:79], v116, s[4:7], s88 offen offset:3072 sc1
v_mfma_f32_16x16x32_bf16 v[208:211], v[80:83], a[12:15], v[208:211]
ds_read_b64_tr_b16 v[58:59], v120 offset:928
ds_read_b64_tr_b16 v[60:61], v120 offset:17056
v_mfma_f32_16x16x32_bf16 v[212:215], v[80:83], a[28:31], v[212:215]
ds_read_b64_tr_b16 v[62:63], v120 offset:17312
v_mfma_f32_16x16x32_bf16 v[212:215], v[76:79], a[24:27], v[212:215]
ds_read_b64_tr_b16 v[64:65], v120 offset:17568
v_mfma_f32_16x16x32_bf16 v[212:215], v[72:75], a[20:23], v[212:215]
buffer_load_dwordx4 a[80:83], v117, s[4:7], s88 offen offset:0 sc1
v_mfma_f32_16x16x32_bf16 v[212:215], v[68:71], a[16:19], v[212:215]
s_waitcnt lgkmcnt(15)
ds_read_b64_tr_b16 v[66:67], v120 offset:17824
v_mfma_f32_16x16x32_bf16 v[220:223], v[84:87], a[16:19], v[220:223]
ds_read_b64_tr_b16 v[68:69], v120 offset:192
v_mfma_f32_16x16x32_bf16 v[220:223], v[88:91], a[20:23], v[220:223]
ds_read_b64_tr_b16 v[70:71], v120 offset:448
ds_read_b64_tr_b16 v[72:73], v120 offset:704
v_mfma_f32_16x16x32_bf16 v[220:223], v[92:95], a[24:27], v[220:223]
buffer_load_dwordx4 a[84:87], v117, s[4:7], s88 offen offset:1024 sc1
v_mfma_f32_16x16x32_bf16 v[220:223], v[96:99], a[28:31], v[220:223]
ds_read_b64_tr_b16 v[74:75], v120 offset:960
ds_read_b64_tr_b16 v[76:77], v120 offset:17088
v_mfma_f32_16x16x32_bf16 v[216:219], v[96:99], a[12:15], v[216:219]
ds_read_b64_tr_b16 v[78:79], v120 offset:17344
v_mfma_f32_16x16x32_bf16 v[216:219], v[92:95], a[8:11], v[216:219]
buffer_load_dwordx4 a[88:91], v117, s[4:7], s88 offen offset:2048 sc1
v_mfma_f32_16x16x32_bf16 v[216:219], v[88:91], a[4:7], v[216:219]
ds_read_b64_tr_b16 v[80:81], v120 offset:17600
v_mfma_f32_16x16x32_bf16 v[216:219], v[84:87], a[0:3], v[216:219]
s_waitcnt lgkmcnt(15)
ds_read_b64_tr_b16 v[82:83], v120 offset:17856
v_mfma_f32_16x16x32_bf16 v[224:227], v[36:39], a[0:3], v[224:227]
ds_read_b64_tr_b16 v[84:85], v120 offset:224
ds_read_b64_tr_b16 v[86:87], v120 offset:480
v_mfma_f32_16x16x32_bf16 v[224:227], v[40:43], a[4:7], v[224:227]
buffer_load_dwordx4 a[92:95], v117, s[4:7], s88 offen offset:3072 sc1
v_mfma_f32_16x16x32_bf16 v[224:227], v[44:47], a[8:11], v[224:227]
ds_read_b64_tr_b16 v[88:89], v120 offset:736
v_mfma_f32_16x16x32_bf16 v[224:227], v[48:51], a[12:15], v[224:227]
ds_read_b64_tr_b16 v[90:91], v120 offset:992
v_mfma_f32_16x16x32_bf16 v[228:231], v[48:51], a[28:31], v[228:231]
ds_read_b64_tr_b16 v[92:93], v120 offset:17120
v_mfma_f32_16x16x32_bf16 v[228:231], v[44:47], a[24:27], v[228:231]
s_waitcnt lgkmcnt(15)
ds_read_b64_tr_b16 v[94:95], v120 offset:17376
v_mfma_f32_16x16x32_bf16 v[228:231], v[40:43], a[20:23], v[228:231]
s_waitcnt vmcnt(24)
ds_read_b64_tr_b16 v[96:97], v120 offset:17632
v_mfma_f32_16x16x32_bf16 v[228:231], v[36:39], a[16:19], v[228:231]
s_barrier
ds_read_b64_tr_b16 v[98:99], v120 offset:17888
v_add_u32 v120, 0, v3
v_mfma_f32_16x16x32_bf16 v[236:239], v[52:55], a[16:19], v[236:239]
s_mov_b32 s89, 1966080
ds_read_b64_tr_b16 v[36:37], v120 offset:0
v_mfma_f32_16x16x32_bf16 v[236:239], v[56:59], a[20:23], v[236:239]
s_add_u32 m0, s90, 101376
ds_read_b64_tr_b16 v[38:39], v120 offset:256
ds_read_b64_tr_b16 v[40:41], v120 offset:512
v_mfma_f32_16x16x32_bf16 v[236:239], v[60:63], a[24:27], v[236:239]
s_waitcnt lgkmcnt(15)
buffer_load_dwordx4 v118, s[8:11], s89 offen offset:0  lds
v_mfma_f32_16x16x32_bf16 v[236:239], v[64:67], a[28:31], v[236:239]
s_add_u32 m0, s90, 101408
ds_read_b64_tr_b16 v[42:43], v120 offset:768
ds_read_b64_tr_b16 v[44:45], v120 offset:16896
v_mfma_f32_16x16x32_bf16 v[232:235], v[64:67], a[12:15], v[232:235]
buffer_load_dwordx4 v118, s[8:11], s89 offen offset:1024  lds
v_mfma_f32_16x16x32_bf16 v[232:235], v[60:63], a[8:11], v[232:235]
ds_read_b64_tr_b16 v[46:47], v120 offset:17152
v_mfma_f32_16x16x32_bf16 v[232:235], v[56:59], a[4:7], v[232:235]
ds_read_b64_tr_b16 v[48:49], v120 offset:17408
v_mfma_f32_16x16x32_bf16 v[232:235], v[52:55], a[0:3], v[232:235]
s_add_u32 m0, s90, 101440
ds_read_b64_tr_b16 v[50:51], v120 offset:17664
v_mfma_f32_16x16x32_bf16 v[240:243], v[68:71], a[0:3], v[240:243]
buffer_load_dwordx4 v118, s[8:11], s89 offen offset:2048  lds
v_mfma_f32_16x16x32_bf16 v[240:243], v[72:75], a[4:7], v[240:243]
s_waitcnt lgkmcnt(15)
ds_read_b64_tr_b16 v[52:53], v120 offset:32
ds_read_b64_tr_b16 v[54:55], v120 offset:288
v_mfma_f32_16x16x32_bf16 v[240:243], v[76:79], a[8:11], v[240:243]
ds_read_b64_tr_b16 v[56:57], v120 offset:544
v_mfma_f32_16x16x32_bf16 v[240:243], v[80:83], a[12:15], v[240:243]
s_add_u32 m0, s90, 101472
ds_read_b64_tr_b16 v[58:59], v120 offset:800
ds_read_b64_tr_b16 v[60:61], v120 offset:16928
v_mfma_f32_16x16x32_bf16 v[244:247], v[80:83], a[28:31], v[244:247]
buffer_load_dwordx4 v118, s[8:11], s89 offen offset:3072  lds
v_mfma_f32_16x16x32_bf16 v[244:247], v[76:79], a[24:27], v[244:247]
ds_read_b64_tr_b16 v[62:63], v120 offset:17184
ds_read_b64_tr_b16 v[64:65], v120 offset:17440
v_mfma_f32_16x16x32_bf16 v[244:247], v[72:75], a[20:23], v[244:247]
s_add_u32 m0, s90, 105600
ds_read_b64_tr_b16 v[66:67], v120 offset:17696
v_mfma_f32_16x16x32_bf16 v[244:247], v[68:71], a[16:19], v[244:247]
s_waitcnt lgkmcnt(15)
buffer_load_dwordx4 v119, s[8:11], s89 offen offset:0  lds
v_mfma_f32_16x16x32_bf16 v[252:255], v[84:87], a[16:19], v[252:255]
ds_read_b64_tr_b16 v[68:69], v120 offset:64
ds_read_b64_tr_b16 v[70:71], v120 offset:320
v_mfma_f32_16x16x32_bf16 v[252:255], v[88:91], a[20:23], v[252:255]
ds_read_b64_tr_b16 v[72:73], v120 offset:576
v_mfma_f32_16x16x32_bf16 v[252:255], v[92:95], a[24:27], v[252:255]
s_add_u32 m0, s90, 105632
ds_read_b64_tr_b16 v[74:75], v120 offset:832
ds_read_b64_tr_b16 v[76:77], v120 offset:16960
v_mfma_f32_16x16x32_bf16 v[252:255], v[96:99], a[28:31], v[252:255]
buffer_load_dwordx4 v119, s[8:11], s89 offen offset:1024  lds
v_mfma_f32_16x16x32_bf16 v[248:251], v[96:99], a[12:15], v[248:251]
ds_read_b64_tr_b16 v[78:79], v120 offset:17216
v_mfma_f32_16x16x32_bf16 v[248:251], v[92:95], a[8:11], v[248:251]
ds_read_b64_tr_b16 v[80:81], v120 offset:17472
v_mfma_f32_16x16x32_bf16 v[248:251], v[88:91], a[4:7], v[248:251]
s_add_u32 m0, s90, 105664
s_waitcnt vmcnt(22)
ds_read_b64_tr_b16 v[82:83], v120 offset:17728
v_mfma_f32_16x16x32_bf16 v[248:251], v[84:87], a[0:3], v[248:251]
s_waitcnt lgkmcnt(15)
buffer_load_dwordx4 v119, s[8:11], s89 offen offset:2048  lds
v_mfma_f32_16x16x32_bf16 v[192:195], v[36:39], a[32:35], v[192:195]
ds_read_b64_tr_b16 v[84:85], v120 offset:96
ds_read_b64_tr_b16 v[86:87], v120 offset:352
v_mfma_f32_16x16x32_bf16 v[192:195], v[40:43], a[36:39], v[192:195]
ds_read_b64_tr_b16 v[88:89], v120 offset:608
v_mfma_f32_16x16x32_bf16 v[192:195], v[44:47], a[40:43], v[192:195]
s_add_u32 m0, s90, 105696
ds_read_b64_tr_b16 v[90:91], v120 offset:864
ds_read_b64_tr_b16 v[92:93], v120 offset:16992
v_mfma_f32_16x16x32_bf16 v[192:195], v[48:51], a[44:47], v[192:195]
buffer_load_dwordx4 v119, s[8:11], s89 offen offset:3072  lds
v_mfma_f32_16x16x32_bf16 v[196:199], v[48:51], a[60:63], v[196:199]
ds_read_b64_tr_b16 v[94:95], v120 offset:17248
v_mfma_f32_16x16x32_bf16 v[196:199], v[44:47], a[56:59], v[196:199]
ds_read_b64_tr_b16 v[96:97], v120 offset:17504
v_mfma_f32_16x16x32_bf16 v[196:199], v[40:43], a[52:55], v[196:199]
s_mov_b32 s88, 983040
ds_read_b64_tr_b16 v[98:99], v120 offset:17760
v_mfma_f32_16x16x32_bf16 v[196:199], v[36:39], a[48:51], v[196:199]
s_waitcnt lgkmcnt(15)
buffer_load_dwordx4 a[96:99], v116, s[4:7], s88 offen offset:0 sc1
v_mfma_f32_16x16x32_bf16 v[204:207], v[52:55], a[48:51], v[204:207]
ds_read_b64_tr_b16 v[36:37], v120 offset:128
ds_read_b64_tr_b16 v[38:39], v120 offset:384
v_mfma_f32_16x16x32_bf16 v[204:207], v[56:59], a[52:55], v[204:207]
ds_read_b64_tr_b16 v[40:41], v120 offset:640
ds_read_b64_tr_b16 v[42:43], v120 offset:896
v_mfma_f32_16x16x32_bf16 v[204:207], v[60:63], a[56:59], v[204:207]
buffer_load_dwordx4 a[100:103], v116, s[4:7], s88 offen offset:1024 sc1
v_mfma_f32_16x16x32_bf16 v[204:207], v[64:67], a[60:63], v[204:207]
ds_read_b64_tr_b16 v[44:45], v120 offset:17024
v_mfma_f32_16x16x32_bf16 v[200:203], v[64:67], a[44:47], v[200:203]
ds_read_b64_tr_b16 v[46:47], v120 offset:17280
v_mfma_f32_16x16x32_bf16 v[200:203], v[60:63], a[40:43], v[200:203]
ds_read_b64_tr_b16 v[48:49], v120 offset:17536
v_mfma_f32_16x16x32_bf16 v[200:203], v[56:59], a[36:39], v[200:203]
buffer_load_dwordx4 a[104:107], v116, s[4:7], s88 offen offset:2048 sc1
v_mfma_f32_16x16x32_bf16 v[200:203], v[52:55], a[32:35], v[200:203]
s_waitcnt lgkmcnt(15)
ds_read_b64_tr_b16 v[50:51], v120 offset:17792
v_mfma_f32_16x16x32_bf16 v[208:211], v[68:71], a[32:35], v[208:211]
ds_read_b64_tr_b16 v[52:53], v120 offset:160
v_mfma_f32_16x16x32_bf16 v[208:211], v[72:75], a[36:39], v[208:211]
ds_read_b64_tr_b16 v[54:55], v120 offset:416
ds_read_b64_tr_b16 v[56:57], v120 offset:672
v_mfma_f32_16x16x32_bf16 v[208:211], v[76:79], a[40:43], v[208:211]
buffer_load_dwordx4 a[108:111], v116, s[4:7], s88 offen offset:3072 sc1
v_mfma_f32_16x16x32_bf16 v[208:211], v[80:83], a[44:47], v[208:211]
ds_read_b64_tr_b16 v[58:59], v120 offset:928
ds_read_b64_tr_b16 v[60:61], v120 offset:17056
v_mfma_f32_16x16x32_bf16 v[212:215], v[80:83], a[60:63], v[212:215]
ds_read_b64_tr_b16 v[62:63], v120 offset:17312
v_mfma_f32_16x16x32_bf16 v[212:215], v[76:79], a[56:59], v[212:215]
ds_read_b64_tr_b16 v[64:65], v120 offset:17568
v_mfma_f32_16x16x32_bf16 v[212:215], v[72:75], a[52:55], v[212:215]
buffer_load_dwordx4 a[112:115], v117, s[4:7], s88 offen offset:0 sc1
v_mfma_f32_16x16x32_bf16 v[212:215], v[68:71], a[48:51], v[212:215]
s_waitcnt lgkmcnt(15)
ds_read_b64_tr_b16 v[66:67], v120 offset:17824
v_mfma_f32_16x16x32_bf16 v[220:223], v[84:87], a[48:51], v[220:223]
ds_read_b64_tr_b16 v[68:69], v120 offset:192
v_mfma_f32_16x16x32_bf16 v[220:223], v[88:91], a[52:55], v[220:223]
ds_read_b64_tr_b16 v[70:71], v120 offset:448
ds_read_b64_tr_b16 v[72:73], v120 offset:704
v_mfma_f32_16x16x32_bf16 v[220:223], v[92:95], a[56:59], v[220:223]
buffer_load_dwordx4 a[116:119], v117, s[4:7], s88 offen offset:1024 sc1
v_mfma_f32_16x16x32_bf16 v[220:223], v[96:99], a[60:63], v[220:223]
ds_read_b64_tr_b16 v[74:75], v120 offset:960
ds_read_b64_tr_b16 v[76:77], v120 offset:17088
v_mfma_f32_16x16x32_bf16 v[216:219], v[96:99], a[44:47], v[216:219]
ds_read_b64_tr_b16 v[78:79], v120 offset:17344
v_mfma_f32_16x16x32_bf16 v[216:219], v[92:95], a[40:43], v[216:219]
buffer_load_dwordx4 a[120:123], v117, s[4:7], s88 offen offset:2048 sc1
v_mfma_f32_16x16x32_bf16 v[216:219], v[88:91], a[36:39], v[216:219]
ds_read_b64_tr_b16 v[80:81], v120 offset:17600
v_mfma_f32_16x16x32_bf16 v[216:219], v[84:87], a[32:35], v[216:219]
s_waitcnt lgkmcnt(15)
ds_read_b64_tr_b16 v[82:83], v120 offset:17856
v_mfma_f32_16x16x32_bf16 v[224:227], v[36:39], a[32:35], v[224:227]
ds_read_b64_tr_b16 v[84:85], v120 offset:224
ds_read_b64_tr_b16 v[86:87], v120 offset:480
v_mfma_f32_16x16x32_bf16 v[224:227], v[40:43], a[36:39], v[224:227]
buffer_load_dwordx4 a[124:127], v117, s[4:7], s88 offen offset:3072 sc1
v_mfma_f32_16x16x32_bf16 v[224:227], v[44:47], a[40:43], v[224:227]
ds_read_b64_tr_b16 v[88:89], v120 offset:736
v_mfma_f32_16x16x32_bf16 v[224:227], v[48:51], a[44:47], v[224:227]
ds_read_b64_tr_b16 v[90:91], v120 offset:992
v_mfma_f32_16x16x32_bf16 v[228:231], v[48:51], a[60:63], v[228:231]
s_cmp_eq_u32 s40, 0
s_cbranch_scc1 TICKET2
TICKET2_RET:
ds_read_b64_tr_b16 v[92:93], v120 offset:17120
v_mfma_f32_16x16x32_bf16 v[228:231], v[44:47], a[56:59], v[228:231]
s_waitcnt lgkmcnt(15)
ds_read_b64_tr_b16 v[94:95], v120 offset:17376
v_mfma_f32_16x16x32_bf16 v[228:231], v[40:43], a[52:55], v[228:231]
s_waitcnt vmcnt(24)
ds_read_b64_tr_b16 v[96:97], v120 offset:17632
v_mfma_f32_16x16x32_bf16 v[228:231], v[36:39], a[48:51], v[228:231]
s_barrier
ds_read_b64_tr_b16 v[98:99], v120 offset:17888
v_add_u32 v120, 4294933504, v3
v_mfma_f32_16x16x32_bf16 v[236:239], v[52:55], a[48:51], v[236:239]
ds_read_b64_tr_b16 v[36:37], v120 offset:0
ds_read_b32 v8, v7 offset:0
v_mfma_f32_16x16x32_bf16 v[236:239], v[56:59], a[52:55], v[236:239]
ds_read_b64_tr_b16 v[38:39], v120 offset:256
v_mfma_f32_16x16x32_bf16 v[236:239], v[60:63], a[56:59], v[236:239]
s_waitcnt lgkmcnt(15)
ds_read_b64_tr_b16 v[40:41], v120 offset:512
v_mfma_f32_16x16x32_bf16 v[236:239], v[64:67], a[60:63], v[236:239]
ds_read_b64_tr_b16 v[42:43], v120 offset:768
v_mfma_f32_16x16x32_bf16 v[232:235], v[64:67], a[44:47], v[232:235]
ds_read_b64_tr_b16 v[44:45], v120 offset:16896
v_mfma_f32_16x16x32_bf16 v[232:235], v[60:63], a[40:43], v[232:235]
ds_read_b64_tr_b16 v[46:47], v120 offset:17152
v_mfma_f32_16x16x32_bf16 v[232:235], v[56:59], a[36:39], v[232:235]
ds_read_b64_tr_b16 v[48:49], v120 offset:17408
v_mfma_f32_16x16x32_bf16 v[232:235], v[52:55], a[32:35], v[232:235]
ds_read_b64_tr_b16 v[50:51], v120 offset:17664
v_mfma_f32_16x16x32_bf16 v[240:243], v[68:71], a[32:35], v[240:243]
ds_read_b64_tr_b16 v[52:53], v120 offset:32
v_mfma_f32_16x16x32_bf16 v[240:243], v[72:75], a[36:39], v[240:243]
s_waitcnt lgkmcnt(15)
ds_read_b64_tr_b16 v[54:55], v120 offset:288
v_mfma_f32_16x16x32_bf16 v[240:243], v[76:79], a[40:43], v[240:243]
ds_read_b64_tr_b16 v[56:57], v120 offset:544
v_mfma_f32_16x16x32_bf16 v[240:243], v[80:83], a[44:47], v[240:243]
ds_read_b64_tr_b16 v[58:59], v120 offset:800
v_mfma_f32_16x16x32_bf16 v[244:247], v[80:83], a[60:63], v[244:247]
ds_read_b64_tr_b16 v[60:61], v120 offset:16928
s_waitcnt lgkmcnt(12)
v_readfirstlane_b32 s30, v8
v_mfma_f32_16x16x32_bf16 v[244:247], v[76:79], a[56:59], v[244:247]
ds_read_b64_tr_b16 v[62:63], v120 offset:17184
ds_read_b64_tr_b16 v[64:65], v120 offset:17440
v_mfma_f32_16x16x32_bf16 v[244:247], v[72:75], a[52:55], v[244:247]
global_load_dword v122, v121, s[76:77] sc1
v_mfma_f32_16x16x32_bf16 v[244:247], v[68:71], a[48:51], v[244:247]
ds_read_b64_tr_b16 v[66:67], v120 offset:17696
v_mfma_f32_16x16x32_bf16 v[252:255], v[84:87], a[48:51], v[252:255]
ds_read_b64_tr_b16 v[68:69], v120 offset:64
v_add_u32 v20, s74, v1
v_mfma_f32_16x16x32_bf16 v[252:255], v[88:91], a[52:55], v[252:255]
ds_read_b64_tr_b16 v[70:71], v120 offset:320
v_mfma_f32_16x16x32_bf16 v[252:255], v[92:95], a[56:59], v[252:255]
ds_read_b64_tr_b16 v[72:73], v120 offset:576
v_add_u32 v21, 4096, v20
v_mfma_f32_16x16x32_bf16 v[252:255], v[96:99], a[60:63], v[252:255]
ds_read_b64_tr_b16 v[74:75], v120 offset:832
v_mfma_f32_16x16x32_bf16 v[248:251], v[96:99], a[44:47], v[248:251]
ds_read_b64_tr_b16 v[76:77], v120 offset:16960
v_add_u32 v22, 8192, v20
v_mfma_f32_16x16x32_bf16 v[248:251], v[92:95], a[40:43], v[248:251]
ds_read_b64_tr_b16 v[78:79], v120 offset:17216
v_mfma_f32_16x16x32_bf16 v[248:251], v[88:91], a[36:39], v[248:251]
s_waitcnt vmcnt(17)
ds_read_b64_tr_b16 v[80:81], v120 offset:17472
v_add_u32 v23, 12288, v20
v_mfma_f32_16x16x32_bf16 v[248:251], v[84:87], a[32:35], v[248:251]
s_waitcnt lgkmcnt(15)
ds_read_b64_tr_b16 v[82:83], v120 offset:17728
v_mfma_f32_16x16x32_bf16 v[192:195], v[36:39], a[64:67], v[192:195]
ds_read_b64_tr_b16 v[84:85], v120 offset:96
v_mfma_f32_16x16x32_bf16 v[192:195], v[40:43], a[68:71], v[192:195]
ds_read_b64_tr_b16 v[86:87], v120 offset:352
v_mfma_f32_16x16x32_bf16 v[192:195], v[44:47], a[72:75], v[192:195]
ds_read_b64_tr_b16 v[88:89], v120 offset:608
v_mfma_f32_16x16x32_bf16 v[192:195], v[48:51], a[76:79], v[192:195]
s_mov_b64 s[12:13], s[68:69]
ds_read_b64_tr_b16 v[90:91], v120 offset:864
v_mfma_f32_16x16x32_bf16 v[196:199], v[48:51], a[92:95], v[196:199]
s_mov_b32 s15, 0x20000
ds_read_b64_tr_b16 v[92:93], v120 offset:16992
v_mfma_f32_16x16x32_bf16 v[196:199], v[44:47], a[88:91], v[196:199]
ds_read_b64_tr_b16 v[94:95], v120 offset:17248
v_mfma_f32_16x16x32_bf16 v[196:199], v[40:43], a[84:87], v[196:199]
s_cmp_eq_u32 s30, 0
s_cselect_b32 s14, 0x10000, 0
ds_read_b64_tr_b16 v[96:97], v120 offset:17504
v_mfma_f32_16x16x32_bf16 v[196:199], v[36:39], a[80:83], v[196:199]
s_waitcnt lgkmcnt(15)
ds_read_b64_tr_b16 v[98:99], v120 offset:17760
v_mfma_f32_16x16x32_bf16 v[204:207], v[52:55], a[80:83], v[204:207]
ds_read_b64_tr_b16 v[36:37], v120 offset:128
v_mfma_f32_16x16x32_bf16 v[204:207], v[56:59], a[84:87], v[204:207]
ds_read_b64_tr_b16 v[38:39], v120 offset:384
v_mfma_f32_16x16x32_bf16 v[204:207], v[60:63], a[88:91], v[204:207]
ds_read_b64_tr_b16 v[40:41], v120 offset:640
v_mfma_f32_16x16x32_bf16 v[204:207], v[64:67], a[92:95], v[204:207]
s_waitcnt vmcnt(0)
ds_read_b64_tr_b16 v[42:43], v120 offset:896
v_readfirstlane_b32 s61, v122
v_mfma_f32_16x16x32_bf16 v[200:203], v[64:67], a[76:79], v[200:203]
s_and_b32 s31, s61, s30
ds_read_b64_tr_b16 v[44:45], v120 offset:17024
v_mfma_f32_16x16x32_bf16 v[200:203], v[60:63], a[72:75], v[200:203]
s_lshl_b32 s74, s31, 16
ds_read_b64_tr_b16 v[46:47], v120 offset:17280
v_mfma_f32_16x16x32_bf16 v[200:203], v[56:59], a[68:71], v[200:203]
ds_read_b64_tr_b16 v[48:49], v120 offset:17536
v_mfma_f32_16x16x32_bf16 v[200:203], v[52:55], a[64:67], v[200:203]
s_waitcnt lgkmcnt(15)
ds_read_b64_tr_b16 v[50:51], v120 offset:17792
v_mfma_f32_16x16x32_bf16 v[208:211], v[68:71], a[64:67], v[208:211]
buffer_load_dwordx4 v[128:131], v20, s[72:75], 0 offen offset:0 sc1
v_mfma_f32_16x16x32_bf16 v[208:211], v[72:75], a[68:71], v[208:211]
ds_read_b64_tr_b16 v[52:53], v120 offset:160
ds_read_b64_tr_b16 v[54:55], v120 offset:416
v_mfma_f32_16x16x32_bf16 v[208:211], v[76:79], a[72:75], v[208:211]
ds_read_b64_tr_b16 v[56:57], v120 offset:672
v_mfma_f32_16x16x32_bf16 v[208:211], v[80:83], a[76:79], v[208:211]
ds_read_b64_tr_b16 v[58:59], v120 offset:928
v_mfma_f32_16x16x32_bf16 v[212:215], v[80:83], a[92:95], v[212:215]
ds_read_b64_tr_b16 v[60:61], v120 offset:17056
v_mfma_f32_16x16x32_bf16 v[212:215], v[76:79], a[88:91], v[212:215]
ds_read_b64_tr_b16 v[62:63], v120 offset:17312
ds_read_b64_tr_b16 v[64:65], v120 offset:17568
v_mfma_f32_16x16x32_bf16 v[212:215], v[72:75], a[84:87], v[212:215]
buffer_load_dwordx4 v[132:135], v20, s[72:75], 0 offen offset:1024 sc1
v_mfma_f32_16x16x32_bf16 v[212:215], v[68:71], a[80:83], v[212:215]
s_waitcnt lgkmcnt(15)
ds_read_b64_tr_b16 v[66:67], v120 offset:17824
v_mfma_f32_16x16x32_bf16 v[220:223], v[84:87], a[80:83], v[220:223]
ds_read_b64_tr_b16 v[68:69], v120 offset:192
v_mfma_f32_16x16x32_bf16 v[220:223], v[88:91], a[84:87], v[220:223]
ds_read_b64_tr_b16 v[70:71], v120 offset:448
v_mfma_f32_16x16x32_bf16 v[220:223], v[92:95], a[88:91], v[220:223]
ds_read_b64_tr_b16 v[72:73], v120 offset:704
v_mfma_f32_16x16x32_bf16 v[220:223], v[96:99], a[92:95], v[220:223]
ds_read_b64_tr_b16 v[74:75], v120 offset:960
ds_read_b64_tr_b16 v[76:77], v120 offset:17088
v_mfma_f32_16x16x32_bf16 v[216:219], v[96:99], a[76:79], v[216:219]
buffer_load_dwordx4 v[136:139], v20, s[72:75], 0 offen offset:2048 sc1
v_mfma_f32_16x16x32_bf16 v[216:219], v[92:95], a[72:75], v[216:219]
ds_read_b64_tr_b16 v[78:79], v120 offset:17344
v_mfma_f32_16x16x32_bf16 v[216:219], v[88:91], a[68:71], v[216:219]
ds_read_b64_tr_b16 v[80:81], v120 offset:17600
v_mfma_f32_16x16x32_bf16 v[216:219], v[84:87], a[64:67], v[216:219]
s_waitcnt lgkmcnt(15)
ds_read_b64_tr_b16 v[82:83], v120 offset:17856
v_mfma_f32_16x16x32_bf16 v[224:227], v[36:39], a[64:67], v[224:227]
ds_read_b64_tr_b16 v[84:85], v120 offset:224
v_mfma_f32_16x16x32_bf16 v[224:227], v[40:43], a[68:71], v[224:227]
ds_read_b64_tr_b16 v[86:87], v120 offset:480
ds_read_b64_tr_b16 v[88:89], v120 offset:736
v_mfma_f32_16x16x32_bf16 v[224:227], v[44:47], a[72:75], v[224:227]
buffer_load_dwordx4 v[140:143], v20, s[72:75], 0 offen offset:3072 sc1
v_mfma_f32_16x16x32_bf16 v[224:227], v[48:51], a[76:79], v[224:227]
ds_read_b64_tr_b16 v[90:91], v120 offset:992
v_mfma_f32_16x16x32_bf16 v[228:231], v[48:51], a[92:95], v[228:231]
ds_read_b64_tr_b16 v[92:93], v120 offset:17120
v_mfma_f32_16x16x32_bf16 v[228:231], v[44:47], a[88:91], v[228:231]
s_waitcnt lgkmcnt(15)
ds_read_b64_tr_b16 v[94:95], v120 offset:17376
v_mfma_f32_16x16x32_bf16 v[228:231], v[40:43], a[84:87], v[228:231]
s_waitcnt vmcnt(13)
ds_read_b64_tr_b16 v[96:97], v120 offset:17632
v_mfma_f32_16x16x32_bf16 v[228:231], v[36:39], a[80:83], v[228:231]
s_barrier
ds_read_b64_tr_b16 v[98:99], v120 offset:17888
v_add_u32 v120, 33792, v3
v_mfma_f32_16x16x32_bf16 v[236:239], v[52:55], a[80:83], v[236:239]
buffer_load_dwordx4 v[144:147], v21, s[72:75], 0 offen offset:0 sc1
v_mfma_f32_16x16x32_bf16 v[236:239], v[56:59], a[84:87], v[236:239]
ds_read_b64_tr_b16 v[36:37], v120 offset:0
ds_read_b64_tr_b16 v[38:39], v120 offset:256
v_mfma_f32_16x16x32_bf16 v[236:239], v[60:63], a[88:91], v[236:239]
s_waitcnt lgkmcnt(15)
ds_read_b64_tr_b16 v[40:41], v120 offset:512
v_mfma_f32_16x16x32_bf16 v[236:239], v[64:67], a[92:95], v[236:239]
ds_read_b64_tr_b16 v[42:43], v120 offset:768
v_mfma_f32_16x16x32_bf16 v[232:235], v[64:67], a[76:79], v[232:235]
ds_read_b64_tr_b16 v[44:45], v120 offset:16896
v_mfma_f32_16x16x32_bf16 v[232:235], v[60:63], a[72:75], v[232:235]
ds_read_b64_tr_b16 v[46:47], v120 offset:17152
ds_read_b64_tr_b16 v[48:49], v120 offset:17408
v_mfma_f32_16x16x32_bf16 v[232:235], v[56:59], a[68:71], v[232:235]
buffer_load_dwordx4 v[148:151], v21, s[72:75], 0 offen offset:1024 sc1
v_mfma_f32_16x16x32_bf16 v[232:235], v[52:55], a[64:67], v[232:235]
ds_read_b64_tr_b16 v[50:51], v120 offset:17664
v_mfma_f32_16x16x32_bf16 v[240:243], v[68:71], a[64:67], v[240:243]
s_waitcnt lgkmcnt(15)
ds_read_b64_tr_b16 v[52:53], v120 offset:32
v_mfma_f32_16x16x32_bf16 v[240:243], v[72:75], a[68:71], v[240:243]
ds_read_b64_tr_b16 v[54:55], v120 offset:288
v_mfma_f32_16x16x32_bf16 v[240:243], v[76:79], a[72:75], v[240:243]
ds_read_b64_tr_b16 v[56:57], v120 offset:544
v_mfma_f32_16x16x32_bf16 v[240:243], v[80:83], a[76:79], v[240:243]
ds_read_b64_tr_b16 v[58:59], v120 offset:800
ds_read_b64_tr_b16 v[60:61], v120 offset:16928
v_mfma_f32_16x16x32_bf16 v[244:247], v[80:83], a[92:95], v[244:247]
buffer_load_dwordx4 v[152:155], v21, s[72:75], 0 offen offset:2048 sc1
v_mfma_f32_16x16x32_bf16 v[244:247], v[76:79], a[88:91], v[244:247]
ds_read_b64_tr_b16 v[62:63], v120 offset:17184
v_mfma_f32_16x16x32_bf16 v[244:247], v[72:75], a[84:87], v[244:247]
ds_read_b64_tr_b16 v[64:65], v120 offset:17440
v_mfma_f32_16x16x32_bf16 v[244:247], v[68:71], a[80:83], v[244:247]
s_waitcnt lgkmcnt(15)
ds_read_b64_tr_b16 v[66:67], v120 offset:17696
v_mfma_f32_16x16x32_bf16 v[252:255], v[84:87], a[80:83], v[252:255]
ds_read_b64_tr_b16 v[68:69], v120 offset:64
v_mfma_f32_16x16x32_bf16 v[252:255], v[88:91], a[84:87], v[252:255]
ds_read_b64_tr_b16 v[70:71], v120 offset:320
ds_read_b64_tr_b16 v[72:73], v120 offset:576
v_mfma_f32_16x16x32_bf16 v[252:255], v[92:95], a[88:91], v[252:255]
buffer_load_dwordx4 v[156:159], v21, s[72:75], 0 offen offset:3072 sc1
v_mfma_f32_16x16x32_bf16 v[252:255], v[96:99], a[92:95], v[252:255]
ds_read_b64_tr_b16 v[74:75], v120 offset:832
v_mfma_f32_16x16x32_bf16 v[248:251], v[96:99], a[76:79], v[248:251]
ds_read_b64_tr_b16 v[76:77], v120 offset:16960
v_mfma_f32_16x16x32_bf16 v[248:251], v[92:95], a[72:75], v[248:251]
ds_read_b64_tr_b16 v[78:79], v120 offset:17216
v_mfma_f32_16x16x32_bf16 v[248:251], v[88:91], a[68:71], v[248:251]
s_waitcnt vmcnt(9)
ds_read_b64_tr_b16 v[80:81], v120 offset:17472
v_mfma_f32_16x16x32_bf16 v[248:251], v[84:87], a[64:67], v[248:251]
s_waitcnt lgkmcnt(15)
ds_read_b64_tr_b16 v[82:83], v120 offset:17728
v_mfma_f32_16x16x32_bf16 v[192:195], v[36:39], a[96:99], v[192:195]
ds_read_b64_tr_b16 v[84:85], v120 offset:96
v_mfma_f32_16x16x32_bf16 v[192:195], v[40:43], a[100:103], v[192:195]
ds_read_b64_tr_b16 v[86:87], v120 offset:352
v_mfma_f32_16x16x32_bf16 v[192:195], v[44:47], a[104:107], v[192:195]
ds_read_b64_tr_b16 v[88:89], v120 offset:608
v_mfma_f32_16x16x32_bf16 v[192:195], v[48:51], a[108:111], v[192:195]
ds_read_b64_tr_b16 v[90:91], v120 offset:864
v_mfma_f32_16x16x32_bf16 v[196:199], v[48:51], a[124:127], v[196:199]
ds_read_b64_tr_b16 v[92:93], v120 offset:16992
v_mfma_f32_16x16x32_bf16 v[196:199], v[44:47], a[120:123], v[196:199]
ds_read_b64_tr_b16 v[94:95], v120 offset:17248
v_mfma_f32_16x16x32_bf16 v[196:199], v[40:43], a[116:119], v[196:199]
ds_read_b64_tr_b16 v[96:97], v120 offset:17504
v_mfma_f32_16x16x32_bf16 v[196:199], v[36:39], a[112:115], v[196:199]
s_waitcnt lgkmcnt(15)
ds_read_b64_tr_b16 v[98:99], v120 offset:17760
v_mfma_f32_16x16x32_bf16 v[200:203], v[52:55], a[96:99], v[200:203]
ds_read_b64_tr_b16 v[36:37], v120 offset:128
v_mfma_f32_16x16x32_bf16 v[200:203], v[56:59], a[100:103], v[200:203]
ds_read_b64_tr_b16 v[38:39], v120 offset:384
v_mfma_f32_16x16x32_bf16 v[200:203], v[60:63], a[104:107], v[200:203]
ds_read_b64_tr_b16 v[40:41], v120 offset:640
v_mfma_f32_16x16x32_bf16 v[200:203], v[64:67], a[108:111], v[200:203]
v_cvt_pk_bf16_f32 v160, v192, v193
v_cvt_pk_bf16_f32 v161, v194, v195
ds_read_b64_tr_b16 v[42:43], v120 offset:896
v_mfma_f32_16x16x32_bf16 v[204:207], v[64:67], a[124:127], v[204:207]
ds_read_b64_tr_b16 v[44:45], v120 offset:17024
v_mfma_f32_16x16x32_bf16 v[204:207], v[60:63], a[120:123], v[204:207]
v_cvt_pk_bf16_f32 v162, v196, v197
v_cvt_pk_bf16_f32 v163, v198, v199
ds_read_b64_tr_b16 v[46:47], v120 offset:17280
v_mfma_f32_16x16x32_bf16 v[204:207], v[56:59], a[116:119], v[204:207]
ds_read_b64_tr_b16 v[48:49], v120 offset:17536
ds_read_b64_tr_b16 v[50:51], v120 offset:17792
v_mfma_f32_16x16x32_bf16 v[204:207], v[52:55], a[112:115], v[204:207]
s_waitcnt lgkmcnt(15)
buffer_store_dwordx4 v[160:163], v20, s[12:15], 0 offen offset:0 sc1
v_mfma_f32_16x16x32_bf16 v[208:211], v[68:71], a[96:99], v[208:211]
ds_read_b64_tr_b16 v[52:53], v120 offset:160
ds_read_b64_tr_b16 v[54:55], v120 offset:416
v_mfma_f32_16x16x32_bf16 v[208:211], v[72:75], a[100:103], v[208:211]
ds_read_b64_tr_b16 v[56:57], v120 offset:672
v_mfma_f32_16x16x32_bf16 v[208:211], v[76:79], a[104:107], v[208:211]
ds_read_b64_tr_b16 v[58:59], v120 offset:928
v_mfma_f32_16x16x32_bf16 v[208:211], v[80:83], a[108:111], v[208:211]
v_cvt_pk_bf16_f32 v164, v200, v201
v_cvt_pk_bf16_f32 v165, v202, v203
ds_read_b64_tr_b16 v[60:61], v120 offset:17056
v_mfma_f32_16x16x32_bf16 v[212:215], v[80:83], a[124:127], v[212:215]
ds_read_b64_tr_b16 v[62:63], v120 offset:17312
v_mfma_f32_16x16x32_bf16 v[212:215], v[76:79], a[120:123], v[212:215]
v_cvt_pk_bf16_f32 v166, v204, v205
v_cvt_pk_bf16_f32 v167, v206, v207
ds_read_b64_tr_b16 v[64:65], v120 offset:17568
v_mfma_f32_16x16x32_bf16 v[212:215], v[72:75], a[116:119], v[212:215]
ds_read_b64_tr_b16 v[66:67], v120 offset:17824
v_mfma_f32_16x16x32_bf16 v[212:215], v[68:71], a[112:115], v[212:215]
s_waitcnt lgkmcnt(15)
buffer_store_dwordx4 v[164:167], v20, s[12:15], 0 offen offset:1024 sc1
v_mfma_f32_16x16x32_bf16 v[216:219], v[84:87], a[96:99], v[216:219]
ds_read_b64_tr_b16 v[68:69], v120 offset:192
ds_read_b64_tr_b16 v[70:71], v120 offset:448
v_mfma_f32_16x16x32_bf16 v[216:219], v[88:91], a[100:103], v[216:219]
ds_read_b64_tr_b16 v[72:73], v120 offset:704
v_mfma_f32_16x16x32_bf16 v[216:219], v[92:95], a[104:107], v[216:219]
ds_read_b64_tr_b16 v[74:75], v120 offset:960
v_mfma_f32_16x16x32_bf16 v[216:219], v[96:99], a[108:111], v[216:219]
v_cvt_pk_bf16_f32 v168, v208, v209
v_cvt_pk_bf16_f32 v169, v210, v211
ds_read_b64_tr_b16 v[76:77], v120 offset:17088
v_mfma_f32_16x16x32_bf16 v[220:223], v[96:99], a[124:127], v[220:223]
ds_read_b64_tr_b16 v[78:79], v120 offset:17344
v_mfma_f32_16x16x32_bf16 v[220:223], v[92:95], a[120:123], v[220:223]
v_cvt_pk_bf16_f32 v170, v212, v213
v_cvt_pk_bf16_f32 v171, v214, v215
ds_read_b64_tr_b16 v[80:81], v120 offset:17600
v_mfma_f32_16x16x32_bf16 v[220:223], v[88:91], a[116:119], v[220:223]
ds_read_b64_tr_b16 v[82:83], v120 offset:17856
v_mfma_f32_16x16x32_bf16 v[220:223], v[84:87], a[112:115], v[220:223]
s_waitcnt lgkmcnt(15)
buffer_store_dwordx4 v[168:171], v20, s[12:15], 0 offen offset:2048 sc1
v_mfma_f32_16x16x32_bf16 v[224:227], v[36:39], a[96:99], v[224:227]
ds_read_b64_tr_b16 v[84:85], v120 offset:224
ds_read_b64_tr_b16 v[86:87], v120 offset:480
v_mfma_f32_16x16x32_bf16 v[224:227], v[40:43], a[100:103], v[224:227]
ds_read_b64_tr_b16 v[88:89], v120 offset:736
v_mfma_f32_16x16x32_bf16 v[224:227], v[44:47], a[104:107], v[224:227]
ds_read_b64_tr_b16 v[90:91], v120 offset:992
v_mfma_f32_16x16x32_bf16 v[224:227], v[48:51], a[108:111], v[224:227]
v_cvt_pk_bf16_f32 v172, v216, v217
v_cvt_pk_bf16_f32 v173, v218, v219
ds_read_b64_tr_b16 v[92:93], v120 offset:17120
v_mfma_f32_16x16x32_bf16 v[228:231], v[48:51], a[124:127], v[228:231]
ds_read_b64_tr_b16 v[94:95], v120 offset:17376
v_mfma_f32_16x16x32_bf16 v[228:231], v[44:47], a[120:123], v[228:231]
v_cvt_pk_bf16_f32 v174, v220, v221
v_cvt_pk_bf16_f32 v175, v222, v223
ds_read_b64_tr_b16 v[96:97], v120 offset:17632
v_mfma_f32_16x16x32_bf16 v[228:231], v[40:43], a[116:119], v[228:231]
ds_read_b64_tr_b16 v[98:99], v120 offset:17888
v_mfma_f32_16x16x32_bf16 v[228:231], v[36:39], a[112:115], v[228:231]
s_waitcnt lgkmcnt(15)
buffer_store_dwordx4 v[172:175], v20, s[12:15], 0 offen offset:3072 sc1
v_mfma_f32_16x16x32_bf16 v[232:235], v[52:55], a[96:99], v[232:235]
v_mfma_f32_16x16x32_bf16 v[232:235], v[56:59], a[100:103], v[232:235]
v_mfma_f32_16x16x32_bf16 v[232:235], v[60:63], a[104:107], v[232:235]
v_mfma_f32_16x16x32_bf16 v[232:235], v[64:67], a[108:111], v[232:235]
v_cvt_pk_bf16_f32 v176, v224, v225
v_cvt_pk_bf16_f32 v177, v226, v227
v_mfma_f32_16x16x32_bf16 v[236:239], v[64:67], a[124:127], v[236:239]
global_load_dword v122, v121, s[76:77] sc1
v_mfma_f32_16x16x32_bf16 v[236:239], v[60:63], a[120:123], v[236:239]
v_cvt_pk_bf16_f32 v178, v228, v229
v_cvt_pk_bf16_f32 v179, v230, v231
v_mfma_f32_16x16x32_bf16 v[236:239], v[56:59], a[116:119], v[236:239]
v_mfma_f32_16x16x32_bf16 v[236:239], v[52:55], a[112:115], v[236:239]
s_waitcnt lgkmcnt(12)
buffer_store_dwordx4 v[176:179], v21, s[12:15], 0 offen offset:0 sc1
v_mfma_f32_16x16x32_bf16 v[240:243], v[68:71], a[96:99], v[240:243]
s_waitcnt lgkmcnt(10)
v_mfma_f32_16x16x32_bf16 v[240:243], v[72:75], a[100:103], v[240:243]
s_waitcnt lgkmcnt(8)
v_mfma_f32_16x16x32_bf16 v[240:243], v[76:79], a[104:107], v[240:243]
v_mfma_f32_16x16x32_bf16 v[240:243], v[80:83], a[108:111], v[240:243]
v_cvt_pk_bf16_f32 v180, v232, v233
v_cvt_pk_bf16_f32 v181, v234, v235
v_mfma_f32_16x16x32_bf16 v[244:247], v[80:83], a[124:127], v[244:247]
v_mfma_f32_16x16x32_bf16 v[244:247], v[76:79], a[120:123], v[244:247]
v_cvt_pk_bf16_f32 v182, v236, v237
v_cvt_pk_bf16_f32 v183, v238, v239
v_mfma_f32_16x16x32_bf16 v[244:247], v[72:75], a[116:119], v[244:247]
v_mfma_f32_16x16x32_bf16 v[244:247], v[68:71], a[112:115], v[244:247]
s_waitcnt lgkmcnt(4)
buffer_store_dwordx4 v[180:183], v21, s[12:15], 0 offen offset:1024 sc1
v_mfma_f32_16x16x32_bf16 v[248:251], v[84:87], a[96:99], v[248:251]
s_waitcnt lgkmcnt(2)
v_mfma_f32_16x16x32_bf16 v[248:251], v[88:91], a[100:103], v[248:251]
s_waitcnt lgkmcnt(0)
v_mfma_f32_16x16x32_bf16 v[248:251], v[92:95], a[104:107], v[248:251]
v_mfma_f32_16x16x32_bf16 v[248:251], v[96:99], a[108:111], v[248:251]
v_cvt_pk_bf16_f32 v184, v240, v241
v_cvt_pk_bf16_f32 v185, v242, v243
v_mfma_f32_16x16x32_bf16 v[252:255], v[96:99], a[124:127], v[252:255]
v_mfma_f32_16x16x32_bf16 v[252:255], v[92:95], a[120:123], v[252:255]
v_cvt_pk_bf16_f32 v186, v244, v245
v_cvt_pk_bf16_f32 v187, v246, v247
v_mfma_f32_16x16x32_bf16 v[252:255], v[88:91], a[116:119], v[252:255]
v_mfma_f32_16x16x32_bf16 v[252:255], v[84:87], a[112:115], v[252:255]
buffer_store_dwordx4 v[184:187], v21, s[12:15], 0 offen offset:2048 sc1
s_nop 2
v_cvt_pk_bf16_f32 v188, v248, v249
v_cvt_pk_bf16_f32 v189, v250, v251
s_nop 1
v_cvt_pk_bf16_f32 v190, v252, v253
v_cvt_pk_bf16_f32 v191, v254, v255
s_cmp_lg_u32 s30, 0
s_cbranch_scc1 X_RECV
buffer_store_dwordx4 v[188:191], v21, s[68:71], 0 offen offset:3072 sc1
v_mov_b32 v25, 1
s_waitcnt vmcnt(0)
s_barrier
s_cmp_lg_u32 s40, 0
s_cbranch_scc1 X_DONE
s_mov_b64 exec, 1
global_store_dword v121, v25, s[76:77] sc1
s_mov_b64 exec, -1
s_branch X_DONE
X_RECV:
s_waitcnt vmcnt(0)
s_cmp_lg_u32 s31, 0
s_cbranch_scc1 X_HAVE
v_readfirstlane_b32 s61, v122
s_nop 0
s_cmp_eq_u32 s61, 1
s_cbranch_scc1 X_POLLED
X_POLL:
global_load_dword v122, v121, s[76:77] sc1
s_waitcnt vmcnt(0)
v_readfirstlane_b32 s61, v122
s_nop 0
s_cmp_eq_u32 s61, 1
s_cbranch_scc1 X_POLLED
s_cmp_eq_u32 s28, 0
s_cbranch_scc1 X_POLLED
s_sub_u32 s28, s28, 1
s_sleep 1
s_branch X_POLL
X_POLLED:
buffer_load_dwordx4 v[128:131], v20, s[68:71], 0 offen offset:0 sc1
buffer_load_dwordx4 v[132:135], v20, s[68:71], 0 offen offset:1024 sc1
buffer_load_dwordx4 v[136:139], v20, s[68:71], 0 offen offset:2048 sc1
buffer_load_dwordx4 v[140:143], v20, s[68:71], 0 offen offset:3072 sc1
buffer_load_dwordx4 v[144:147], v21, s[68:71], 0 offen offset:0 sc1
buffer_load_dwordx4 v[148:151], v21, s[68:71], 0 offen offset:1024 sc1
buffer_load_dwordx4 v[152:155], v21, s[68:71], 0 offen offset:2048 sc1
buffer_load_dwordx4 v[156:159], v21, s[68:71], 0 offen offset:3072 sc1
X_HAVE:
s_lshl_b32 s62, s92, 7
s_lshl_b32 s61, s40, 5
s_add_u32 s61, s61, s62
v_and_b32 v24, 15, v0
v_add_u32 v24, s61, v24
v_lshlrev_b32 v24, 11, v24
v_bfe_u32 v25, v0, 4, 2
v_lshl_add_u32 v24, v25, 4, v24
v_add_u32 v25, 32768, v24
v_lshlrev_b32 v192, 16, v160
v_and_b32 v193, 0xffff0000, v160
v_lshlrev_b32 v194, 16, v161
v_and_b32 v195, 0xffff0000, v161
v_lshlrev_b32 v200, 16, v164
v_and_b32 v201, 0xffff0000, v164
v_lshlrev_b32 v202, 16, v165
v_and_b32 v203, 0xffff0000, v165
s_waitcnt vmcnt(6)
v_lshlrev_b32 v36, 16, v128
v_and_b32 v37, 0xffff0000, v128
v_lshlrev_b32 v38, 16, v129
v_and_b32 v39, 0xffff0000, v129
v_lshlrev_b32 v40, 16, v132
v_and_b32 v41, 0xffff0000, v132
v_lshlrev_b32 v42, 16, v133
v_and_b32 v43, 0xffff0000, v133
v_pk_add_f32 v[192:193], v[192:193], v[36:37]
v_pk_add_f32 v[194:195], v[194:195], v[38:39]
v_pk_add_f32 v[200:201], v[200:201], v[40:41]
v_pk_add_f32 v[202:203], v[202:203], v[42:43]
v_cvt_pk_bf16_f32 v28, v192, v193
v_cvt_pk_bf16_f32 v29, v194, v195
v_cvt_pk_bf16_f32 v30, v200, v201
v_cvt_pk_bf16_f32 v31, v202, v203
s_nop 0
v_permlane32_swap_b32 v28, v30
v_permlane32_swap_b32 v29, v31
s_nop 0
v_permlane16_swap_b32 v28, v30
v_permlane16_swap_b32 v29, v31
buffer_store_dwordx4 v[28:31], v24, s[64:67], 0 offen offset:0 sc1
v_lshlrev_b32 v196, 16, v162
v_and_b32 v197, 0xffff0000, v162
v_lshlrev_b32 v198, 16, v163
v_and_b32 v199, 0xffff0000, v163
v_lshlrev_b32 v204, 16, v166
v_and_b32 v205, 0xffff0000, v166
v_lshlrev_b32 v206, 16, v167
v_and_b32 v207, 0xffff0000, v167
s_waitcnt vmcnt(7)
v_lshlrev_b32 v44, 16, v130
v_and_b32 v45, 0xffff0000, v130
v_lshlrev_b32 v46, 16, v131
v_and_b32 v47, 0xffff0000, v131
v_lshlrev_b32 v48, 16, v134
v_and_b32 v49, 0xffff0000, v134
v_lshlrev_b32 v50, 16, v135
v_and_b32 v51, 0xffff0000, v135
v_pk_add_f32 v[196:197], v[196:197], v[44:45]
v_pk_add_f32 v[198:199], v[198:199], v[46:47]
v_pk_add_f32 v[204:205], v[204:205], v[48:49]
v_pk_add_f32 v[206:207], v[206:207], v[50:51]
v_cvt_pk_bf16_f32 v32, v196, v197
v_cvt_pk_bf16_f32 v33, v198, v199
v_cvt_pk_bf16_f32 v34, v204, v205
v_cvt_pk_bf16_f32 v35, v206, v207
s_nop 0
v_permlane32_swap_b32 v32, v34
v_permlane32_swap_b32 v33, v35
s_nop 0
v_permlane16_swap_b32 v32, v34
v_permlane16_swap_b32 v33, v35
buffer_store_dwordx4 v[32:35], v25, s[64:67], 0 offen offset:0 sc1
v_lshlrev_b32 v208, 16, v168
v_and_b32 v209, 0xffff0000, v168
v_lshlrev_b32 v210, 16, v169
v_and_b32 v211, 0xffff0000, v169
v_lshlrev_b32 v216, 16, v172
v_and_b32 v217, 0xffff0000, v172
v_lshlrev_b32 v218, 16, v173
v_and_b32 v219, 0xffff0000, v173
s_waitcnt vmcnt(6)
v_lshlrev_b32 v36, 16, v136
v_and_b32 v37, 0xffff0000, v136
v_lshlrev_b32 v38, 16, v137
v_and_b32 v39, 0xffff0000, v137
v_lshlrev_b32 v40, 16, v140
v_and_b32 v41, 0xffff0000, v140
v_lshlrev_b32 v42, 16, v141
v_and_b32 v43, 0xffff0000, v141
v_pk_add_f32 v[208:209], v[208:209], v[36:37]
v_pk_add_f32 v[210:211], v[210:211], v[38:39]
v_pk_add_f32 v[216:217], v[216:217], v[40:41]
v_pk_add_f32 v[218:219], v[218:219], v[42:43]
v_cvt_pk_bf16_f32 v28, v208, v209
v_cvt_pk_bf16_f32 v29, v210, v211
v_cvt_pk_bf16_f32 v30, v216, v217
v_cvt_pk_bf16_f32 v31, v218, v219
s_nop 0
v_permlane32_swap_b32 v28, v30
v_permlane32_swap_b32 v29, v31
s_nop 0
v_permlane16_swap_b32 v28, v30
v_permlane16_swap_b32 v29, v31
buffer_store_dwordx4 v[28:31], v24, s[64:67], 0 offen offset:64 sc1
v_lshlrev_b32 v212, 16, v170
v_and_b32 v213, 0xffff0000, v170
v_lshlrev_b32 v214, 16, v171
v_and_b32 v215, 0xffff0000, v171
v_lshlrev_b32 v220, 16, v174
v_and_b32 v221, 0xffff0000, v174
v_lshlrev_b32 v222, 16, v175
v_and_b32 v223, 0xffff0000, v175
s_waitcnt vmcnt(7)
v_lshlrev_b32 v44, 16, v138
v_and_b32 v45, 0xffff0000, v138
v_lshlrev_b32 v46, 16, v139
v_and_b32 v47, 0xffff0000, v139
v_lshlrev_b32 v48, 16, v142
v_and_b32 v49, 0xffff0000, v142
v_lshlrev_b32 v50, 16, v143
v_and_b32 v51, 0xffff0000, v143
v_pk_add_f32 v[212:213], v[212:213], v[44:45]
v_pk_add_f32 v[214:215], v[214:215], v[46:47]
v_pk_add_f32 v[220:221], v[220:221], v[48:49]
v_pk_add_f32 v[222:223], v[222:223], v[50:51]
v_cvt_pk_bf16_f32 v32, v212, v213
v_cvt_pk_bf16_f32 v33, v214, v215
v_cvt_pk_bf16_f32 v34, v220, v221
v_cvt_pk_bf16_f32 v35, v222, v223
s_nop 0
v_permlane32_swap_b32 v32, v34
v_permlane32_swap_b32 v33, v35
s_nop 0
v_permlane16_swap_b32 v32, v34
v_permlane16_swap_b32 v33, v35
buffer_store_dwordx4 v[32:35], v25, s[64:67], 0 offen offset:64 sc1
v_lshlrev_b32 v224, 16, v176
v_and_b32 v225, 0xffff0000, v176
v_lshlrev_b32 v226, 16, v177
v_and_b32 v227, 0xffff0000, v177
v_lshlrev_b32 v232, 16, v180
v_and_b32 v233, 0xffff0000, v180
v_lshlrev_b32 v234, 16, v181
v_and_b32 v235, 0xffff0000, v181
s_waitcnt vmcnt(6)
v_lshlrev_b32 v36, 16, v144
v_and_b32 v37, 0xffff0000, v144
v_lshlrev_b32 v38, 16, v145
v_and_b32 v39, 0xffff0000, v145
v_lshlrev_b32 v40, 16, v148
v_and_b32 v41, 0xffff0000, v148
v_lshlrev_b32 v42, 16, v149
v_and_b32 v43, 0xffff0000, v149
v_pk_add_f32 v[224:225], v[224:225], v[36:37]
v_pk_add_f32 v[226:227], v[226:227], v[38:39]
v_pk_add_f32 v[232:233], v[232:233], v[40:41]
v_pk_add_f32 v[234:235], v[234:235], v[42:43]
v_cvt_pk_bf16_f32 v28, v224, v225
v_cvt_pk_bf16_f32 v29, v226, v227
v_cvt_pk_bf16_f32 v30, v232, v233
v_cvt_pk_bf16_f32 v31, v234, v235
s_nop 0
v_permlane32_swap_b32 v28, v30
v_permlane32_swap_b32 v29, v31
s_nop 0
v_permlane16_swap_b32 v28, v30
v_permlane16_swap_b32 v29, v31
buffer_store_dwordx4 v[28:31], v24, s[64:67], 0 offen offset:128 sc1
v_lshlrev_b32 v228, 16, v178
v_and_b32 v229, 0xffff0000, v178
v_lshlrev_b32 v230, 16, v179
v_and_b32 v231, 0xffff0000, v179
v_lshlrev_b32 v236, 16, v182
v_and_b32 v237, 0xffff0000, v182
v_lshlrev_b32 v238, 16, v183
v_and_b32 v239, 0xffff0000, v183
s_waitcnt vmcnt(7)
v_lshlrev_b32 v44, 16, v146
v_and_b32 v45, 0xffff0000, v146
v_lshlrev_b32 v46, 16, v147
v_and_b32 v47, 0xffff0000, v147
v_lshlrev_b32 v48, 16, v150
v_and_b32 v49, 0xffff0000, v150
v_lshlrev_b32 v50, 16, v151
v_and_b32 v51, 0xffff0000, v151
v_pk_add_f32 v[228:229], v[228:229], v[44:45]
v_pk_add_f32 v[230:231], v[230:231], v[46:47]
v_pk_add_f32 v[236:237], v[236:237], v[48:49]
v_pk_add_f32 v[238:239], v[238:239], v[50:51]
v_cvt_pk_bf16_f32 v32, v228, v229
v_cvt_pk_bf16_f32 v33, v230, v231
v_cvt_pk_bf16_f32 v34, v236, v237
v_cvt_pk_bf16_f32 v35, v238, v239
s_nop 0
v_permlane32_swap_b32 v32, v34
v_permlane32_swap_b32 v33, v35
s_nop 0
v_permlane16_swap_b32 v32, v34
v_permlane16_swap_b32 v33, v35
buffer_store_dwordx4 v[32:35], v25, s[64:67], 0 offen offset:128 sc1
v_lshlrev_b32 v240, 16, v184
v_and_b32 v241, 0xffff0000, v184
v_lshlrev_b32 v242, 16, v185
v_and_b32 v243, 0xffff0000, v185
v_lshlrev_b32 v248, 16, v188
v_and_b32 v249, 0xffff0000, v188
v_lshlrev_b32 v250, 16, v189
v_and_b32 v251, 0xffff0000, v189
s_waitcnt vmcnt(6)
v_lshlrev_b32 v36, 16, v152
v_and_b32 v37, 0xffff0000, v152
v_lshlrev_b32 v38, 16, v153
v_and_b32 v39, 0xffff0000, v153
v_lshlrev_b32 v40, 16, v156
v_and_b32 v41, 0xffff0000, v156
v_lshlrev_b32 v42, 16, v157
v_and_b32 v43, 0xffff0000, v157
v_pk_add_f32 v[240:241], v[240:241], v[36:37]
v_pk_add_f32 v[242:243], v[242:243], v[38:39]
v_pk_add_f32 v[248:249], v[248:249], v[40:41]
v_pk_add_f32 v[250:251], v[250:251], v[42:43]
v_cvt_pk_bf16_f32 v28, v240, v241
v_cvt_pk_bf16_f32 v29, v242, v243
v_cvt_pk_bf16_f32 v30, v248, v249
v_cvt_pk_bf16_f32 v31, v250, v251
s_nop 0
v_permlane32_swap_b32 v28, v30
v_permlane32_swap_b32 v29, v31
s_nop 0
v_permlane16_swap_b32 v28, v30
v_permlane16_swap_b32 v29, v31
buffer_store_dwordx4 v[28:31], v24, s[64:67], 0 offen offset:192 sc1
v_lshlrev_b32 v244, 16, v186
v_and_b32 v245, 0xffff0000, v186
v_lshlrev_b32 v246, 16, v187
v_and_b32 v247, 0xffff0000, v187
v_lshlrev_b32 v252, 16, v190
v_and_b32 v253, 0xffff0000, v190
v_lshlrev_b32 v254, 16, v191
v_and_b32 v255, 0xffff0000, v191
s_waitcnt vmcnt(7)
v_lshlrev_b32 v44, 16, v154
v_and_b32 v45, 0xffff0000, v154
v_lshlrev_b32 v46, 16, v155
v_and_b32 v47, 0xffff0000, v155
v_lshlrev_b32 v48, 16, v158
v_and_b32 v49, 0xffff0000, v158
v_lshlrev_b32 v50, 16, v159
v_and_b32 v51, 0xffff0000, v159
v_pk_add_f32 v[244:245], v[244:245], v[44:45]
v_pk_add_f32 v[246:247], v[246:247], v[46:47]
v_pk_add_f32 v[252:253], v[252:253], v[48:49]
v_pk_add_f32 v[254:255], v[254:255], v[50:51]
v_cvt_pk_bf16_f32 v32, v244, v245
v_cvt_pk_bf16_f32 v33, v246, v247
v_cvt_pk_bf16_f32 v34, v252, v253
v_cvt_pk_bf16_f32 v35, v254, v255
s_nop 0
v_permlane32_swap_b32 v32, v34
v_permlane32_swap_b32 v33, v35
s_nop 0
v_permlane16_swap_b32 v32, v34
v_permlane16_swap_b32 v33, v35
buffer_store_dwordx4 v[32:35], v25, s[64:67], 0 offen offset:192 sc1
X_DONE:
K1_END:
s_endpgm
PUB1:
s_cmp_eq_u32 s61, 0
s_cbranch_scc1 PUB1_B
v_mov_b32 v7, 163836
ds_read_b32 v8, v7
s_branch PUB1_RET
PUB1_B:
v_readfirstlane_b32 s61, v8
s_nop 0
s_cmp_lg_u32 s61, 0
s_cbranch_scc1 PUB1_RET
s_lshl_b32 s63, s93, 2
v_mov_b32 v122, s63
v_mov_b32 v123, 1
s_mov_b64 exec, 1
global_atomic_add v122, v123, s[80:81] sc1
s_mov_b64 exec, -1
s_branch PUB1_RET
TICKET2:
s_waitcnt vmcnt(17)
s_mov_b64 exec, 1
ds_write_b32 v7, v122
s_mov_b64 exec, -1
s_waitcnt lgkmcnt(0)
s_branch TICKET2_RET
TICKET:
v_mov_b32 v123, 1
s_mov_b64 exec, 1
global_atomic_add v122, v121, v123, s[76:77] offset:128 sc0 sc1
s_mov_b64 exec, -1
s_branch TICKET_RET
PUB2:
s_lshl_b32 s63, s93, 2
v_mov_b32 v122, s63
v_mov_b32 v123, 0x10000
s_mov_b64 exec, 1
global_atomic_add v122, v123, s[80:81] sc1
s_mov_b64 exec, -1
s_branch PUB2_RET
SPIN1:
s_cmp_eq_u32 s28, 0
s_cbranch_scc1 SPIN1_RET
s_sub_u32 s28, s28, 1
s_sleep 2
global_load_dwordx2 v[122:123], v121, s[80:81] sc1
s_waitcnt vmcnt(0)
v_readfirstlane_b32 s61, v122
v_readfirstlane_b32 s62, v123
s_cmp_eq_u32 s93, 0
s_cselect_b32 s61, s61, s62
s_and_b32 s61, s61, 0xfff8
s_cmp_eq_u32 s61, 0
s_cbranch_scc1 SPIN1
s_branch SPIN1_RET
SPIN2:
s_cmp_eq_u32 s28, 0
s_cbranch_scc1 SPIN2_RET
s_sub_u32 s28, s28, 1
s_sleep 2
global_load_dwordx2 v[122:123], v121, s[80:81] sc1
s_waitcnt vmcnt(0)
v_readfirstlane_b32 s61, v122
v_readfirstlane_b32 s62, v123
s_and_b32 s63, s61, 0xffff
s_and_b32 s31, s62, 0xffff
s_cmp_eq_u32 s93, 0
s_cselect_b32 s61, s61, s62
s_lshr_b32 s61, s61, 16
s_min_u32 s63, s63, s31
s_min_u32 s61, s61, s63
s_cmp_lt_u32 s61, 8
s_cbranch_scc1 SPIN2
s_branch SPIN2_RET
SLOW:
s_mov_b32 s47, s62
s_mov_b32 s52, 65536
buffer_store_dwordx4 v[128:131], v6, s[20:23], s52 offen offset:0 sc1
buffer_store_dwordx4 v[132:135], v6, s[20:23], s52 offen offset:1024 sc1
buffer_store_dwordx4 v[136:139], v6, s[20:23], s52 offen offset:2048 sc1
buffer_store_dwordx4 v[140:143], v6, s[20:23], s52 offen offset:3072 sc1
s_mov_b32 s52, 69632
buffer_store_dwordx4 v[160:163], v6, s[20:23], s52 offen offset:0 sc1
buffer_store_dwordx4 v[164:167], v6, s[20:23], s52 offen offset:1024 sc1
buffer_store_dwordx4 v[168:171], v6, s[20:23], s52 offen offset:2048 sc1
buffer_store_dwordx4 v[172:175], v6, s[20:23], s52 offen offset:3072 sc1
s_mov_b32 s52, 73728
buffer_store_dwordx4 v[144:147], v6, s[20:23], s52 offen offset:0 sc1
buffer_store_dwordx4 v[148:151], v6, s[20:23], s52 offen offset:1024 sc1
buffer_store_dwordx4 v[152:155], v6, s[20:23], s52 offen offset:2048 sc1
buffer_store_dwordx4 v[156:159], v6, s[20:23], s52 offen offset:3072 sc1
s_mov_b32 s52, 77824
buffer_store_dwordx4 v[176:179], v6, s[20:23], s52 offen offset:0 sc1
buffer_store_dwordx4 v[180:183], v6, s[20:23], s52 offen offset:1024 sc1
buffer_store_dwordx4 v[184:187], v6, s[20:23], s52 offen offset:2048 sc1
buffer_store_dwordx4 v[188:191], v6, s[20:23], s52 offen offset:3072 sc1
s_bitcmp1_b32 s47, 0
s_cbranch_scc1 SLOW_T0
SLOW_T1:
s_mov_b32 s48, 1
s_and_b32 s47, s47, 1
v_accvgpr_mov_b32 a128, a192
v_accvgpr_mov_b32 a129, a193
v_accvgpr_mov_b32 a130, a194
v_accvgpr_mov_b32 a131, a195
v_accvgpr_mov_b32 a132, a196
v_accvgpr_mov_b32 a133, a197
v_accvgpr_mov_b32 a134, a198
v_accvgpr_mov_b32 a135, a199
v_accvgpr_mov_b32 a136, a200
v_accvgpr_mov_b32 a137, a201
v_accvgpr_mov_b32 a138, a202
v_accvgpr_mov_b32 a139, a203
v_accvgpr_mov_b32 a140, a204
v_accvgpr_mov_b32 a141, a205
v_accvgpr_mov_b32 a142, a206
v_accvgpr_mov_b32 a143, a207
v_accvgpr_mov_b32 a144, a208
v_accvgpr_mov_b32 a145, a209
v_accvgpr_mov_b32 a146, a210
v_accvgpr_mov_b32 a147, a211
v_accvgpr_mov_b32 a148, a212
v_accvgpr_mov_b32 a149, a213
v_accvgpr_mov_b32 a150, a214
v_accvgpr_mov_b32 a151, a215
v_accvgpr_mov_b32 a152, a216
v_accvgpr_mov_b32 a153, a217
v_accvgpr_mov_b32 a154, a218
v_accvgpr_mov_b32 a155, a219
v_accvgpr_mov_b32 a156, a220
v_accvgpr_mov_b32 a157, a221
v_accvgpr_mov_b32 a158, a222
v_accvgpr_mov_b32 a159, a223
v_accvgpr_mov_b32 a160, a224
v_accvgpr_mov_b32 a161, a225
v_accvgpr_mov_b32 a162, a226
v_accvgpr_mov_b32 a163, a227
v_accvgpr_mov_b32 a164, a228
v_accvgpr_mov_b32 a165, a229
v_accvgpr_mov_b32 a166, a230
v_accvgpr_mov_b32 a167, a231
v_accvgpr_mov_b32 a168, a232
v_accvgpr_mov_b32 a169, a233
v_accvgpr_mov_b32 a170, a234
v_accvgpr_mov_b32 a171, a235
v_accvgpr_mov_b32 a172, a236
v_accvgpr_mov_b32 a173, a237
v_accvgpr_mov_b32 a174, a238
v_accvgpr_mov_b32 a175, a239
v_accvgpr_mov_b32 a176, a240
v_accvgpr_mov_b32 a177, a241
v_accvgpr_mov_b32 a178, a242
v_accvgpr_mov_b32 a179, a243
v_accvgpr_mov_b32 a180, a244
v_accvgpr_mov_b32 a181, a245
v_accvgpr_mov_b32 a182, a246
v_accvgpr_mov_b32 a183, a247
v_accvgpr_mov_b32 a184, a248
v_accvgpr_mov_b32 a185, a249
v_accvgpr_mov_b32 a186, a250
v_accvgpr_mov_b32 a187, a251
v_accvgpr_mov_b32 a188, a252
v_accvgpr_mov_b32 a189, a253
v_accvgpr_mov_b32 a190, a254
v_accvgpr_mov_b32 a191, a255
s_branch SLOW_TASK
SLOW_T0:
s_mov_b32 s48, 0
SLOW_TASK:
s_waitcnt vmcnt(0) lgkmcnt(0)
s_barrier
s_lshl_b32 s61, s48, 2
s_lshr_b32 s49, s56, s61
s_lshl_b32 s61, s48, 18
s_add_u32 s50, s35, s61
v_mov_b32 v128, 0
v_mov_b32 v129, 0
v_mov_b32 v130, 0
v_mov_b32 v131, 0
v_mov_b32 v132, 0
v_mov_b32 v133, 0
v_mov_b32 v134, 0
v_mov_b32 v135, 0
v_mov_b32 v136, 0
v_mov_b32 v137, 0
v_mov_b32 v138, 0
v_mov_b32 v139, 0
v_mov_b32 v140, 0
v_mov_b32 v141, 0
v_mov_b32 v142, 0
v_mov_b32 v143, 0
v_mov_b32 v144, 0
v_mov_b32 v145, 0
v_mov_b32 v146, 0
v_mov_b32 v147, 0
v_mov_b32 v148, 0
v_mov_b32 v149, 0
v_mov_b32 v150, 0
v_mov_b32 v151, 0
v_mov_b32 v152, 0
v_mov_b32 v153, 0
v_mov_b32 v154, 0
v_mov_b32 v155, 0
v_mov_b32 v156, 0
v_mov_b32 v157, 0
v_mov_b32 v158, 0
v_mov_b32 v159, 0
v_mov_b32 v160, 0
v_mov_b32 v161, 0
v_mov_b32 v162, 0
v_mov_b32 v163, 0
v_mov_b32 v164, 0
v_mov_b32 v165, 0
v_mov_b32 v166, 0
v_mov_b32 v167, 0
v_mov_b32 v168, 0
v_mov_b32 v169, 0
v_mov_b32 v170, 0
v_mov_b32 v171, 0
v_mov_b32 v172, 0
v_mov_b32 v173, 0
v_mov_b32 v174, 0
v_mov_b32 v175, 0
v_mov_b32 v176, 0
v_mov_b32 v177, 0
v_mov_b32 v178, 0
v_mov_b32 v179, 0
v_mov_b32 v180, 0
v_mov_b32 v181, 0
v_mov_b32 v182, 0
v_mov_b32 v183, 0
v_mov_b32 v184, 0
v_mov_b32 v185, 0
v_mov_b32 v186, 0
v_mov_b32 v187, 0
v_mov_b32 v188, 0
v_mov_b32 v189, 0
v_mov_b32 v190, 0
v_mov_b32 v191, 0
v_mov_b32 v192, 0
v_mov_b32 v193, 0
v_mov_b32 v194, 0
v_mov_b32 v195, 0
v_mov_b32 v196, 0
v_mov_b32 v197, 0
v_mov_b32 v198, 0
v_mov_b32 v199, 0
v_mov_b32 v200, 0
v_mov_b32 v201, 0
v_mov_b32 v202, 0
v_mov_b32 v203, 0
v_mov_b32 v204, 0
v_mov_b32 v205, 0
v_mov_b32 v206, 0
v_mov_b32 v207, 0
v_mov_b32 v208, 0
v_mov_b32 v209, 0
v_mov_b32 v210, 0
v_mov_b32 v211, 0
v_mov_b32 v212, 0
v_mov_b32 v213, 0
v_mov_b32 v214, 0
v_mov_b32 v215, 0
v_mov_b32 v216, 0
v_mov_b32 v217, 0
v_mov_b32 v218, 0
v_mov_b32 v219, 0
v_mov_b32 v220, 0
v_mov_b32 v221, 0
v_mov_b32 v222, 0
v_mov_b32 v223, 0
v_mov_b32 v224, 0
v_mov_b32 v225, 0
v_mov_b32 v226, 0
v_mov_b32 v227, 0
v_mov_b32 v228, 0
v_mov_b32 v229, 0
v_mov_b32 v230, 0
v_mov_b32 v231, 0
v_mov_b32 v232, 0
v_mov_b32 v233, 0
v_mov_b32 v234, 0
v_mov_b32 v235, 0
v_mov_b32 v236, 0
v_mov_b32 v237, 0
v_mov_b32 v238, 0
v_mov_b32 v239, 0
v_mov_b32 v240, 0
v_mov_b32 v241, 0
v_mov_b32 v242, 0
v_mov_b32 v243, 0
v_mov_b32 v244, 0
v_mov_b32 v245, 0
v_mov_b32 v246, 0
v_mov_b32 v247, 0
v_mov_b32 v248, 0
v_mov_b32 v249, 0
v_mov_b32 v250, 0
v_mov_b32 v251, 0
v_mov_b32 v252, 0
v_mov_b32 v253, 0
v_mov_b32 v254, 0
v_mov_b32 v255, 0
v_mov_b32 v20, 0
v_mov_b32 v21, 0
v_mov_b32 v22, 0
v_mov_b32 v23, 0
v_mov_b32 v24, 0
v_mov_b32 v25, 0
v_mov_b32 v26, 0
v_mov_b32 v27, 0
v_mov_b32 v28, 0
v_mov_b32 v29, 0
v_mov_b32 v30, 0
v_mov_b32 v31, 0
v_mov_b32 v32, 0
v_mov_b32 v33, 0
v_mov_b32 v34, 0
v_mov_b32 v35, 0
v_mov_b32 v10, 0xff800000
v_mov_b32 v11, 0xff800000
v_mov_b32 v12, 0xff800000
v_mov_b32 v13, 0xff800000
v_mov_b32 v4, v2
v_mov_b32 v5, v3
s_mov_b32 s51, 16
SLOW_LOOP:
s_add_u32 m0, s43, 0
s_nop 0
buffer_load_dwordx4 v1, s[12:15], s50 offen offset:0 nt lds
s_add_u32 m0, s43, 32
s_nop 0
buffer_load_dwordx4 v1, s[12:15], s50 offen offset:1024 nt lds
s_add_u32 m0, s43, 64
s_nop 0
buffer_load_dwordx4 v1, s[12:15], s50 offen offset:2048 nt lds
s_add_u32 m0, s43, 96
s_nop 0
buffer_load_dwordx4 v1, s[12:15], s50 offen offset:3072 nt lds
s_add_u32 m0, s43, 67584
s_nop 0
buffer_load_dwordx4 v1, s[16:19], s50 offen offset:0 nt lds
s_add_u32 m0, s43, 67616
s_nop 0
buffer_load_dwordx4 v1, s[16:19], s50 offen offset:1024 nt lds
s_add_u32 m0, s43, 67648
s_nop 0
buffer_load_dwordx4 v1, s[16:19], s50 offen offset:2048 nt lds
s_add_u32 m0, s43, 67680
s_nop 0
buffer_load_dwordx4 v1, s[16:19], s50 offen offset:3072 nt lds
s_add_u32 s50, s50, 16384
s_waitcnt vmcnt(0)
s_barrier
ds_read_b128 a[0:3], v4 offset:0
ds_read_b128 a[4:7], v4 offset:64
ds_read_b128 a[8:11], v4 offset:128
ds_read_b128 a[12:15], v4 offset:192
ds_read_b128 a[16:19], v4 offset:256
ds_read_b128 a[20:23], v4 offset:320
ds_read_b128 a[24:27], v4 offset:384
ds_read_b128 a[28:31], v4 offset:448
ds_read_b128 a[32:35], v4 offset:512
ds_read_b128 a[36:39], v4 offset:576
ds_read_b128 a[40:43], v4 offset:640
ds_read_b128 a[44:47], v4 offset:704
ds_read_b128 a[48:51], v4 offset:768
ds_read_b128 a[52:55], v4 offset:832
ds_read_b128 a[56:59], v4 offset:896
ds_read_b128 a[60:63], v4 offset:960
s_waitcnt lgkmcnt(0)
ds_read_b64_tr_b16 a[64:65], v5 offset:0
ds_read_b64_tr_b16 a[66:67], v5 offset:256
ds_read_b64_tr_b16 a[68:69], v5 offset:512
ds_read_b64_tr_b16 a[70:71], v5 offset:768
ds_read_b64_tr_b16 a[72:73], v5 offset:32
ds_read_b64_tr_b16 a[74:75], v5 offset:288
ds_read_b64_tr_b16 a[76:77], v5 offset:544
ds_read_b64_tr_b16 a[78:79], v5 offset:800
ds_read_b64_tr_b16 a[80:81], v5 offset:64
ds_read_b64_tr_b16 a[82:83], v5 offset:320
ds_read_b64_tr_b16 a[84:85], v5 offset:576
ds_read_b64_tr_b16 a[86:87], v5 offset:832
ds_read_b64_tr_b16 a[88:89], v5 offset:96
ds_read_b64_tr_b16 a[90:91], v5 offset:352
ds_read_b64_tr_b16 a[92:93], v5 offset:608
ds_read_b64_tr_b16 a[94:95], v5 offset:864
s_waitcnt lgkmcnt(0)
ds_read_b64_tr_b16 a[96:97], v5 offset:128
ds_read_b64_tr_b16 a[98:99], v5 offset:384
ds_read_b64_tr_b16 a[100:101], v5 offset:640
ds_read_b64_tr_b16 a[102:103], v5 offset:896
ds_read_b64_tr_b16 a[104:105], v5 offset:160
ds_read_b64_tr_b16 a[106:107], v5 offset:416
ds_read_b64_tr_b16 a[108:109], v5 offset:672
ds_read_b64_tr_b16 a[110:111], v5 offset:928
ds_read_b64_tr_b16 a[112:113], v5 offset:192
ds_read_b64_tr_b16 a[114:115], v5 offset:448
ds_read_b64_tr_b16 a[116:117], v5 offset:704
ds_read_b64_tr_b16 a[118:119], v5 offset:960
ds_read_b64_tr_b16 a[120:121], v5 offset:224
ds_read_b64_tr_b16 a[122:123], v5 offset:480
ds_read_b64_tr_b16 a[124:125], v5 offset:736
ds_read_b64_tr_b16 a[126:127], v5 offset:992
s_waitcnt lgkmcnt(0)
s_barrier
s_bitcmp1_b32 s49, 0
s_cbranch_scc0 SLOW_SKIP0
v_mfma_f32_16x16x32_bf16 v[68:71], a[0:3], a[128:131], 0
v_mfma_f32_16x16x32_bf16 v[68:71], a[4:7], a[132:135], v[68:71]
v_mfma_f32_16x16x32_bf16 v[68:71], a[8:11], a[136:139], v[68:71]
v_mfma_f32_16x16x32_bf16 v[68:71], a[12:15], a[140:143], v[68:71]
v_mfma_f32_16x16x32_bf16 v[72:75], a[16:19], a[128:131], 0
v_mfma_f32_16x16x32_bf16 v[72:75], a[20:23], a[132:135], v[72:75]
v_mfma_f32_16x16x32_bf16 v[72:75], a[24:27], a[136:139], v[72:75]
v_mfma_f32_16x16x32_bf16 v[72:75], a[28:31], a[140:143], v[72:75]
v_mfma_f32_16x16x32_bf16 v[76:79], a[32:35], a[128:131], 0
v_mfma_f32_16x16x32_bf16 v[76:79], a[36:39], a[132:135], v[76:79]
v_mfma_f32_16x16x32_bf16 v[76:79], a[40:43], a[136:139], v[76:79]
v_mfma_f32_16x16x32_bf16 v[76:79], a[44:47], a[140:143], v[76:79]
v_mfma_f32_16x16x32_bf16 v[80:83], a[48:51], a[128:131], 0
v_mfma_f32_16x16x32_bf16 v[80:83], a[52:55], a[132:135], v[80:83]
v_mfma_f32_16x16x32_bf16 v[80:83], a[56:59], a[136:139], v[80:83]
v_mfma_f32_16x16x32_bf16 v[80:83], a[60:63], a[140:143], v[80:83]
v_max3_f32 v7, v68, v69, v10
v_max3_f32 v7, v7, v70, v71
v_max3_f32 v7, v7, v72, v73
v_max3_f32 v7, v7, v74, v75
v_max3_f32 v7, v7, v76, v77
v_max3_f32 v7, v7, v78, v79
s_nop 1
v_max3_f32 v7, v7, v80, v81
v_max3_f32 v7, v7, v82, v83
v_mov_b32 v8, v7
s_nop 1
v_permlane32_swap_b32 v7, v8
v_max_f32 v7, v7, v8
v_mov_b32 v8, v7
s_nop 1
v_permlane16_swap_b32 v7, v8
v_max_f32 v7, v7, v8
v_sub_f32 v14, v10, v7
v_exp_f32 v14, v14
v_mov_b32 v10, v7
v_sub_f32 v68, v68, v7
v_sub_f32 v69, v69, v7
v_sub_f32 v70, v70, v7
v_sub_f32 v71, v71, v7
v_sub_f32 v72, v72, v7
v_sub_f32 v73, v73, v7
v_sub_f32 v74, v74, v7
v_sub_f32 v75, v75, v7
v_sub_f32 v76, v76, v7
v_sub_f32 v77, v77, v7
v_sub_f32 v78, v78, v7
v_sub_f32 v79, v79, v7
v_sub_f32 v80, v80, v7
v_sub_f32 v81, v81, v7
v_sub_f32 v82, v82, v7
v_sub_f32 v83, v83, v7
v_exp_f32 v68, v68
v_exp_f32 v69, v69
v_exp_f32 v70, v70
v_exp_f32 v71, v71
v_exp_f32 v72, v72
v_exp_f32 v73, v73
v_exp_f32 v74, v74
v_exp_f32 v75, v75
v_exp_f32 v76, v76
v_exp_f32 v77, v77
v_exp_f32 v78, v78
v_exp_f32 v79, v79
v_exp_f32 v80, v80
v_exp_f32 v81, v81
v_exp_f32 v82, v82
v_exp_f32 v83, v83
v_cvt_pk_bf16_f32 v52, v68, v69
v_cvt_pk_bf16_f32 v53, v70, v71
v_cvt_pk_bf16_f32 v54, v72, v73
v_cvt_pk_bf16_f32 v55, v74, v75
v_cvt_pk_bf16_f32 v56, v76, v77
v_cvt_pk_bf16_f32 v57, v78, v79
v_cvt_pk_bf16_f32 v58, v80, v81
v_cvt_pk_bf16_f32 v59, v82, v83
v_mul_f32 v128, v128, v14
v_mul_f32 v129, v129, v14
v_mul_f32 v130, v130, v14
v_mul_f32 v131, v131, v14
v_mul_f32 v132, v132, v14
v_mul_f32 v133, v133, v14
v_mul_f32 v134, v134, v14
v_mul_f32 v135, v135, v14
v_mul_f32 v136, v136, v14
v_mul_f32 v137, v137, v14
v_mul_f32 v138, v138, v14
v_mul_f32 v139, v139, v14
v_mul_f32 v140, v140, v14
v_mul_f32 v141, v141, v14
v_mul_f32 v142, v142, v14
v_mul_f32 v143, v143, v14
v_mul_f32 v144, v144, v14
v_mul_f32 v145, v145, v14
v_mul_f32 v146, v146, v14
v_mul_f32 v147, v147, v14
v_mul_f32 v148, v148, v14
v_mul_f32 v149, v149, v14
v_mul_f32 v150, v150, v14
v_mul_f32 v151, v151, v14
v_mul_f32 v152, v152, v14
v_mul_f32 v153, v153, v14
v_mul_f32 v154, v154, v14
v_mul_f32 v155, v155, v14
v_mul_f32 v156, v156, v14
v_mul_f32 v157, v157, v14
v_mul_f32 v158, v158, v14
v_mul_f32 v159, v159, v14
v_mul_f32 v20, v20, v14
v_mul_f32 v21, v21, v14
v_mul_f32 v22, v22, v14
v_mul_f32 v23, v23, v14
v_mfma_f32_16x16x32_bf16 v[128:131], a[64:67], v[52:55], v[128:131]
v_mfma_f32_16x16x32_bf16 v[128:131], a[68:71], v[56:59], v[128:131]
v_mfma_f32_16x16x32_bf16 v[132:135], a[72:75], v[52:55], v[132:135]
v_mfma_f32_16x16x32_bf16 v[132:135], a[76:79], v[56:59], v[132:135]
v_mfma_f32_16x16x32_bf16 v[136:139], a[80:83], v[52:55], v[136:139]
v_mfma_f32_16x16x32_bf16 v[136:139], a[84:87], v[56:59], v[136:139]
v_mfma_f32_16x16x32_bf16 v[140:143], a[88:91], v[52:55], v[140:143]
v_mfma_f32_16x16x32_bf16 v[140:143], a[92:95], v[56:59], v[140:143]
v_mfma_f32_16x16x32_bf16 v[144:147], a[96:99], v[52:55], v[144:147]
v_mfma_f32_16x16x32_bf16 v[144:147], a[100:103], v[56:59], v[144:147]
v_mfma_f32_16x16x32_bf16 v[148:151], a[104:107], v[52:55], v[148:151]
v_mfma_f32_16x16x32_bf16 v[148:151], a[108:111], v[56:59], v[148:151]
v_mfma_f32_16x16x32_bf16 v[152:155], a[112:115], v[52:55], v[152:155]
v_mfma_f32_16x16x32_bf16 v[152:155], a[116:119], v[56:59], v[152:155]
v_mfma_f32_16x16x32_bf16 v[156:159], a[120:123], v[52:55], v[156:159]
v_mfma_f32_16x16x32_bf16 v[156:159], a[124:127], v[56:59], v[156:159]
v_mfma_f32_16x16x32_bf16 v[20:23], v[16:19], v[52:55], v[20:23]
v_mfma_f32_16x16x32_bf16 v[20:23], v[16:19], v[56:59], v[20:23]
s_nop 7
SLOW_SKIP0:
s_bitcmp1_b32 s49, 1
s_cbranch_scc0 SLOW_SKIP1
v_mfma_f32_16x16x32_bf16 v[68:71], a[0:3], a[144:147], 0
v_mfma_f32_16x16x32_bf16 v[68:71], a[4:7], a[148:151], v[68:71]
v_mfma_f32_16x16x32_bf16 v[68:71], a[8:11], a[152:155], v[68:71]
v_mfma_f32_16x16x32_bf16 v[68:71], a[12:15], a[156:159], v[68:71]
v_mfma_f32_16x16x32_bf16 v[72:75], a[16:19], a[144:147], 0
v_mfma_f32_16x16x32_bf16 v[72:75], a[20:23], a[148:151], v[72:75]
v_mfma_f32_16x16x32_bf16 v[72:75], a[24:27], a[152:155], v[72:75]
v_mfma_f32_16x16x32_bf16 v[72:75], a[28:31], a[156:159], v[72:75]
v_mfma_f32_16x16x32_bf16 v[76:79], a[32:35], a[144:147], 0
v_mfma_f32_16x16x32_bf16 v[76:79], a[36:39], a[148:151], v[76:79]
v_mfma_f32_16x16x32_bf16 v[76:79], a[40:43], a[152:155], v[76:79]
v_mfma_f32_16x16x32_bf16 v[76:79], a[44:47], a[156:159], v[76:79]
v_mfma_f32_16x16x32_bf16 v[80:83], a[48:51], a[144:147], 0
v_mfma_f32_16x16x32_bf16 v[80:83], a[52:55], a[148:151], v[80:83]
v_mfma_f32_16x16x32_bf16 v[80:83], a[56:59], a[152:155], v[80:83]
v_mfma_f32_16x16x32_bf16 v[80:83], a[60:63], a[156:159], v[80:83]
v_max3_f32 v7, v68, v69, v11
v_max3_f32 v7, v7, v70, v71
v_max3_f32 v7, v7, v72, v73
v_max3_f32 v7, v7, v74, v75
v_max3_f32 v7, v7, v76, v77
v_max3_f32 v7, v7, v78, v79
s_nop 1
v_max3_f32 v7, v7, v80, v81
v_max3_f32 v7, v7, v82, v83
v_mov_b32 v8, v7
s_nop 1
v_permlane32_swap_b32 v7, v8
v_max_f32 v7, v7, v8
v_mov_b32 v8, v7
s_nop 1
v_permlane16_swap_b32 v7, v8
v_max_f32 v7, v7, v8
v_sub_f32 v14, v11, v7
v_exp_f32 v14, v14
v_mov_b32 v11, v7
v_sub_f32 v68, v68, v7
v_sub_f32 v69, v69, v7
v_sub_f32 v70, v70, v7
v_sub_f32 v71, v71, v7
v_sub_f32 v72, v72, v7
v_sub_f32 v73, v73, v7
v_sub_f32 v74, v74, v7
v_sub_f32 v75, v75, v7
v_sub_f32 v76, v76, v7
v_sub_f32 v77, v77, v7
v_sub_f32 v78, v78, v7
v_sub_f32 v79, v79, v7
v_sub_f32 v80, v80, v7
v_sub_f32 v81, v81, v7
v_sub_f32 v82, v82, v7
v_sub_f32 v83, v83, v7
v_exp_f32 v68, v68
v_exp_f32 v69, v69
v_exp_f32 v70, v70
v_exp_f32 v71, v71
v_exp_f32 v72, v72
v_exp_f32 v73, v73
v_exp_f32 v74, v74
v_exp_f32 v75, v75
v_exp_f32 v76, v76
v_exp_f32 v77, v77
v_exp_f32 v78, v78
v_exp_f32 v79, v79
v_exp_f32 v80, v80
v_exp_f32 v81, v81
v_exp_f32 v82, v82
v_exp_f32 v83, v83
v_cvt_pk_bf16_f32 v52, v68, v69
v_cvt_pk_bf16_f32 v53, v70, v71
v_cvt_pk_bf16_f32 v54, v72, v73
v_cvt_pk_bf16_f32 v55, v74, v75
v_cvt_pk_bf16_f32 v56, v76, v77
v_cvt_pk_bf16_f32 v57, v78, v79
v_cvt_pk_bf16_f32 v58, v80, v81
v_cvt_pk_bf16_f32 v59, v82, v83
v_mul_f32 v160, v160, v14
v_mul_f32 v161, v161, v14
v_mul_f32 v162, v162, v14
v_mul_f32 v163, v163, v14
v_mul_f32 v164, v164, v14
v_mul_f32 v165, v165, v14
v_mul_f32 v166, v166, v14
v_mul_f32 v167, v167, v14
v_mul_f32 v168, v168, v14
v_mul_f32 v169, v169, v14
v_mul_f32 v170, v170, v14
v_mul_f32 v171, v171, v14
v_mul_f32 v172, v172, v14
v_mul_f32 v173, v173, v14
v_mul_f32 v174, v174, v14
v_mul_f32 v175, v175, v14
v_mul_f32 v176, v176, v14
v_mul_f32 v177, v177, v14
v_mul_f32 v178, v178, v14
v_mul_f32 v179, v179, v14
v_mul_f32 v180, v180, v14
v_mul_f32 v181, v181, v14
v_mul_f32 v182, v182, v14
v_mul_f32 v183, v183, v14
v_mul_f32 v184, v184, v14
v_mul_f32 v185, v185, v14
v_mul_f32 v186, v186, v14
v_mul_f32 v187, v187, v14
v_mul_f32 v188, v188, v14
v_mul_f32 v189, v189, v14
v_mul_f32 v190, v190, v14
v_mul_f32 v191, v191, v14
v_mul_f32 v24, v24, v14
v_mul_f32 v25, v25, v14
v_mul_f32 v26, v26, v14
v_mul_f32 v27, v27, v14
v_mfma_f32_16x16x32_bf16 v[160:163], a[64:67], v[52:55], v[160:163]
v_mfma_f32_16x16x32_bf16 v[160:163], a[68:71], v[56:59], v[160:163]
v_mfma_f32_16x16x32_bf16 v[164:167], a[72:75], v[52:55], v[164:167]
v_mfma_f32_16x16x32_bf16 v[164:167], a[76:79], v[56:59], v[164:167]
v_mfma_f32_16x16x32_bf16 v[168:171], a[80:83], v[52:55], v[168:171]
v_mfma_f32_16x16x32_bf16 v[168:171], a[84:87], v[56:59], v[168:171]
v_mfma_f32_16x16x32_bf16 v[172:175], a[88:91], v[52:55], v[172:175]
v_mfma_f32_16x16x32_bf16 v[172:175], a[92:95], v[56:59], v[172:175]
v_mfma_f32_16x16x32_bf16 v[176:179], a[96:99], v[52:55], v[176:179]
v_mfma_f32_16x16x32_bf16 v[176:179], a[100:103], v[56:59], v[176:179]
v_mfma_f32_16x16x32_bf16 v[180:183], a[104:107], v[52:55], v[180:183]
v_mfma_f32_16x16x32_bf16 v[180:183], a[108:111], v[56:59], v[180:183]
v_mfma_f32_16x16x32_bf16 v[184:187], a[112:115], v[52:55], v[184:187]
v_mfma_f32_16x16x32_bf16 v[184:187], a[116:119], v[56:59], v[184:187]
v_mfma_f32_16x16x32_bf16 v[188:191], a[120:123], v[52:55], v[188:191]
v_mfma_f32_16x16x32_bf16 v[188:191], a[124:127], v[56:59], v[188:191]
v_mfma_f32_16x16x32_bf16 v[24:27], v[16:19], v[52:55], v[24:27]
v_mfma_f32_16x16x32_bf16 v[24:27], v[16:19], v[56:59], v[24:27]
s_nop 7
SLOW_SKIP1:
s_bitcmp1_b32 s49, 2
s_cbranch_scc0 SLOW_SKIP2
v_mfma_f32_16x16x32_bf16 v[68:71], a[0:3], a[160:163], 0
v_mfma_f32_16x16x32_bf16 v[68:71], a[4:7], a[164:167], v[68:71]
v_mfma_f32_16x16x32_bf16 v[68:71], a[8:11], a[168:171], v[68:71]
v_mfma_f32_16x16x32_bf16 v[68:71], a[12:15], a[172:175], v[68:71]
v_mfma_f32_16x16x32_bf16 v[72:75], a[16:19], a[160:163], 0
v_mfma_f32_16x16x32_bf16 v[72:75], a[20:23], a[164:167], v[72:75]
v_mfma_f32_16x16x32_bf16 v[72:75], a[24:27], a[168:171], v[72:75]
v_mfma_f32_16x16x32_bf16 v[72:75], a[28:31], a[172:175], v[72:75]
v_mfma_f32_16x16x32_bf16 v[76:79], a[32:35], a[160:163], 0
v_mfma_f32_16x16x32_bf16 v[76:79], a[36:39], a[164:167], v[76:79]
v_mfma_f32_16x16x32_bf16 v[76:79], a[40:43], a[168:171], v[76:79]
v_mfma_f32_16x16x32_bf16 v[76:79], a[44:47], a[172:175], v[76:79]
v_mfma_f32_16x16x32_bf16 v[80:83], a[48:51], a[160:163], 0
v_mfma_f32_16x16x32_bf16 v[80:83], a[52:55], a[164:167], v[80:83]
v_mfma_f32_16x16x32_bf16 v[80:83], a[56:59], a[168:171], v[80:83]
v_mfma_f32_16x16x32_bf16 v[80:83], a[60:63], a[172:175], v[80:83]
v_max3_f32 v7, v68, v69, v12
v_max3_f32 v7, v7, v70, v71
v_max3_f32 v7, v7, v72, v73
v_max3_f32 v7, v7, v74, v75
v_max3_f32 v7, v7, v76, v77
v_max3_f32 v7, v7, v78, v79
s_nop 1
v_max3_f32 v7, v7, v80, v81
v_max3_f32 v7, v7, v82, v83
v_mov_b32 v8, v7
s_nop 1
v_permlane32_swap_b32 v7, v8
v_max_f32 v7, v7, v8
v_mov_b32 v8, v7
s_nop 1
v_permlane16_swap_b32 v7, v8
v_max_f32 v7, v7, v8
v_sub_f32 v14, v12, v7
v_exp_f32 v14, v14
v_mov_b32 v12, v7
v_sub_f32 v68, v68, v7
v_sub_f32 v69, v69, v7
v_sub_f32 v70, v70, v7
v_sub_f32 v71, v71, v7
v_sub_f32 v72, v72, v7
v_sub_f32 v73, v73, v7
v_sub_f32 v74, v74, v7
v_sub_f32 v75, v75, v7
v_sub_f32 v76, v76, v7
v_sub_f32 v77, v77, v7
v_sub_f32 v78, v78, v7
v_sub_f32 v79, v79, v7
v_sub_f32 v80, v80, v7
v_sub_f32 v81, v81, v7
v_sub_f32 v82, v82, v7
v_sub_f32 v83, v83, v7
v_exp_f32 v68, v68
v_exp_f32 v69, v69
v_exp_f32 v70, v70
v_exp_f32 v71, v71
v_exp_f32 v72, v72
v_exp_f32 v73, v73
v_exp_f32 v74, v74
v_exp_f32 v75, v75
v_exp_f32 v76, v76
v_exp_f32 v77, v77
v_exp_f32 v78, v78
v_exp_f32 v79, v79
v_exp_f32 v80, v80
v_exp_f32 v81, v81
v_exp_f32 v82, v82
v_exp_f32 v83, v83
v_cvt_pk_bf16_f32 v52, v68, v69
v_cvt_pk_bf16_f32 v53, v70, v71
v_cvt_pk_bf16_f32 v54, v72, v73
v_cvt_pk_bf16_f32 v55, v74, v75
v_cvt_pk_bf16_f32 v56, v76, v77
v_cvt_pk_bf16_f32 v57, v78, v79
v_cvt_pk_bf16_f32 v58, v80, v81
v_cvt_pk_bf16_f32 v59, v82, v83
v_mul_f32 v192, v192, v14
v_mul_f32 v193, v193, v14
v_mul_f32 v194, v194, v14
v_mul_f32 v195, v195, v14
v_mul_f32 v196, v196, v14
v_mul_f32 v197, v197, v14
v_mul_f32 v198, v198, v14
v_mul_f32 v199, v199, v14
v_mul_f32 v200, v200, v14
v_mul_f32 v201, v201, v14
v_mul_f32 v202, v202, v14
v_mul_f32 v203, v203, v14
v_mul_f32 v204, v204, v14
v_mul_f32 v205, v205, v14
v_mul_f32 v206, v206, v14
v_mul_f32 v207, v207, v14
v_mul_f32 v208, v208, v14
v_mul_f32 v209, v209, v14
v_mul_f32 v210, v210, v14
v_mul_f32 v211, v211, v14
v_mul_f32 v212, v212, v14
v_mul_f32 v213, v213, v14
v_mul_f32 v214, v214, v14
v_mul_f32 v215, v215, v14
v_mul_f32 v216, v216, v14
v_mul_f32 v217, v217, v14
v_mul_f32 v218, v218, v14
v_mul_f32 v219, v219, v14
v_mul_f32 v220, v220, v14
v_mul_f32 v221, v221, v14
v_mul_f32 v222, v222, v14
v_mul_f32 v223, v223, v14
v_mul_f32 v28, v28, v14
v_mul_f32 v29, v29, v14
v_mul_f32 v30, v30, v14
v_mul_f32 v31, v31, v14
v_mfma_f32_16x16x32_bf16 v[192:195], a[64:67], v[52:55], v[192:195]
v_mfma_f32_16x16x32_bf16 v[192:195], a[68:71], v[56:59], v[192:195]
v_mfma_f32_16x16x32_bf16 v[196:199], a[72:75], v[52:55], v[196:199]
v_mfma_f32_16x16x32_bf16 v[196:199], a[76:79], v[56:59], v[196:199]
v_mfma_f32_16x16x32_bf16 v[200:203], a[80:83], v[52:55], v[200:203]
v_mfma_f32_16x16x32_bf16 v[200:203], a[84:87], v[56:59], v[200:203]
v_mfma_f32_16x16x32_bf16 v[204:207], a[88:91], v[52:55], v[204:207]
v_mfma_f32_16x16x32_bf16 v[204:207], a[92:95], v[56:59], v[204:207]
v_mfma_f32_16x16x32_bf16 v[208:211], a[96:99], v[52:55], v[208:211]
v_mfma_f32_16x16x32_bf16 v[208:211], a[100:103], v[56:59], v[208:211]
v_mfma_f32_16x16x32_bf16 v[212:215], a[104:107], v[52:55], v[212:215]
v_mfma_f32_16x16x32_bf16 v[212:215], a[108:111], v[56:59], v[212:215]
v_mfma_f32_16x16x32_bf16 v[216:219], a[112:115], v[52:55], v[216:219]
v_mfma_f32_16x16x32_bf16 v[216:219], a[116:119], v[56:59], v[216:219]
v_mfma_f32_16x16x32_bf16 v[220:223], a[120:123], v[52:55], v[220:223]
v_mfma_f32_16x16x32_bf16 v[220:223], a[124:127], v[56:59], v[220:223]
v_mfma_f32_16x16x32_bf16 v[28:31], v[16:19], v[52:55], v[28:31]
v_mfma_f32_16x16x32_bf16 v[28:31], v[16:19], v[56:59], v[28:31]
s_nop 7
SLOW_SKIP2:
s_bitcmp1_b32 s49, 3
s_cbranch_scc0 SLOW_SKIP3
v_mfma_f32_16x16x32_bf16 v[68:71], a[0:3], a[176:179], 0
v_mfma_f32_16x16x32_bf16 v[68:71], a[4:7], a[180:183], v[68:71]
v_mfma_f32_16x16x32_bf16 v[68:71], a[8:11], a[184:187], v[68:71]
v_mfma_f32_16x16x32_bf16 v[68:71], a[12:15], a[188:191], v[68:71]
v_mfma_f32_16x16x32_bf16 v[72:75], a[16:19], a[176:179], 0
v_mfma_f32_16x16x32_bf16 v[72:75], a[20:23], a[180:183], v[72:75]
v_mfma_f32_16x16x32_bf16 v[72:75], a[24:27], a[184:187], v[72:75]
v_mfma_f32_16x16x32_bf16 v[72:75], a[28:31], a[188:191], v[72:75]
v_mfma_f32_16x16x32_bf16 v[76:79], a[32:35], a[176:179], 0
v_mfma_f32_16x16x32_bf16 v[76:79], a[36:39], a[180:183], v[76:79]
v_mfma_f32_16x16x32_bf16 v[76:79], a[40:43], a[184:187], v[76:79]
v_mfma_f32_16x16x32_bf16 v[76:79], a[44:47], a[188:191], v[76:79]
v_mfma_f32_16x16x32_bf16 v[80:83], a[48:51], a[176:179], 0
v_mfma_f32_16x16x32_bf16 v[80:83], a[52:55], a[180:183], v[80:83]
v_mfma_f32_16x16x32_bf16 v[80:83], a[56:59], a[184:187], v[80:83]
v_mfma_f32_16x16x32_bf16 v[80:83], a[60:63], a[188:191], v[80:83]
v_max3_f32 v7, v68, v69, v13
v_max3_f32 v7, v7, v70, v71
v_max3_f32 v7, v7, v72, v73
v_max3_f32 v7, v7, v74, v75
v_max3_f32 v7, v7, v76, v77
v_max3_f32 v7, v7, v78, v79
s_nop 1
v_max3_f32 v7, v7, v80, v81
v_max3_f32 v7, v7, v82, v83
v_mov_b32 v8, v7
s_nop 1
v_permlane32_swap_b32 v7, v8
v_max_f32 v7, v7, v8
v_mov_b32 v8, v7
s_nop 1
v_permlane16_swap_b32 v7, v8
v_max_f32 v7, v7, v8
v_sub_f32 v14, v13, v7
v_exp_f32 v14, v14
v_mov_b32 v13, v7
v_sub_f32 v68, v68, v7
v_sub_f32 v69, v69, v7
v_sub_f32 v70, v70, v7
v_sub_f32 v71, v71, v7
v_sub_f32 v72, v72, v7
v_sub_f32 v73, v73, v7
v_sub_f32 v74, v74, v7
v_sub_f32 v75, v75, v7
v_sub_f32 v76, v76, v7
v_sub_f32 v77, v77, v7
v_sub_f32 v78, v78, v7
v_sub_f32 v79, v79, v7
v_sub_f32 v80, v80, v7
v_sub_f32 v81, v81, v7
v_sub_f32 v82, v82, v7
v_sub_f32 v83, v83, v7
v_exp_f32 v68, v68
v_exp_f32 v69, v69
v_exp_f32 v70, v70
v_exp_f32 v71, v71
v_exp_f32 v72, v72
v_exp_f32 v73, v73
v_exp_f32 v74, v74
v_exp_f32 v75, v75
v_exp_f32 v76, v76
v_exp_f32 v77, v77
v_exp_f32 v78, v78
v_exp_f32 v79, v79
v_exp_f32 v80, v80
v_exp_f32 v81, v81
v_exp_f32 v82, v82
v_exp_f32 v83, v83
v_cvt_pk_bf16_f32 v52, v68, v69
v_cvt_pk_bf16_f32 v53, v70, v71
v_cvt_pk_bf16_f32 v54, v72, v73
v_cvt_pk_bf16_f32 v55, v74, v75
v_cvt_pk_bf16_f32 v56, v76, v77
v_cvt_pk_bf16_f32 v57, v78, v79
v_cvt_pk_bf16_f32 v58, v80, v81
v_cvt_pk_bf16_f32 v59, v82, v83
v_mul_f32 v224, v224, v14
v_mul_f32 v225, v225, v14
v_mul_f32 v226, v226, v14
v_mul_f32 v227, v227, v14
v_mul_f32 v228, v228, v14
v_mul_f32 v229, v229, v14
v_mul_f32 v230, v230, v14
v_mul_f32 v231, v231, v14
v_mul_f32 v232, v232, v14
v_mul_f32 v233, v233, v14
v_mul_f32 v234, v234, v14
v_mul_f32 v235, v235, v14
v_mul_f32 v236, v236, v14
v_mul_f32 v237, v237, v14
v_mul_f32 v238, v238, v14
v_mul_f32 v239, v239, v14
v_mul_f32 v240, v240, v14
v_mul_f32 v241, v241, v14
v_mul_f32 v242, v242, v14
v_mul_f32 v243, v243, v14
v_mul_f32 v244, v244, v14
v_mul_f32 v245, v245, v14
v_mul_f32 v246, v246, v14
v_mul_f32 v247, v247, v14
v_mul_f32 v248, v248, v14
v_mul_f32 v249, v249, v14
v_mul_f32 v250, v250, v14
v_mul_f32 v251, v251, v14
v_mul_f32 v252, v252, v14
v_mul_f32 v253, v253, v14
v_mul_f32 v254, v254, v14
v_mul_f32 v255, v255, v14
v_mul_f32 v32, v32, v14
v_mul_f32 v33, v33, v14
v_mul_f32 v34, v34, v14
v_mul_f32 v35, v35, v14
v_mfma_f32_16x16x32_bf16 v[224:227], a[64:67], v[52:55], v[224:227]
v_mfma_f32_16x16x32_bf16 v[224:227], a[68:71], v[56:59], v[224:227]
v_mfma_f32_16x16x32_bf16 v[228:231], a[72:75], v[52:55], v[228:231]
v_mfma_f32_16x16x32_bf16 v[228:231], a[76:79], v[56:59], v[228:231]
v_mfma_f32_16x16x32_bf16 v[232:235], a[80:83], v[52:55], v[232:235]
v_mfma_f32_16x16x32_bf16 v[232:235], a[84:87], v[56:59], v[232:235]
v_mfma_f32_16x16x32_bf16 v[236:239], a[88:91], v[52:55], v[236:239]
v_mfma_f32_16x16x32_bf16 v[236:239], a[92:95], v[56:59], v[236:239]
v_mfma_f32_16x16x32_bf16 v[240:243], a[96:99], v[52:55], v[240:243]
v_mfma_f32_16x16x32_bf16 v[240:243], a[100:103], v[56:59], v[240:243]
v_mfma_f32_16x16x32_bf16 v[244:247], a[104:107], v[52:55], v[244:247]
v_mfma_f32_16x16x32_bf16 v[244:247], a[108:111], v[56:59], v[244:247]
v_mfma_f32_16x16x32_bf16 v[248:251], a[112:115], v[52:55], v[248:251]
v_mfma_f32_16x16x32_bf16 v[248:251], a[116:119], v[56:59], v[248:251]
v_mfma_f32_16x16x32_bf16 v[252:255], a[120:123], v[52:55], v[252:255]
v_mfma_f32_16x16x32_bf16 v[252:255], a[124:127], v[56:59], v[252:255]
v_mfma_f32_16x16x32_bf16 v[32:35], v[16:19], v[52:55], v[32:35]
v_mfma_f32_16x16x32_bf16 v[32:35], v[16:19], v[56:59], v[32:35]
s_nop 7
SLOW_SKIP3:
s_sub_u32 s51, s51, 1
s_cmp_lg_u32 s51, 0
s_nop 7
s_cbranch_scc1 SLOW_LOOP
s_bitcmp1_b32 s49, 0
s_cbranch_scc0 SLOW_NOST0
s_lshl_b32 s52, s48, 16
s_add_u32 s52, s52, 0
v_rcp_f32 v9, v20
s_nop 0
v_mul_f32 v128, v128, v9
v_mul_f32 v129, v129, v9
v_mul_f32 v130, v130, v9
v_mul_f32 v131, v131, v9
v_mul_f32 v132, v132, v9
v_mul_f32 v133, v133, v9
v_mul_f32 v134, v134, v9
v_mul_f32 v135, v135, v9
v_cvt_pk_bf16_f32 v100, v128, v129
v_cvt_pk_bf16_f32 v101, v130, v131
v_mul_f32 v136, v136, v9
v_mul_f32 v137, v137, v9
v_mul_f32 v138, v138, v9
v_mul_f32 v139, v139, v9
v_cvt_pk_bf16_f32 v102, v132, v133
v_cvt_pk_bf16_f32 v103, v134, v135
v_mul_f32 v140, v140, v9
v_mul_f32 v141, v141, v9
v_mul_f32 v142, v142, v9
v_mul_f32 v143, v143, v9
v_cvt_pk_bf16_f32 v104, v136, v137
v_cvt_pk_bf16_f32 v105, v138, v139
buffer_store_dwordx4 v[100:103], v6, s[20:23], s52 offen offset:0 sc1
v_mul_f32 v144, v144, v9
v_mul_f32 v145, v145, v9
v_mul_f32 v146, v146, v9
v_mul_f32 v147, v147, v9
v_cvt_pk_bf16_f32 v106, v140, v141
v_cvt_pk_bf16_f32 v107, v142, v143
v_mul_f32 v148, v148, v9
v_mul_f32 v149, v149, v9
v_mul_f32 v150, v150, v9
v_mul_f32 v151, v151, v9
v_cvt_pk_bf16_f32 v108, v144, v145
v_cvt_pk_bf16_f32 v109, v146, v147
buffer_store_dwordx4 v[104:107], v6, s[20:23], s52 offen offset:1024 sc1
v_mul_f32 v152, v152, v9
v_mul_f32 v153, v153, v9
v_mul_f32 v154, v154, v9
v_mul_f32 v155, v155, v9
v_cvt_pk_bf16_f32 v110, v148, v149
v_cvt_pk_bf16_f32 v111, v150, v151
v_mul_f32 v156, v156, v9
v_mul_f32 v157, v157, v9
v_mul_f32 v158, v158, v9
v_mul_f32 v159, v159, v9
v_cvt_pk_bf16_f32 v112, v152, v153
v_cvt_pk_bf16_f32 v113, v154, v155
buffer_store_dwordx4 v[108:111], v6, s[20:23], s52 offen offset:2048 sc1
v_cvt_pk_bf16_f32 v114, v156, v157
v_cvt_pk_bf16_f32 v115, v158, v159
buffer_store_dwordx4 v[112:115], v6, s[20:23], s52 offen offset:3072 sc1
SLOW_NOST0:
s_bitcmp1_b32 s49, 1
s_cbranch_scc0 SLOW_NOST1
s_lshl_b32 s52, s48, 16
s_add_u32 s52, s52, 4096
v_rcp_f32 v9, v24
s_nop 0
v_mul_f32 v160, v160, v9
v_mul_f32 v161, v161, v9
v_mul_f32 v162, v162, v9
v_mul_f32 v163, v163, v9
v_mul_f32 v164, v164, v9
v_mul_f32 v165, v165, v9
v_mul_f32 v166, v166, v9
v_mul_f32 v167, v167, v9
v_cvt_pk_bf16_f32 v100, v160, v161
v_cvt_pk_bf16_f32 v101, v162, v163
v_mul_f32 v168, v168, v9
v_mul_f32 v169, v169, v9
v_mul_f32 v170, v170, v9
v_mul_f32 v171, v171, v9
v_cvt_pk_bf16_f32 v102, v164, v165
v_cvt_pk_bf16_f32 v103, v166, v167
v_mul_f32 v172, v172, v9
v_mul_f32 v173, v173, v9
v_mul_f32 v174, v174, v9
v_mul_f32 v175, v175, v9
v_cvt_pk_bf16_f32 v104, v168, v169
v_cvt_pk_bf16_f32 v105, v170, v171
buffer_store_dwordx4 v[100:103], v6, s[20:23], s52 offen offset:0 sc1
v_mul_f32 v176, v176, v9
v_mul_f32 v177, v177, v9
v_mul_f32 v178, v178, v9
v_mul_f32 v179, v179, v9
v_cvt_pk_bf16_f32 v106, v172, v173
v_cvt_pk_bf16_f32 v107, v174, v175
v_mul_f32 v180, v180, v9
v_mul_f32 v181, v181, v9
v_mul_f32 v182, v182, v9
v_mul_f32 v183, v183, v9
v_cvt_pk_bf16_f32 v108, v176, v177
v_cvt_pk_bf16_f32 v109, v178, v179
buffer_store_dwordx4 v[104:107], v6, s[20:23], s52 offen offset:1024 sc1
v_mul_f32 v184, v184, v9
v_mul_f32 v185, v185, v9
v_mul_f32 v186, v186, v9
v_mul_f32 v187, v187, v9
v_cvt_pk_bf16_f32 v110, v180, v181
v_cvt_pk_bf16_f32 v111, v182, v183
v_mul_f32 v188, v188, v9
v_mul_f32 v189, v189, v9
v_mul_f32 v190, v190, v9
v_mul_f32 v191, v191, v9
v_cvt_pk_bf16_f32 v112, v184, v185
v_cvt_pk_bf16_f32 v113, v186, v187
buffer_store_dwordx4 v[108:111], v6, s[20:23], s52 offen offset:2048 sc1
v_cvt_pk_bf16_f32 v114, v188, v189
v_cvt_pk_bf16_f32 v115, v190, v191
buffer_store_dwordx4 v[112:115], v6, s[20:23], s52 offen offset:3072 sc1
SLOW_NOST1:
s_bitcmp1_b32 s49, 2
s_cbranch_scc0 SLOW_NOST2
s_lshl_b32 s52, s48, 16
s_add_u32 s52, s52, 8192
v_rcp_f32 v9, v28
s_nop 0
v_mul_f32 v192, v192, v9
v_mul_f32 v193, v193, v9
v_mul_f32 v194, v194, v9
v_mul_f32 v195, v195, v9
v_mul_f32 v196, v196, v9
v_mul_f32 v197, v197, v9
v_mul_f32 v198, v198, v9
v_mul_f32 v199, v199, v9
v_cvt_pk_bf16_f32 v100, v192, v193
v_cvt_pk_bf16_f32 v101, v194, v195
v_mul_f32 v200, v200, v9
v_mul_f32 v201, v201, v9
v_mul_f32 v202, v202, v9
v_mul_f32 v203, v203, v9
v_cvt_pk_bf16_f32 v102, v196, v197
v_cvt_pk_bf16_f32 v103, v198, v199
v_mul_f32 v204, v204, v9
v_mul_f32 v205, v205, v9
v_mul_f32 v206, v206, v9
v_mul_f32 v207, v207, v9
v_cvt_pk_bf16_f32 v104, v200, v201
v_cvt_pk_bf16_f32 v105, v202, v203
buffer_store_dwordx4 v[100:103], v6, s[20:23], s52 offen offset:0 sc1
v_mul_f32 v208, v208, v9
v_mul_f32 v209, v209, v9
v_mul_f32 v210, v210, v9
v_mul_f32 v211, v211, v9
v_cvt_pk_bf16_f32 v106, v204, v205
v_cvt_pk_bf16_f32 v107, v206, v207
v_mul_f32 v212, v212, v9
v_mul_f32 v213, v213, v9
v_mul_f32 v214, v214, v9
v_mul_f32 v215, v215, v9
v_cvt_pk_bf16_f32 v108, v208, v209
v_cvt_pk_bf16_f32 v109, v210, v211
buffer_store_dwordx4 v[104:107], v6, s[20:23], s52 offen offset:1024 sc1
v_mul_f32 v216, v216, v9
v_mul_f32 v217, v217, v9
v_mul_f32 v218, v218, v9
v_mul_f32 v219, v219, v9
v_cvt_pk_bf16_f32 v110, v212, v213
v_cvt_pk_bf16_f32 v111, v214, v215
v_mul_f32 v220, v220, v9
v_mul_f32 v221, v221, v9
v_mul_f32 v222, v222, v9
v_mul_f32 v223, v223, v9
v_cvt_pk_bf16_f32 v112, v216, v217
v_cvt_pk_bf16_f32 v113, v218, v219
buffer_store_dwordx4 v[108:111], v6, s[20:23], s52 offen offset:2048 sc1
v_cvt_pk_bf16_f32 v114, v220, v221
v_cvt_pk_bf16_f32 v115, v222, v223
buffer_store_dwordx4 v[112:115], v6, s[20:23], s52 offen offset:3072 sc1
SLOW_NOST2:
s_bitcmp1_b32 s49, 3
s_cbranch_scc0 SLOW_NOST3
s_lshl_b32 s52, s48, 16
s_add_u32 s52, s52, 12288
v_rcp_f32 v9, v32
s_nop 0
v_mul_f32 v224, v224, v9
v_mul_f32 v225, v225, v9
v_mul_f32 v226, v226, v9
v_mul_f32 v227, v227, v9
v_mul_f32 v228, v228, v9
v_mul_f32 v229, v229, v9
v_mul_f32 v230, v230, v9
v_mul_f32 v231, v231, v9
v_cvt_pk_bf16_f32 v100, v224, v225
v_cvt_pk_bf16_f32 v101, v226, v227
v_mul_f32 v232, v232, v9
v_mul_f32 v233, v233, v9
v_mul_f32 v234, v234, v9
v_mul_f32 v235, v235, v9
v_cvt_pk_bf16_f32 v102, v228, v229
v_cvt_pk_bf16_f32 v103, v230, v231
v_mul_f32 v236, v236, v9
v_mul_f32 v237, v237, v9
v_mul_f32 v238, v238, v9
v_mul_f32 v239, v239, v9
v_cvt_pk_bf16_f32 v104, v232, v233
v_cvt_pk_bf16_f32 v105, v234, v235
buffer_store_dwordx4 v[100:103], v6, s[20:23], s52 offen offset:0 sc1
v_mul_f32 v240, v240, v9
v_mul_f32 v241, v241, v9
v_mul_f32 v242, v242, v9
v_mul_f32 v243, v243, v9
v_cvt_pk_bf16_f32 v106, v236, v237
v_cvt_pk_bf16_f32 v107, v238, v239
v_mul_f32 v244, v244, v9
v_mul_f32 v245, v245, v9
v_mul_f32 v246, v246, v9
v_mul_f32 v247, v247, v9
v_cvt_pk_bf16_f32 v108, v240, v241
v_cvt_pk_bf16_f32 v109, v242, v243
buffer_store_dwordx4 v[104:107], v6, s[20:23], s52 offen offset:1024 sc1
v_mul_f32 v248, v248, v9
v_mul_f32 v249, v249, v9
v_mul_f32 v250, v250, v9
v_mul_f32 v251, v251, v9
v_cvt_pk_bf16_f32 v110, v244, v245
v_cvt_pk_bf16_f32 v111, v246, v247
v_mul_f32 v252, v252, v9
v_mul_f32 v253, v253, v9
v_mul_f32 v254, v254, v9
v_mul_f32 v255, v255, v9
v_cvt_pk_bf16_f32 v112, v248, v249
v_cvt_pk_bf16_f32 v113, v250, v251
buffer_store_dwordx4 v[108:111], v6, s[20:23], s52 offen offset:2048 sc1
v_cvt_pk_bf16_f32 v114, v252, v253
v_cvt_pk_bf16_f32 v115, v254, v255
buffer_store_dwordx4 v[112:115], v6, s[20:23], s52 offen offset:3072 sc1
SLOW_NOST3:
s_cmp_eq_u32 s48, 0
s_cselect_b32 s61, s47, 0
s_bitcmp1_b32 s61, 1
s_cbranch_scc1 SLOW_T1
v_mov_b32 v7, 163836
ds_write_b32 v7, v121
s_waitcnt vmcnt(0) lgkmcnt(0)
s_barrier
s_cmp_lg_u32 s40, 0
s_cbranch_scc1 SLOW_PUBD
s_and_b32 s61, s47, 1
s_or_b32 s61, s61, 0x10000
s_lshl_b32 s63, s93, 2
v_mov_b32 v122, s63
v_mov_b32 v123, s61
s_mov_b64 exec, 1
global_atomic_add v122, v123, s[80:81] sc1
s_mov_b64 exec, -1
SLOW_PUBD:
s_mov_b32 s60, 1
SLOW_SPIN:
s_cmp_eq_u32 s28, 0
s_cbranch_scc1 SLOW_SPUN
s_sub_u32 s28, s28, 1
s_sleep 2
global_load_dwordx2 v[122:123], v121, s[80:81] sc1
s_waitcnt vmcnt(0)
v_readfirstlane_b32 s61, v122
v_readfirstlane_b32 s62, v123
s_cmp_eq_u32 s93, 0
s_cselect_b32 s61, s61, s62
s_and_b32 s61, s61, 0xfff8
s_cmp_eq_u32 s61, 0
s_cbranch_scc1 SLOW_SPIN
SLOW_SPUN:
s_mov_b32 s22, 0
s_mov_b32 s88, 0
s_mov_b32 s89, 0
s_add_u32 m0, s90, 0
s_nop 0
buffer_load_dwordx4 v118, s[8:11], s89 offen offset:0  lds
s_add_u32 m0, s90, 32
s_nop 0
buffer_load_dwordx4 v118, s[8:11], s89 offen offset:1024  lds
s_add_u32 m0, s90, 64
s_nop 0
buffer_load_dwordx4 v118, s[8:11], s89 offen offset:2048  lds
s_add_u32 m0, s90, 96
s_nop 0
buffer_load_dwordx4 v118, s[8:11], s89 offen offset:3072  lds
s_add_u32 m0, s90, 4224
s_nop 0
buffer_load_dwordx4 v119, s[8:11], s89 offen offset:0  lds
s_add_u32 m0, s90, 4256
s_nop 0
buffer_load_dwordx4 v119, s[8:11], s89 offen offset:1024  lds
s_add_u32 m0, s90, 4288
s_nop 0
buffer_load_dwordx4 v119, s[8:11], s89 offen offset:2048  lds
s_add_u32 m0, s90, 4320
s_nop 0
buffer_load_dwordx4 v119, s[8:11], s89 offen offset:3072  lds
s_add_u32 s89, s89, 0x40000
s_cmp_eq_u32 s89, 0x200000
s_cselect_b32 s89, 0x20000, s89
buffer_load_dwordx4 a[0:3], v116, s[4:7], s88 offen offset:0 sc1
buffer_load_dwordx4 a[4:7], v116, s[4:7], s88 offen offset:1024 sc1
buffer_load_dwordx4 a[8:11], v116, s[4:7], s88 offen offset:2048 sc1
buffer_load_dwordx4 a[12:15], v116, s[4:7], s88 offen offset:3072 sc1
buffer_load_dwordx4 a[16:19], v117, s[4:7], s88 offen offset:0 sc1
buffer_load_dwordx4 a[20:23], v117, s[4:7], s88 offen offset:1024 sc1
buffer_load_dwordx4 a[24:27], v117, s[4:7], s88 offen offset:2048 sc1
buffer_load_dwordx4 a[28:31], v117, s[4:7], s88 offen offset:3072 sc1
s_add_u32 s88, s88, 0x20000
s_cmp_eq_u32 s88, 0x100000
s_cselect_b32 s88, 0x10000, s88
s_add_u32 m0, s90, 67584
s_nop 0
buffer_load_dwordx4 v118, s[8:11], s89 offen offset:0  lds
s_add_u32 m0, s90, 67616
s_nop 0
buffer_load_dwordx4 v118, s[8:11], s89 offen offset:1024  lds
s_add_u32 m0, s90, 67648
s_nop 0
buffer_load_dwordx4 v118, s[8:11], s89 offen offset:2048  lds
s_add_u32 m0, s90, 67680
s_nop 0
buffer_load_dwordx4 v118, s[8:11], s89 offen offset:3072  lds
s_add_u32 m0, s90, 71808
s_nop 0
buffer_load_dwordx4 v119, s[8:11], s89 offen offset:0  lds
s_add_u32 m0, s90, 71840
s_nop 0
buffer_load_dwordx4 v119, s[8:11], s89 offen offset:1024  lds
s_add_u32 m0, s90, 71872
s_nop 0
buffer_load_dwordx4 v119, s[8:11], s89 offen offset:2048  lds
s_add_u32 m0, s90, 71904
s_nop 0
buffer_load_dwordx4 v119, s[8:11], s89 offen offset:3072  lds
s_add_u32 s89, s89, 0x40000
s_cmp_eq_u32 s89, 0x200000
s_cselect_b32 s89, 0x20000, s89
buffer_load_dwordx4 a[32:35], v116, s[4:7], s88 offen offset:0 sc1
buffer_load_dwordx4 a[36:39], v116, s[4:7], s88 offen offset:1024 sc1
buffer_load_dwordx4 a[40:43], v116, s[4:7], s88 offen offset:2048 sc1
buffer_load_dwordx4 a[44:47], v116, s[4:7], s88 offen offset:3072 sc1
buffer_load_dwordx4 a[48:51], v117, s[4:7], s88 offen offset:0 sc1
buffer_load_dwordx4 a[52:55], v117, s[4:7], s88 offen offset:1024 sc1
buffer_load_dwordx4 a[56:59], v117, s[4:7], s88 offen offset:2048 sc1
buffer_load_dwordx4 a[60:63], v117, s[4:7], s88 offen offset:3072 sc1
s_add_u32 s88, s88, 0x20000
s_cmp_eq_u32 s88, 0x100000
s_cselect_b32 s88, 0x10000, s88
s_add_u32 m0, s90, 33792
s_nop 0
buffer_load_dwordx4 v118, s[8:11], s89 offen offset:0  lds
s_add_u32 m0, s90, 33824
s_nop 0
buffer_load_dwordx4 v118, s[8:11], s89 offen offset:1024  lds
s_add_u32 m0, s90, 33856
s_nop 0
buffer_load_dwordx4 v118, s[8:11], s89 offen offset:2048  lds
s_add_u32 m0, s90, 33888
s_nop 0
buffer_load_dwordx4 v118, s[8:11], s89 offen offset:3072  lds
s_add_u32 m0, s90, 38016
s_nop 0
buffer_load_dwordx4 v119, s[8:11], s89 offen offset:0  lds
s_add_u32 m0, s90, 38048
s_nop 0
buffer_load_dwordx4 v119, s[8:11], s89 offen offset:1024  lds
s_add_u32 m0, s90, 38080
s_nop 0
buffer_load_dwordx4 v119, s[8:11], s89 offen offset:2048  lds
s_add_u32 m0, s90, 38112
s_nop 0
buffer_load_dwordx4 v119, s[8:11], s89 offen offset:3072  lds
s_add_u32 s89, s89, 0x40000
s_cmp_eq_u32 s89, 0x200000
s_cselect_b32 s89, 0x20000, s89
buffer_load_dwordx4 a[64:67], v116, s[4:7], s88 offen offset:0 sc1
buffer_load_dwordx4 a[68:71], v116, s[4:7], s88 offen offset:1024 sc1
buffer_load_dwordx4 a[72:75], v116, s[4:7], s88 offen offset:2048 sc1
buffer_load_dwordx4 a[76:79], v116, s[4:7], s88 offen offset:3072 sc1
buffer_load_dwordx4 a[80:83], v117, s[4:7], s88 offen offset:0 sc1
buffer_load_dwordx4 a[84:87], v117, s[4:7], s88 offen offset:1024 sc1
buffer_load_dwordx4 a[88:91], v117, s[4:7], s88 offen offset:2048 sc1
buffer_load_dwordx4 a[92:95], v117, s[4:7], s88 offen offset:3072 sc1
s_add_u32 s88, s88, 0x20000
s_cmp_eq_u32 s88, 0x100000
s_cselect_b32 s88, 0x10000, s88
s_waitcnt vmcnt(0)
s_add_u32 m0, s90, 101376
s_nop 0
buffer_load_dwordx4 v118, s[8:11], s89 offen offset:0  lds
s_add_u32 m0, s90, 101408
s_nop 0
buffer_load_dwordx4 v118, s[8:11], s89 offen offset:1024  lds
s_add_u32 m0, s90, 101440
s_nop 0
buffer_load_dwordx4 v118, s[8:11], s89 offen offset:2048  lds
s_add_u32 m0, s90, 101472
s_nop 0
buffer_load_dwordx4 v118, s[8:11], s89 offen offset:3072  lds
s_add_u32 m0, s90, 105600
s_nop 0
buffer_load_dwordx4 v119, s[8:11], s89 offen offset:0  lds
s_add_u32 m0, s90, 105632
s_nop 0
buffer_load_dwordx4 v119, s[8:11], s89 offen offset:1024  lds
s_add_u32 m0, s90, 105664
s_nop 0
buffer_load_dwordx4 v119, s[8:11], s89 offen offset:2048  lds
s_add_u32 m0, s90, 105696
s_nop 0
buffer_load_dwordx4 v119, s[8:11], s89 offen offset:3072  lds
s_add_u32 s89, s89, 0x40000
s_cmp_eq_u32 s89, 0x200000
s_cselect_b32 s89, 0x20000, s89
buffer_load_dwordx4 a[96:99], v116, s[4:7], s88 offen offset:0 sc1
buffer_load_dwordx4 a[100:103], v116, s[4:7], s88 offen offset:1024 sc1
buffer_load_dwordx4 a[104:107], v116, s[4:7], s88 offen offset:2048 sc1
buffer_load_dwordx4 a[108:111], v116, s[4:7], s88 offen offset:3072 sc1
buffer_load_dwordx4 a[112:115], v117, s[4:7], s88 offen offset:0 sc1
buffer_load_dwordx4 a[116:119], v117, s[4:7], s88 offen offset:1024 sc1
buffer_load_dwordx4 a[120:123], v117, s[4:7], s88 offen offset:2048 sc1
buffer_load_dwordx4 a[124:127], v117, s[4:7], s88 offen offset:3072 sc1
s_add_u32 s88, s88, 0x20000
s_cmp_eq_u32 s88, 0x100000
s_cselect_b32 s88, 0x10000, s88
v_subrev_u32 v120, 67584, v3
s_waitcnt vmcnt(0)
s_barrier
ds_read_b64_tr_b16 v[36:37], v120 offset:0
ds_read_b64_tr_b16 v[38:39], v120 offset:256
ds_read_b64_tr_b16 v[40:41], v120 offset:512
ds_read_b64_tr_b16 v[42:43], v120 offset:768
ds_read_b64_tr_b16 v[44:45], v120 offset:16896
ds_read_b64_tr_b16 v[46:47], v120 offset:17152
ds_read_b64_tr_b16 v[48:49], v120 offset:17408
ds_read_b64_tr_b16 v[50:51], v120 offset:17664
ds_read_b64_tr_b16 v[52:53], v120 offset:32
ds_read_b64_tr_b16 v[54:55], v120 offset:288
ds_read_b64_tr_b16 v[56:57], v120 offset:544
ds_read_b64_tr_b16 v[58:59], v120 offset:800
ds_read_b64_tr_b16 v[60:61], v120 offset:16928
ds_read_b64_tr_b16 v[62:63], v120 offset:17184
ds_read_b64_tr_b16 v[64:65], v120 offset:17440
ds_read_b64_tr_b16 v[66:67], v120 offset:17696
ds_read_b64_tr_b16 v[68:69], v120 offset:64
ds_read_b64_tr_b16 v[70:71], v120 offset:320
ds_read_b64_tr_b16 v[72:73], v120 offset:576
ds_read_b64_tr_b16 v[74:75], v120 offset:832
ds_read_b64_tr_b16 v[76:77], v120 offset:16960
ds_read_b64_tr_b16 v[78:79], v120 offset:17216
ds_read_b64_tr_b16 v[80:81], v120 offset:17472
ds_read_b64_tr_b16 v[82:83], v120 offset:17728
s_waitcnt lgkmcnt(0)
s_branch O_STEP0
.p2align 6
.type PF_TABLE,@object
PF_TABLE:
.long 0x4000, 0x4080, 0x4100, 0x4180, 0x4200, 0x4280, 0x4300, 0x4380
.long 0x4400, 0x4480, 0x4500, 0x4580, 0x4600, 0x4680, 0x4700, 0x4780
.long 0x4800, 0x4880, 0x4900, 0x4980, 0x4a00, 0x40000000, 0x40000000, 0x40000000
.long 0x40000000, 0x40000000, 0x40000000, 0x40000000, 0x40000000, 0x40000000, 0x40000000, 0x40000000
.long 0x40000000, 0x40000000, 0x40000000, 0x40000000, 0x40000000, 0x40000000, 0x40000000, 0x40000000
.long 0x40000000, 0x40000000, 0x40000000, 0x40000000, 0x40000000, 0x40000000, 0x40000000, 0x40000000
.long 0x40000000, 0x40000000, 0x40000000, 0x40000000, 0x40000000, 0x40000000, 0x40000000, 0x40000000
.long 0x40000000, 0x40000000, 0x40000000, 0x40000000, 0x40000000, 0x40000000, 0x40000000, 0x40000000
.long 0x4a80, 0x4b00, 0x4b80, 0x4c00, 0x4c80, 0x4d00, 0x4d80, 0x4e00
.long 0x4e80, 0x4f00, 0x4f80, 0x8000, 0x8080, 0x8100, 0x8180, 0x8200
.long 0x8280, 0x8300, 0x8380, 0x8400, 0x8480, 0x40000000, 0x40000000, 0x40000000
.long 0x40000000, 0x40000000, 0x40000000, 0x40000000, 0x40000000, 0x40000000, 0x40000000, 0x40000000
.long 0x40000000, 0x40000000, 0x40000000, 0x40000000, 0x40000000, 0x40000000, 0x40000000, 0x40000000
.long 0x40000000, 0x40000000, 0x40000000, 0x40000000, 0x40000000, 0x40000000, 0x40000000, 0x40000000
.long 0x40000000, 0x40000000, 0x40000000, 0x40000000, 0x40000000, 0x40000000, 0x40000000, 0x40000000
.long 0x40000000, 0x40000000, 0x40000000, 0x40000000, 0x40000000, 0x40000000, 0x40000000, 0x40000000
.long 0x8500, 0x8580, 0x8600, 0x8680, 0x8700, 0x8780, 0x8800, 0x8880
.long 0x8900, 0x8980, 0x8a00, 0x8a80, 0x8b00, 0x8b80, 0x8c00, 0x8c80
.long 0x8d00, 0x8d80, 0x8e00, 0x8e80, 0x8f00, 0x40000000, 0x40000000, 0x40000000
.long 0x40000000, 0x40000000, 0x40000000, 0x40000000, 0x40000000, 0x40000000, 0x40000000, 0x40000000
.long 0x40000000, 0x40000000, 0x40000000, 0x40000000, 0x40000000, 0x40000000, 0x40000000, 0x40000000
.long 0x40000000, 0x40000000, 0x40000000, 0x40000000, 0x40000000, 0x40000000, 0x40000000, 0x40000000
.long 0x40000000, 0x40000000, 0x40000000, 0x40000000, 0x40000000, 0x40000000, 0x40000000, 0x40000000
.long 0x40000000, 0x40000000, 0x40000000, 0x40000000, 0x40000000, 0x40000000, 0x40000000, 0x40000000
.long 0x8f80, 0xc300, 0xc380, 0xc400, 0xc480, 0xc500, 0xc580, 0xc600
.long 0xc680, 0xc700, 0xc780, 0xc800, 0xc880, 0xc900, 0xc980, 0xca00
.long 0xca80, 0xcb00, 0xcb80, 0xcc00, 0xcc80, 0x40000000, 0x40000000, 0x40000000
.long 0x40000000, 0x40000000, 0x40000000, 0x40000000, 0x40000000, 0x40000000, 0x40000000, 0x40000000
.long 0x40000000, 0x40000000, 0x40000000, 0x40000000, 0x40000000, 0x40000000, 0x40000000, 0x40000000
.long 0x40000000, 0x40000000, 0x40000000, 0x40000000, 0x40000000, 0x40000000, 0x40000000, 0x40000000
.long 0x40000000, 0x40000000, 0x40000000, 0x40000000, 0x40000000, 0x40000000, 0x40000000, 0x40000000
.long 0x40000000, 0x40000000, 0x40000000, 0x40000000, 0x40000000, 0x40000000, 0x40000000, 0x40000000
.long 0xcd00, 0xcd80, 0xce00, 0xce80, 0xcf00, 0xcf80, 0x10300, 0x10380
.long 0x10400, 0x10480, 0x10500, 0x10580, 0x10600, 0x10680, 0x10700, 0x10780
.long 0x10800, 0x10880, 0x10900, 0x10980, 0x10a00, 0x40000000, 0x40000000, 0x40000000
.long 0x40000000, 0x40000000, 0x40000000, 0x40000000, 0x40000000, 0x40000000, 0x40000000, 0x40000000
.long 0x40000000, 0x40000000, 0x40000000, 0x40000000, 0x40000000, 0x40000000, 0x40000000, 0x40000000
.long 0x40000000, 0x40000000, 0x40000000, 0x40000000, 0x40000000, 0x40000000, 0x40000000, 0x40000000
.long 0x40000000, 0x40000000, 0x40000000, 0x40000000, 0x40000000, 0x40000000, 0x40000000, 0x40000000
.long 0x40000000, 0x40000000, 0x40000000, 0x40000000, 0x40000000, 0x40000000, 0x40000000, 0x40000000
.long 0x10a80, 0x10b00, 0x10b80, 0x10c00, 0x10c80, 0x10d00, 0x10d80, 0x10e00
.long 0x10e80, 0x10f00, 0x10f80, 0x14300, 0x14380, 0x14400, 0x14480, 0x14500
.long 0x14580, 0x14600, 0x14680, 0x14700, 0x14780, 0x40000000, 0x40000000, 0x40000000
.long 0x40000000, 0x40000000, 0x40000000, 0x40000000, 0x40000000, 0x40000000, 0x40000000, 0x40000000
.long 0x40000000, 0x40000000, 0x40000000, 0x40000000, 0x40000000, 0x40000000, 0x40000000, 0x40000000
.long 0x40000000, 0x40000000, 0x40000000, 0x40000000, 0x40000000, 0x40000000, 0x40000000, 0x40000000
.long 0x40000000, 0x40000000, 0x40000000, 0x40000000, 0x40000000, 0x40000000, 0x40000000, 0x40000000
.long 0x40000000, 0x40000000, 0x40000000, 0x40000000, 0x40000000, 0x40000000, 0x40000000, 0x40000000
.long 0x14800, 0x14880, 0x14900, 0x14980, 0x14a00, 0x14a80, 0x14b00, 0x14b80
.long 0x14c00, 0x14c80, 0x14d00, 0x14d80, 0x14e00, 0x14e80, 0x14f00, 0x14f80
.long 0x18800, 0x18880, 0x18900, 0x18980, 0x18a00, 0x40000000, 0x40000000, 0x40000000
.long 0x40000000, 0x40000000, 0x40000000, 0x40000000, 0x40000000, 0x40000000, 0x40000000, 0x40000000
.long 0x40000000, 0x40000000, 0x40000000, 0x40000000, 0x40000000, 0x40000000, 0x40000000, 0x40000000
.long 0x40000000, 0x40000000, 0x40000000, 0x40000000, 0x40000000, 0x40000000, 0x40000000, 0x40000000
.long 0x40000000, 0x40000000, 0x40000000, 0x40000000, 0x40000000, 0x40000000, 0x40000000, 0x40000000
.long 0x40000000, 0x40000000, 0x40000000, 0x40000000, 0x40000000, 0x40000000, 0x40000000, 0x40000000
.long 0x18a80, 0x18b00, 0x18b80, 0x18c00, 0x18c80, 0x18d00, 0x18d80, 0x18e00
.long 0x18e80, 0x18f00, 0x18f80, 0x1c800, 0x1c880, 0x1c900, 0x1c980, 0x1ca00
.long 0x1ca80, 0x1cb00, 0x1cb80, 0x1cc00, 0x1cc80, 0x40000000, 0x40000000, 0x40000000
.long 0x40000000, 0x40000000, 0x40000000, 0x40000000, 0x40000000, 0x40000000, 0x40000000, 0x40000000
.long 0x40000000, 0x40000000, 0x40000000, 0x40000000, 0x40000000, 0x40000000, 0x40000000, 0x40000000
.long 0x40000000, 0x40000000, 0x40000000, 0x40000000, 0x40000000, 0x40000000, 0x40000000, 0x40000000
.long 0x40000000, 0x40000000, 0x40000000, 0x40000000, 0x40000000, 0x40000000, 0x40000000, 0x40000000
.long 0x40000000, 0x40000000, 0x40000000, 0x40000000, 0x40000000, 0x40000000, 0x40000000, 0x40000000
.long 0x1cd00, 0x1cd80, 0x1ce00, 0x1ce80, 0x1cf00, 0x1cf80, 0x20800, 0x20880
.long 0x20900, 0x20980, 0x20a00, 0x20a80, 0x20b00, 0x20b80, 0x20c00, 0x20c80
.long 0x20d00, 0x20d80, 0x20e00, 0x20e80, 0x20f00, 0x40000000, 0x40000000, 0x40000000
.long 0x40000000, 0x40000000, 0x40000000, 0x40000000, 0x40000000, 0x40000000, 0x40000000, 0x40000000
.long 0x40000000, 0x40000000, 0x40000000, 0x40000000, 0x40000000, 0x40000000, 0x40000000, 0x40000000
.long 0x40000000, 0x40000000, 0x40000000, 0x40000000, 0x40000000, 0x40000000, 0x40000000, 0x40000000
.long 0x40000000, 0x40000000, 0x40000000, 0x40000000, 0x40000000, 0x40000000, 0x40000000, 0x40000000
.long 0x40000000, 0x40000000, 0x40000000, 0x40000000, 0x40000000, 0x40000000, 0x40000000, 0x40000000
.long 0x20f80, 0x24800, 0x24880, 0x24900, 0x24980, 0x24a00, 0x24a80, 0x24b00
.long 0x24b80, 0x24c00, 0x24c80, 0x24d00, 0x24d80, 0x24e00, 0x24e80, 0x24f00
.long 0x24f80, 0x28c00, 0x28c80, 0x28d00, 0x28d80, 0x40000000, 0x40000000, 0x40000000
.long 0x40000000, 0x40000000, 0x40000000, 0x40000000, 0x40000000, 0x40000000, 0x40000000, 0x40000000
.long 0x40000000, 0x40000000, 0x40000000, 0x40000000, 0x40000000, 0x40000000, 0x40000000, 0x40000000
.long 0x40000000, 0x40000000, 0x40000000, 0x40000000, 0x40000000, 0x40000000, 0x40000000, 0x40000000
.long 0x40000000, 0x40000000, 0x40000000, 0x40000000, 0x40000000, 0x40000000, 0x40000000, 0x40000000
.long 0x40000000, 0x40000000, 0x40000000, 0x40000000, 0x40000000, 0x40000000, 0x40000000, 0x40000000
.long 0x28e00, 0x28e80, 0x28f00, 0x28f80, 0x2cc00, 0x2cc80, 0x2cd00, 0x2cd80
.long 0x2ce00, 0x2ce80, 0x2cf00, 0x2cf80, 0x30c00, 0x30c80, 0x30d00, 0x30d80
.long 0x30e00, 0x30e80, 0x30f00, 0x30f80, 0x34c00, 0x40000000, 0x40000000, 0x40000000
.long 0x40000000, 0x40000000, 0x40000000, 0x40000000, 0x40000000, 0x40000000, 0x40000000, 0x40000000
.long 0x40000000, 0x40000000, 0x40000000, 0x40000000, 0x40000000, 0x40000000, 0x40000000, 0x40000000
.long 0x40000000, 0x40000000, 0x40000000, 0x40000000, 0x40000000, 0x40000000, 0x40000000, 0x40000000
.long 0x40000000, 0x40000000, 0x40000000, 0x40000000, 0x40000000, 0x40000000, 0x40000000, 0x40000000
.long 0x40000000, 0x40000000, 0x40000000, 0x40000000, 0x40000000, 0x40000000, 0x40000000, 0x40000000
.long 0x34c80, 0x34d00, 0x34d80, 0x34e00, 0x34e80, 0x34f00, 0x34f80, 0x38e00
.long 0x38e80, 0x38f00, 0x38f80, 0x3ce00, 0x3ce80, 0x3cf00, 0x3cf80, 0x40e00
.long 0x40e80, 0x40f00, 0x40f80, 0x44e00, 0x44e80, 0x40000000, 0x40000000, 0x40000000
.long 0x40000000, 0x40000000, 0x40000000, 0x40000000, 0x40000000, 0x40000000, 0x40000000, 0x40000000
.long 0x40000000, 0x40000000, 0x40000000, 0x40000000, 0x40000000, 0x40000000, 0x40000000, 0x40000000
.long 0x40000000, 0x40000000, 0x40000000, 0x40000000, 0x40000000, 0x40000000, 0x40000000, 0x40000000
.long 0x40000000, 0x40000000, 0x40000000, 0x40000000, 0x40000000, 0x40000000, 0x40000000, 0x40000000
.long 0x40000000, 0x40000000, 0x40000000, 0x40000000, 0x40000000, 0x40000000, 0x40000000, 0x40000000
.long 0x44f00, 0x44f80, 0x48e00, 0x48e80, 0x48f00, 0x48f80, 0x4ca00, 0x4ca80
.long 0x4cb00, 0x4cb80, 0x4cc00, 0x4cc80, 0x4cd00, 0x4cd80, 0x4ce00, 0x4ce80
.long 0x4cf00, 0x4cf80, 0x50a00, 0x50a80, 0x50b00, 0x40000000, 0x40000000, 0x40000000
.long 0x40000000, 0x40000000, 0x40000000, 0x40000000, 0x40000000, 0x40000000, 0x40000000, 0x40000000
.long 0x40000000, 0x40000000, 0x40000000, 0x40000000, 0x40000000, 0x40000000, 0x40000000, 0x40000000
.long 0x40000000, 0x40000000, 0x40000000, 0x40000000, 0x40000000, 0x40000000, 0x40000000, 0x40000000
.long 0x40000000, 0x40000000, 0x40000000, 0x40000000, 0x40000000, 0x40000000, 0x40000000, 0x40000000
.long 0x40000000, 0x40000000, 0x40000000, 0x40000000, 0x40000000, 0x40000000, 0x40000000, 0x40000000
.long 0x50b80, 0x50c00, 0x50c80, 0x50d00, 0x50d80, 0x50e00, 0x50e80, 0x50f00
.long 0x50f80, 0x54a00, 0x54a80, 0x54b00, 0x54b80, 0x54c00, 0x54c80, 0x54d00
.long 0x54d80, 0x54e00, 0x54e80, 0x54f00, 0x54f80, 0x40000000, 0x40000000, 0x40000000
.long 0x40000000, 0x40000000, 0x40000000, 0x40000000, 0x40000000, 0x40000000, 0x40000000, 0x40000000
.long 0x40000000, 0x40000000, 0x40000000, 0x40000000, 0x40000000, 0x40000000, 0x40000000, 0x40000000
.long 0x40000000, 0x40000000, 0x40000000, 0x40000000, 0x40000000, 0x40000000, 0x40000000, 0x40000000
.long 0x40000000, 0x40000000, 0x40000000, 0x40000000, 0x40000000, 0x40000000, 0x40000000, 0x40000000
.long 0x40000000, 0x40000000, 0x40000000, 0x40000000, 0x40000000, 0x40000000, 0x40000000, 0x40000000
.long 0x58a00, 0x58a80, 0x58b00, 0x58b80, 0x58c00, 0x58c80, 0x58d00, 0x58d80
.long 0x58e00, 0x58e80, 0x58f00, 0x58f80, 0x5cd00, 0x5cd80, 0x5ce00, 0x5ce80
.long 0x5cf00, 0x5cf80, 0x60d00, 0x60d80, 0x60e00, 0x40000000, 0x40000000, 0x40000000
.long 0x40000000, 0x40000000, 0x40000000, 0x40000000, 0x40000000, 0x40000000, 0x40000000, 0x40000000
.long 0x40000000, 0x40000000, 0x40000000, 0x40000000, 0x40000000, 0x40000000, 0x40000000, 0x40000000
.long 0x40000000, 0x40000000, 0x40000000, 0x40000000, 0x40000000, 0x40000000, 0x40000000, 0x40000000
.long 0x40000000, 0x40000000, 0x40000000, 0x40000000, 0x40000000, 0x40000000, 0x40000000, 0x40000000
.long 0x40000000, 0x40000000, 0x40000000, 0x40000000, 0x40000000, 0x40000000, 0x40000000, 0x40000000
.long 0x60e80, 0x60f00, 0x60f80, 0x64d00, 0x64d80, 0x64e00, 0x64e80, 0x64f00
.long 0x64f80, 0x68d00, 0x68d80, 0x68e00, 0x68e80, 0x68f00, 0x68f80, 0x6cd00
.long 0x6cd80, 0x6ce00, 0x6ce80, 0x6cf00, 0x6cf80, 0x40000000, 0x40000000, 0x40000000
.long 0x40000000, 0x40000000, 0x40000000, 0x40000000, 0x40000000, 0x40000000, 0x40000000, 0x40000000
.long 0x40000000, 0x40000000, 0x40000000, 0x40000000, 0x40000000, 0x40000000, 0x40000000, 0x40000000
.long 0x40000000, 0x40000000, 0x40000000, 0x40000000, 0x40000000, 0x40000000, 0x40000000, 0x40000000
.long 0x40000000, 0x40000000, 0x40000000, 0x40000000, 0x40000000, 0x40000000, 0x40000000, 0x40000000
.long 0x40000000, 0x40000000, 0x40000000, 0x40000000, 0x40000000, 0x40000000, 0x40000000, 0x40000000
CODE_END:
.section .rodata,"a"
.p2align 6
.amdhsa_kernel concat_heads__mha_block_cached__gqa_block_cached__near_ridge_kernel
  .amdhsa_next_free_vgpr 512
  .amdhsa_next_free_sgpr 102
  .amdhsa_accum_offset 256
  .amdhsa_group_segment_fixed_size 0
  .amdhsa_kernarg_size 104
  .amdhsa_user_sgpr_count 2
  .amdhsa_user_sgpr_kernarg_segment_ptr 1
  .amdhsa_system_sgpr_workgroup_id_x 1
.end_amdhsa_kernel
```
